```python
import torch

def _softmax(x, axis=-1):
    return torch.softmax(x, dim=axis)
def _gelu(x):
    return torch.nn.functional.gelu(x, approximate="tanh")
def _silu(x):
    return torch.nn.functional.silu(x)
def _sigmoid(x):
    return torch.sigmoid(x)
def _layernorm(x, axis=-1, eps=1e-5):
    m = x.mean(dim=axis, keepdim=True)
    v = x.var(dim=axis, keepdim=True, unbiased=False)
    return (x - m) / torch.sqrt(v + eps)
def _scatter_add(tgt, idx, src, axis=0):
    return tgt.clone().index_add_(axis, idx, src)
def _segment_sum(src, seg, n):
    out = torch.zeros((n,) + src.shape[1:], dtype=src.dtype)
    return out.index_add_(0, seg, src)
def _pad(x, pw):
    flat = tuple(v for pair in reversed(pw) for v in pair)
    return torch.nn.functional.pad(x, flat)

kernel_name = 'recurrent_scan__gqa_block_cached__dense_activation_gelu__prompt'

def setup_inputs():

    _w = (lambda a: (lambda t: t.to(torch.bfloat16) if t.is_floating_point() else t)(torch.as_tensor(a)))
    def _A_setup():
        B, Sq, D = 1, 2048, 640
        Hq, Hkv, Sk, Dh = 32, 32, 2048, 192
        assert Hq % Hkv == 0, (Hq, Hkv)
        return {
            "x": _w((lambda *s: torch.randn(*s, dtype=torch.bfloat16) * 0.05)(B, Sq, D)),
            "k_cache": _w((lambda *s: torch.randn(*s, dtype=torch.bfloat16) * 3.2)(B, Hkv, Sk, Dh)),
            "v_cache": _w((lambda *s: torch.randn(*s, dtype=torch.bfloat16) * 3.2)(B, Hkv, Sk, Dh)),
            "wq": _w((lambda *s: torch.randn(*s, dtype=torch.bfloat16) * 3.2)(D, Hq * Dh) * (D ** -0.5)),
            "wo": _w((lambda *s: torch.randn(*s, dtype=torch.bfloat16) * 3.2)(Hq * Dh, D) * ((Hq * Dh) ** -0.5)),
        }
    _A_in = _A_setup()

    def _B_setup():
        B, S, D, F = 1, 2048, 640, 1536
        return {
            "x": _w((lambda *s: torch.randn(*s, dtype=torch.bfloat16) * 0.05)(B, S, D)),
            "w1": _w((lambda *s: torch.randn(*s, dtype=torch.bfloat16) * 3.2)(D, F) * (D ** -0.5)),
            "b1": _w((lambda *s: torch.randn(*s, dtype=torch.bfloat16) * 3.2)(F) * 0.01),
            "w2": _w((lambda *s: torch.randn(*s, dtype=torch.bfloat16) * 0.4)(F, D) * (F ** -0.5)),
            "b2": _w((lambda *s: torch.randn(*s, dtype=torch.bfloat16) * 0.4)(D) * 0.01),
        }
    _B_in = _B_setup()

    return {
        "A_x": _A_in["x"],
        "A_k_cache": _A_in["k_cache"],
        "A_v_cache": _A_in["v_cache"],
        "A_wq": _A_in["wq"],
        "A_wo": _A_in["wo"],
        "B_x": _B_in["x"],
        "B_w1": _B_in["w1"],
        "B_b1": _B_in["b1"],
        "B_w2": _B_in["w2"],
        "B_b2": _B_in["b2"],
    }

def reference(A_x, A_k_cache, A_v_cache, A_wq, A_wo, B_x, B_w1, B_b1, B_w2, B_b2):
    def _A_ref(x, k_cache, v_cache, wq, wo):
        B, Sq, D = x.shape
        Hq, Dh = 32, 192
        Hkv = k_cache.shape[1]
        rep = Hq // Hkv
        q = (lambda x, *d: x.permute(*d))((x @ wq).reshape(B, Sq, Hq, Dh), 0, 2, 1, 3)
        k = (lambda x, n, axis: torch.repeat_interleave(x, n, dim=axis))(k_cache, rep, axis=1)
        v = (lambda x, n, axis: torch.repeat_interleave(x, n, dim=axis))(v_cache, rep, axis=1)
        scores = torch.einsum("bhqd,bhkd->bhqk", q, k) * (Dh ** -0.5)
        p = _softmax(scores, axis=-1)
        o = torch.einsum("bhqk,bhkd->bhqd", p, v)
        return (lambda x, *d: x.permute(*d))(o, 0, 2, 1, 3).reshape(B, Sq, Hq * Dh) @ wo

    def _B_ref(x, w1, b1, w2, b2):
        h = torch.einsum("bsd,df->bsf", x, w1) + b1
        h = _gelu(h)
        return torch.einsum("bsf,fd->bsd", h, w2) + b2

    x = A_x
    xn = _layernorm(x, axis=-1)
    s = _A_ref(xn, A_k_cache, A_v_cache, A_wq, A_wo)
    g = _silu(_B_ref(xn, B_w1, B_b1, B_w2, B_b2))
    return x + s * g
```

```asm
; @launch grid=(256,1,1) block=(256,1,1) lds=163840
.amdgcn_target "amdgcn-amd-amdhsa--gfx950"
.text
.globl recurrent_scan__gqa_block_cached__dense_activation_gelu__prompt_kernel
.p2align 8
.type recurrent_scan__gqa_block_cached__dense_activation_gelu__prompt_kernel,@function
recurrent_scan__gqa_block_cached__dense_activation_gelu__prompt_kernel:
    s_cmp_ge_u32 s2, 256
    s_cbranch_scc1 L_end
    s_load_dwordx2 s[82:83], s[0:1], 0
    s_load_dwordx2 s[80:81], s[0:1], 96
    s_load_dwordx4 s[60:63], s[0:1], 8
    s_load_dwordx4 s[64:67], s[0:1], 24
    s_load_dwordx4 s[68:71], s[0:1], 48
    s_load_dwordx4 s[72:75], s[0:1], 64
    s_load_dwordx4 s[76:79], s[0:1], 80
    v_and_b32 v63, 63, v0
    v_lshlrev_b32 v63, 7, v63
    s_getpc_b64 s[4:5]
L_pc2:
    s_mov_b32 s6, L_p1_loop-L_pc2
    s_mov_b32 s7, 0x00020000
    s_bfe_u32 s45, s2, 0x30003
    s_mul_i32 s45, s45, 768
    v_min_u32 v60, 640, v63
    buffer_load_dword v61, v60, s[4:7], s45 offen
    s_and_b32 s45, s2, 7
    s_lshl_b32 s45, s45, 2
    s_bfe_u32 s46, s2, 0x20003
    s_add_u32 s36, s45, s46
    s_lshr_b32 s37, s2, 5
    s_mov_b32 s51, 0
    v_lshrrev_b32 v85, 4, v0
    v_lshrrev_b32 v1, 6, v0
    v_and_b32 v0, 63, v0
    v_readfirstlane_b32 s38, v1
    s_lshl_b32 s45, s37, 8
    s_lshl_b32 s46, s36, 3
    s_add_u32 s45, s45, s46
    v_add_u32 v85, s45, v85
    v_and_b32 v31, 15, v0
    v_mul_u32_u24 v86, 1280, v85
    v_lshl_add_u32 v86, v31, 4, v86
    s_waitcnt lgkmcnt(0)
    s_add_u32 s92, s80, 117440512
    s_addc_u32 s93, s81, 0
    s_load_dword s100, s[92:93], 163840
    s_mov_b32 s84, s82
    s_mov_b32 s85, s83
    s_mov_b32 s86, 2621440
    s_mov_b32 s87, 0x00020000
    s_cmp_ge_u32 s38, 2
    s_cbranch_scc1 L_restart
    buffer_load_dwordx4 v[64:67], v86, s[84:87], 0 offen offset:0
    buffer_load_dwordx4 v[68:71], v86, s[84:87], 0 offen offset:256
    buffer_load_dwordx4 v[72:75], v86, s[84:87], 0 offen offset:512
    buffer_load_dwordx4 v[76:79], v86, s[84:87], 0 offen offset:768
    buffer_load_dwordx4 v[80:83], v86, s[84:87], 0 offen offset:1024
L_restart:
    v_lshrrev_b32 v84, 4, v85
    v_mul_u32_u24 v84, 20480, v84
    v_lshrrev_b32 v87, 2, v31
    v_lshl_add_u32 v84, v87, 10, v84
    v_and_b32 v87, 3, v31
    v_lshl_add_u32 v84, v87, 6, v84
    v_bfe_u32 v87, v85, 2, 2
    v_lshl_add_u32 v84, v87, 8, v84
    v_and_b32 v87, 3, v85
    v_lshl_add_u32 v84, v87, 4, v84
    v_and_b32 v26, 7, v0
    v_lshrrev_b32 v27, 3, v0
    v_lshrrev_b32 v28, 4, v0
    v_bfe_u32 v29, v0, 2, 2
    v_and_b32 v30, 3, v0
    v_and_b32 v31, 15, v0
    v_lshlrev_b32 v1, 4, v0
    v_lshlrev_b32 v36, 3, v28
    v_lshlrev_b32 v62, 2, v0
    s_mul_i32 s48, s38, 3072
    s_mul_i32 s45, s36, 96
    s_sub_u32 s46, 3072, s45
    s_add_u32 s32, s70, s45
    s_addc_u32 s33, s71, 0
    s_mov_b32 s34, s46
    s_mov_b32 s35, 0x00020000
    buffer_load_dwordx2 v[40:41], v36, s[32:35], 0 offen offset:0
    buffer_load_dwordx2 v[42:43], v36, s[32:35], 0 offen offset:32
    buffer_load_dwordx2 v[44:45], v36, s[32:35], 0 offen offset:64
    s_sub_u32 s46, 1966080, s45
    s_add_u32 s12, s68, s45
    s_addc_u32 s13, s69, 0
    s_mov_b32 s14, s46
    s_mov_b32 s15, 0x00020000
    s_mul_i32 s45, s36, 384
    s_sub_u32 s46, 7864320, s45
    s_add_u32 s8, s64, s45
    s_addc_u32 s9, s65, 0
    s_mov_b32 s10, s46
    s_mov_b32 s11, 0x00020000
    s_mov_b32 s94, 360576
    s_mov_b32 s95, 0x00020000
    s_lshl_b32 s45, s38, 3
    v_add_u32 v32, s45, v27
    v_mul_u32_u24 v33, 12288, v32
    v_bfe_u32 v34, v27, 1, 1
    v_lshlrev_b32 v35, 2, v34
    v_xor_b32 v35, v35, v26
    v_lshl_add_u32 v20, v35, 4, v33
    s_and_b32 s45, s38, 1
    s_lshl_b32 s45, s45, 2
    v_lshlrev_b32 v35, 1, v34
    v_or_b32 v35, s45, v35
    v_xor_b32 v35, v35, v26
    v_mul_u32_u24 v33, 3072, v32
    v_lshl_add_u32 v21, v35, 4, v33
    s_lshl_b32 s53, s38, 10
    v_mov_b32 v36, 0
    s_lshl_b32 s45, s51, 1
    s_or_b32 s45, s45, s38
    s_cmp_lt_u32 s45, 2
    s_cbranch_scc1 L_ln
    s_cmp_lg_u32 s51, 0
    s_cbranch_scc1 L_nopf
    s_lshl_b32 s45, s37, 4
    v_lshrrev_b32 v52, 2, v0
    v_add_u32 v52, s45, v52
    v_mul_u32_u24 v53, 3072, v52
    v_lshlrev_b32 v52, 2, v53
    v_lshl_add_u32 v52, v30, 7, v52
    v_mul_u32_u24 v54, 40, v30
    v_add_u32 v53, v54, v53
    s_cmp_eq_u32 s38, 2
    s_cbranch_scc1 L_pf2
    s_mov_b32 s45, 1572864
    v_mov_b32 v55, v52
    buffer_load_dword v56, v52, s[8:11], 0 offen
    buffer_load_dword v57, v52, s[8:11], s45 offen
    s_branch L_pf3
L_pf2:
    s_mov_b32 s45, 393216
    v_mov_b32 v55, v53
    buffer_load_dword v56, v53, s[12:15], 0 offen
    buffer_load_dword v57, v53, s[12:15], s45 offen
L_pf3:
    s_getpc_b64 s[4:5]
L_pc0:
    s_add_u32 s4, s4, L_p1_loop-L_pc0
    s_addc_u32 s5, s5, 0
    s_mov_b32 s6, L_maxfirst-L_p1_loop
    s_bfe_u32 s45, s2, 0x40003
    s_lshl_b32 s45, s45, 1
    s_add_u32 s45, s45, s38
    s_sub_u32 s45, s45, 2
    s_mul_i32 s45, s45, 640
    buffer_load_dword v58, v60, s[4:7], s45 offen
    s_waitcnt vmcnt(1) lgkmcnt(0)
    s_add_u32 s100, s100, 1
L_nopf:
    v_mov_b32 v52, v20
    v_mov_b32 v53, v21
    s_mov_b32 s40, s48
    s_mov_b32 s52, s53
    s_mov_b32 s44, s51
L_pre:
    s_mov_b32 s42, 0
    s_mov_b32 s43, 393216
    s_mov_b32 s54, 0
    s_mov_b32 s55, 98304
    s_add_u32 m0, s40, 122880
    s_nop 0
    buffer_load_dwordx4 v52, s[8:11], s42 offen offset:0 lds
    s_add_u32 m0, s40, 123776
    s_nop 0
    buffer_load_dwordx4 v52, s[8:11], s42 offen offset:128 lds
    s_add_u32 m0, s40, 124672
    s_nop 0
    buffer_load_dwordx4 v52, s[8:11], s42 offen offset:256 lds
    s_add_u32 m0, s40, 135168
    s_nop 0
    buffer_load_dwordx4 v52, s[8:11], s43 offen offset:0 lds
    s_add_u32 m0, s40, 136064
    s_nop 0
    buffer_load_dwordx4 v52, s[8:11], s43 offen offset:128 lds
    s_add_u32 m0, s40, 136960
    s_nop 0
    buffer_load_dwordx4 v52, s[8:11], s43 offen offset:256 lds
    s_add_u32 m0, s52, 49152
    s_nop 0
    buffer_load_dwordx4 v53, s[12:15], s54 offen lds
    s_add_u32 m0, s52, 53248
    s_nop 0
    buffer_load_dwordx4 v53, s[12:15], s55 offen lds
    s_mov_b32 s42, 786432
    s_mov_b32 s43, 1179648
    s_mov_b32 s54, 196608
    s_mov_b32 s55, 294912
    s_add_u32 m0, s40, 73728
    s_nop 0
    buffer_load_dwordx4 v52, s[8:11], s42 offen offset:0 lds
    s_add_u32 m0, s40, 74624
    s_nop 0
    buffer_load_dwordx4 v52, s[8:11], s42 offen offset:128 lds
    s_add_u32 m0, s40, 75520
    s_nop 0
    buffer_load_dwordx4 v52, s[8:11], s42 offen offset:256 lds
    s_add_u32 m0, s40, 86016
    s_nop 0
    buffer_load_dwordx4 v52, s[8:11], s43 offen offset:0 lds
    s_add_u32 m0, s40, 86912
    s_nop 0
    buffer_load_dwordx4 v52, s[8:11], s43 offen offset:128 lds
    s_add_u32 m0, s40, 87808
    s_nop 0
    buffer_load_dwordx4 v52, s[8:11], s43 offen offset:256 lds
    s_add_u32 m0, s52, 57344
    s_nop 0
    buffer_load_dwordx4 v53, s[12:15], s54 offen lds
    s_add_u32 m0, s52, 61440
    s_nop 0
    buffer_load_dwordx4 v53, s[12:15], s55 offen lds
    s_cmp_lg_u32 s44, 0
    s_cbranch_scc1 L_predone
    s_mov_b32 s44, 1
    v_subrev_u32 v52, 196608, v52
    v_subrev_u32 v53, 49152, v53
    s_sub_u32 s40, s40, 6144
    s_sub_u32 s52, s52, 2048
    s_branch L_pre
L_predone:
    s_cmp_lg_u32 s51, 0
    s_cbranch_scc1 L_setup
    s_branch L_setup
L_ln:
    s_mov_b32 s32, s80
    s_mov_b32 s33, s81
    s_mov_b32 s34, 2621440
    s_mov_b32 s35, 0x00020000
    s_waitcnt vmcnt(7)
    v_lshlrev_b32 v96, 16, v64
    v_and_b32 v97, 0xffff0000, v64
    v_lshlrev_b32 v98, 16, v65
    v_and_b32 v99, 0xffff0000, v65
    v_lshlrev_b32 v100, 16, v66
    v_and_b32 v101, 0xffff0000, v66
    v_lshlrev_b32 v102, 16, v67
    v_and_b32 v103, 0xffff0000, v67
    s_waitcnt vmcnt(6)
    v_lshlrev_b32 v104, 16, v68
    v_and_b32 v105, 0xffff0000, v68
    v_lshlrev_b32 v106, 16, v69
    v_and_b32 v107, 0xffff0000, v69
    v_lshlrev_b32 v108, 16, v70
    v_and_b32 v109, 0xffff0000, v70
    v_lshlrev_b32 v110, 16, v71
    v_and_b32 v111, 0xffff0000, v71
    s_waitcnt vmcnt(5)
    v_lshlrev_b32 v112, 16, v72
    v_and_b32 v113, 0xffff0000, v72
    v_lshlrev_b32 v114, 16, v73
    v_and_b32 v115, 0xffff0000, v73
    v_lshlrev_b32 v116, 16, v74
    v_and_b32 v117, 0xffff0000, v74
    v_lshlrev_b32 v118, 16, v75
    v_and_b32 v119, 0xffff0000, v75
    s_waitcnt vmcnt(4)
    v_lshlrev_b32 v120, 16, v76
    v_and_b32 v121, 0xffff0000, v76
    v_lshlrev_b32 v122, 16, v77
    v_and_b32 v123, 0xffff0000, v77
    v_lshlrev_b32 v124, 16, v78
    v_and_b32 v125, 0xffff0000, v78
    v_lshlrev_b32 v126, 16, v79
    v_and_b32 v127, 0xffff0000, v79
    s_waitcnt vmcnt(3)
    v_lshlrev_b32 v128, 16, v80
    v_and_b32 v129, 0xffff0000, v80
    v_lshlrev_b32 v130, 16, v81
    v_and_b32 v131, 0xffff0000, v81
    v_lshlrev_b32 v132, 16, v82
    v_and_b32 v133, 0xffff0000, v82
    v_lshlrev_b32 v134, 16, v83
    v_and_b32 v135, 0xffff0000, v83
    v_pk_add_f32 v[88:89], v[96:97], v[100:101]
    v_pk_add_f32 v[90:91], v[98:99], v[102:103]
    v_pk_add_f32 v[88:89], v[104:105], v[88:89]
    v_pk_add_f32 v[90:91], v[106:107], v[90:91]
    v_pk_add_f32 v[88:89], v[108:109], v[88:89]
    v_pk_add_f32 v[90:91], v[110:111], v[90:91]
    v_pk_add_f32 v[88:89], v[112:113], v[88:89]
    v_pk_add_f32 v[90:91], v[114:115], v[90:91]
    v_pk_add_f32 v[88:89], v[116:117], v[88:89]
    v_pk_add_f32 v[90:91], v[118:119], v[90:91]
    v_pk_add_f32 v[88:89], v[120:121], v[88:89]
    v_pk_add_f32 v[90:91], v[122:123], v[90:91]
    v_pk_add_f32 v[88:89], v[124:125], v[88:89]
    v_pk_add_f32 v[90:91], v[126:127], v[90:91]
    v_pk_add_f32 v[88:89], v[128:129], v[88:89]
    v_pk_add_f32 v[90:91], v[130:131], v[90:91]
    v_pk_add_f32 v[88:89], v[132:133], v[88:89]
    v_pk_add_f32 v[90:91], v[134:135], v[90:91]
    v_pk_add_f32 v[88:89], v[88:89], v[90:91]
    v_add_f32 v86, v88, v89
    s_nop 1
    v_add_f32 v86, v86, v86 row_ror:8
    s_nop 1
    v_add_f32 v86, v86, v86 row_ror:4
    s_nop 1
    v_add_f32 v86, v86, v86 row_ror:2
    s_nop 1
    v_add_f32 v86, v86, v86 row_ror:1
    v_mul_f32 v86, 0x3acccccd, v86
    v_pk_add_f32 v[140:141], v[96:97], v[86:87] op_sel_hi:[1,0] neg_lo:[0,1] neg_hi:[0,1]
    v_pk_mul_f32 v[136:137], v[140:141], v[140:141]
    v_pk_add_f32 v[142:143], v[98:99], v[86:87] op_sel_hi:[1,0] neg_lo:[0,1] neg_hi:[0,1]
    v_pk_mul_f32 v[138:139], v[142:143], v[142:143]
    v_pk_add_f32 v[140:141], v[100:101], v[86:87] op_sel_hi:[1,0] neg_lo:[0,1] neg_hi:[0,1]
    v_pk_fma_f32 v[136:137], v[140:141], v[140:141], v[136:137]
    v_pk_add_f32 v[142:143], v[102:103], v[86:87] op_sel_hi:[1,0] neg_lo:[0,1] neg_hi:[0,1]
    v_pk_fma_f32 v[138:139], v[142:143], v[142:143], v[138:139]
    v_pk_add_f32 v[140:141], v[104:105], v[86:87] op_sel_hi:[1,0] neg_lo:[0,1] neg_hi:[0,1]
    v_pk_fma_f32 v[136:137], v[140:141], v[140:141], v[136:137]
    v_pk_add_f32 v[142:143], v[106:107], v[86:87] op_sel_hi:[1,0] neg_lo:[0,1] neg_hi:[0,1]
    v_pk_fma_f32 v[138:139], v[142:143], v[142:143], v[138:139]
    v_pk_add_f32 v[140:141], v[108:109], v[86:87] op_sel_hi:[1,0] neg_lo:[0,1] neg_hi:[0,1]
    v_pk_fma_f32 v[136:137], v[140:141], v[140:141], v[136:137]
    v_pk_add_f32 v[142:143], v[110:111], v[86:87] op_sel_hi:[1,0] neg_lo:[0,1] neg_hi:[0,1]
    v_pk_fma_f32 v[138:139], v[142:143], v[142:143], v[138:139]
    v_pk_add_f32 v[140:141], v[112:113], v[86:87] op_sel_hi:[1,0] neg_lo:[0,1] neg_hi:[0,1]
    v_pk_fma_f32 v[136:137], v[140:141], v[140:141], v[136:137]
    v_pk_add_f32 v[142:143], v[114:115], v[86:87] op_sel_hi:[1,0] neg_lo:[0,1] neg_hi:[0,1]
    v_pk_fma_f32 v[138:139], v[142:143], v[142:143], v[138:139]
    v_pk_add_f32 v[140:141], v[116:117], v[86:87] op_sel_hi:[1,0] neg_lo:[0,1] neg_hi:[0,1]
    v_pk_fma_f32 v[136:137], v[140:141], v[140:141], v[136:137]
    v_pk_add_f32 v[142:143], v[118:119], v[86:87] op_sel_hi:[1,0] neg_lo:[0,1] neg_hi:[0,1]
    v_pk_fma_f32 v[138:139], v[142:143], v[142:143], v[138:139]
    v_pk_add_f32 v[140:141], v[120:121], v[86:87] op_sel_hi:[1,0] neg_lo:[0,1] neg_hi:[0,1]
    v_pk_fma_f32 v[136:137], v[140:141], v[140:141], v[136:137]
    v_pk_add_f32 v[142:143], v[122:123], v[86:87] op_sel_hi:[1,0] neg_lo:[0,1] neg_hi:[0,1]
    v_pk_fma_f32 v[138:139], v[142:143], v[142:143], v[138:139]
    v_pk_add_f32 v[140:141], v[124:125], v[86:87] op_sel_hi:[1,0] neg_lo:[0,1] neg_hi:[0,1]
    v_pk_fma_f32 v[136:137], v[140:141], v[140:141], v[136:137]
    v_pk_add_f32 v[142:143], v[126:127], v[86:87] op_sel_hi:[1,0] neg_lo:[0,1] neg_hi:[0,1]
    v_pk_fma_f32 v[138:139], v[142:143], v[142:143], v[138:139]
    v_pk_add_f32 v[140:141], v[128:129], v[86:87] op_sel_hi:[1,0] neg_lo:[0,1] neg_hi:[0,1]
    v_pk_fma_f32 v[136:137], v[140:141], v[140:141], v[136:137]
    v_pk_add_f32 v[142:143], v[130:131], v[86:87] op_sel_hi:[1,0] neg_lo:[0,1] neg_hi:[0,1]
    v_pk_fma_f32 v[138:139], v[142:143], v[142:143], v[138:139]
    v_pk_add_f32 v[140:141], v[132:133], v[86:87] op_sel_hi:[1,0] neg_lo:[0,1] neg_hi:[0,1]
    v_pk_fma_f32 v[136:137], v[140:141], v[140:141], v[136:137]
    v_pk_add_f32 v[142:143], v[134:135], v[86:87] op_sel_hi:[1,0] neg_lo:[0,1] neg_hi:[0,1]
    v_pk_fma_f32 v[138:139], v[142:143], v[142:143], v[138:139]
    v_pk_add_f32 v[136:137], v[136:137], v[138:139]
    v_add_f32 v136, v136, v137
    s_nop 1
    v_add_f32 v136, v136, v136 row_ror:8
    s_nop 1
    v_add_f32 v136, v136, v136 row_ror:4
    s_nop 1
    v_add_f32 v136, v136, v136 row_ror:2
    s_nop 1
    v_add_f32 v136, v136, v136 row_ror:1
    v_mul_f32 v136, 0x3acccccd, v136
    v_cvt_pk_bf16_f32 v87, v86, v136
    v_lshlrev_b32 v86, 16, v87
    v_and_b32 v136, 0xffff0000, v87
    v_add_f32 v136, 0x3727c5ac, v136
    v_cvt_pk_bf16_f32 v136, v136, v136
    v_and_b32 v136, 0xffff0000, v136
    v_sqrt_f32 v136, v136
    s_nop 0
    v_cvt_pk_bf16_f32 v136, v136, v136
    v_and_b32 v136, 0xffff0000, v136
    v_rcp_f32 v136, v136
    s_mov_b32 s45, 0
    v_mul_f32 v136, 0x3dd53b95, v136
    v_pk_add_f32 v[96:97], v[96:97], v[86:87] op_sel_hi:[1,0] neg_lo:[0,1] neg_hi:[0,1]
    v_cvt_pk_bf16_f32 v96, v96, v97
    v_and_b32 v97, 0xffff0000, v96
    v_lshlrev_b32 v96, 16, v96
    v_pk_mul_f32 v[96:97], v[96:97], v[136:137] op_sel_hi:[1,0]
    v_cvt_pk_bf16_f32 v144, v96, v97
    v_pk_add_f32 v[98:99], v[98:99], v[86:87] op_sel_hi:[1,0] neg_lo:[0,1] neg_hi:[0,1]
    v_cvt_pk_bf16_f32 v98, v98, v99
    v_and_b32 v99, 0xffff0000, v98
    v_lshlrev_b32 v98, 16, v98
    v_pk_mul_f32 v[98:99], v[98:99], v[136:137] op_sel_hi:[1,0]
    v_cvt_pk_bf16_f32 v145, v98, v99
    v_pk_add_f32 v[100:101], v[100:101], v[86:87] op_sel_hi:[1,0] neg_lo:[0,1] neg_hi:[0,1]
    v_cvt_pk_bf16_f32 v100, v100, v101
    v_and_b32 v101, 0xffff0000, v100
    v_lshlrev_b32 v100, 16, v100
    v_pk_mul_f32 v[100:101], v[100:101], v[136:137] op_sel_hi:[1,0]
    v_cvt_pk_bf16_f32 v146, v100, v101
    v_pk_add_f32 v[102:103], v[102:103], v[86:87] op_sel_hi:[1,0] neg_lo:[0,1] neg_hi:[0,1]
    v_cvt_pk_bf16_f32 v102, v102, v103
    v_and_b32 v103, 0xffff0000, v102
    v_lshlrev_b32 v102, 16, v102
    v_pk_mul_f32 v[102:103], v[102:103], v[136:137] op_sel_hi:[1,0]
    v_cvt_pk_bf16_f32 v147, v102, v103
    buffer_store_dwordx4 v[144:147], v84, s[32:35], s45 offen sc1
    s_add_u32 s45, s45, 4096
    v_pk_add_f32 v[104:105], v[104:105], v[86:87] op_sel_hi:[1,0] neg_lo:[0,1] neg_hi:[0,1]
    v_cvt_pk_bf16_f32 v104, v104, v105
    v_and_b32 v105, 0xffff0000, v104
    v_lshlrev_b32 v104, 16, v104
    v_pk_mul_f32 v[104:105], v[104:105], v[136:137] op_sel_hi:[1,0]
    v_cvt_pk_bf16_f32 v148, v104, v105
    v_pk_add_f32 v[106:107], v[106:107], v[86:87] op_sel_hi:[1,0] neg_lo:[0,1] neg_hi:[0,1]
    v_cvt_pk_bf16_f32 v106, v106, v107
    v_and_b32 v107, 0xffff0000, v106
    v_lshlrev_b32 v106, 16, v106
    v_pk_mul_f32 v[106:107], v[106:107], v[136:137] op_sel_hi:[1,0]
    v_cvt_pk_bf16_f32 v149, v106, v107
    v_pk_add_f32 v[108:109], v[108:109], v[86:87] op_sel_hi:[1,0] neg_lo:[0,1] neg_hi:[0,1]
    v_cvt_pk_bf16_f32 v108, v108, v109
    v_and_b32 v109, 0xffff0000, v108
    v_lshlrev_b32 v108, 16, v108
    v_pk_mul_f32 v[108:109], v[108:109], v[136:137] op_sel_hi:[1,0]
    v_cvt_pk_bf16_f32 v150, v108, v109
    v_pk_add_f32 v[110:111], v[110:111], v[86:87] op_sel_hi:[1,0] neg_lo:[0,1] neg_hi:[0,1]
    v_cvt_pk_bf16_f32 v110, v110, v111
    v_and_b32 v111, 0xffff0000, v110
    v_lshlrev_b32 v110, 16, v110
    v_pk_mul_f32 v[110:111], v[110:111], v[136:137] op_sel_hi:[1,0]
    v_cvt_pk_bf16_f32 v151, v110, v111
    buffer_store_dwordx4 v[148:151], v84, s[32:35], s45 offen sc1
    s_add_u32 s45, s45, 4096
    v_pk_add_f32 v[112:113], v[112:113], v[86:87] op_sel_hi:[1,0] neg_lo:[0,1] neg_hi:[0,1]
    v_cvt_pk_bf16_f32 v112, v112, v113
    v_and_b32 v113, 0xffff0000, v112
    v_lshlrev_b32 v112, 16, v112
    v_pk_mul_f32 v[112:113], v[112:113], v[136:137] op_sel_hi:[1,0]
    v_cvt_pk_bf16_f32 v152, v112, v113
    v_pk_add_f32 v[114:115], v[114:115], v[86:87] op_sel_hi:[1,0] neg_lo:[0,1] neg_hi:[0,1]
    v_cvt_pk_bf16_f32 v114, v114, v115
    v_and_b32 v115, 0xffff0000, v114
    v_lshlrev_b32 v114, 16, v114
    v_pk_mul_f32 v[114:115], v[114:115], v[136:137] op_sel_hi:[1,0]
    v_cvt_pk_bf16_f32 v153, v114, v115
    v_pk_add_f32 v[116:117], v[116:117], v[86:87] op_sel_hi:[1,0] neg_lo:[0,1] neg_hi:[0,1]
    v_cvt_pk_bf16_f32 v116, v116, v117
    v_and_b32 v117, 0xffff0000, v116
    v_lshlrev_b32 v116, 16, v116
    v_pk_mul_f32 v[116:117], v[116:117], v[136:137] op_sel_hi:[1,0]
    v_cvt_pk_bf16_f32 v154, v116, v117
    v_pk_add_f32 v[118:119], v[118:119], v[86:87] op_sel_hi:[1,0] neg_lo:[0,1] neg_hi:[0,1]
    v_cvt_pk_bf16_f32 v118, v118, v119
    v_and_b32 v119, 0xffff0000, v118
    v_lshlrev_b32 v118, 16, v118
    v_pk_mul_f32 v[118:119], v[118:119], v[136:137] op_sel_hi:[1,0]
    v_cvt_pk_bf16_f32 v155, v118, v119
    buffer_store_dwordx4 v[152:155], v84, s[32:35], s45 offen sc1
    s_add_u32 s45, s45, 4096
    v_pk_add_f32 v[120:121], v[120:121], v[86:87] op_sel_hi:[1,0] neg_lo:[0,1] neg_hi:[0,1]
    v_cvt_pk_bf16_f32 v120, v120, v121
    v_and_b32 v121, 0xffff0000, v120
    v_lshlrev_b32 v120, 16, v120
    v_pk_mul_f32 v[120:121], v[120:121], v[136:137] op_sel_hi:[1,0]
    v_cvt_pk_bf16_f32 v156, v120, v121
    v_pk_add_f32 v[122:123], v[122:123], v[86:87] op_sel_hi:[1,0] neg_lo:[0,1] neg_hi:[0,1]
    v_cvt_pk_bf16_f32 v122, v122, v123
    v_and_b32 v123, 0xffff0000, v122
    v_lshlrev_b32 v122, 16, v122
    v_pk_mul_f32 v[122:123], v[122:123], v[136:137] op_sel_hi:[1,0]
    v_cvt_pk_bf16_f32 v157, v122, v123
    v_pk_add_f32 v[124:125], v[124:125], v[86:87] op_sel_hi:[1,0] neg_lo:[0,1] neg_hi:[0,1]
    v_cvt_pk_bf16_f32 v124, v124, v125
    v_and_b32 v125, 0xffff0000, v124
    v_lshlrev_b32 v124, 16, v124
    v_pk_mul_f32 v[124:125], v[124:125], v[136:137] op_sel_hi:[1,0]
    v_cvt_pk_bf16_f32 v158, v124, v125
    v_pk_add_f32 v[126:127], v[126:127], v[86:87] op_sel_hi:[1,0] neg_lo:[0,1] neg_hi:[0,1]
    v_cvt_pk_bf16_f32 v126, v126, v127
    v_and_b32 v127, 0xffff0000, v126
    v_lshlrev_b32 v126, 16, v126
    v_pk_mul_f32 v[126:127], v[126:127], v[136:137] op_sel_hi:[1,0]
    v_cvt_pk_bf16_f32 v159, v126, v127
    buffer_store_dwordx4 v[156:159], v84, s[32:35], s45 offen sc1
    s_add_u32 s45, s45, 4096
    v_pk_add_f32 v[128:129], v[128:129], v[86:87] op_sel_hi:[1,0] neg_lo:[0,1] neg_hi:[0,1]
    v_cvt_pk_bf16_f32 v128, v128, v129
    v_and_b32 v129, 0xffff0000, v128
    v_lshlrev_b32 v128, 16, v128
    v_pk_mul_f32 v[128:129], v[128:129], v[136:137] op_sel_hi:[1,0]
    v_cvt_pk_bf16_f32 v160, v128, v129
    v_pk_add_f32 v[130:131], v[130:131], v[86:87] op_sel_hi:[1,0] neg_lo:[0,1] neg_hi:[0,1]
    v_cvt_pk_bf16_f32 v130, v130, v131
    v_and_b32 v131, 0xffff0000, v130
    v_lshlrev_b32 v130, 16, v130
    v_pk_mul_f32 v[130:131], v[130:131], v[136:137] op_sel_hi:[1,0]
    v_cvt_pk_bf16_f32 v161, v130, v131
    v_pk_add_f32 v[132:133], v[132:133], v[86:87] op_sel_hi:[1,0] neg_lo:[0,1] neg_hi:[0,1]
    v_cvt_pk_bf16_f32 v132, v132, v133
    v_and_b32 v133, 0xffff0000, v132
    v_lshlrev_b32 v132, 16, v132
    v_pk_mul_f32 v[132:133], v[132:133], v[136:137] op_sel_hi:[1,0]
    v_cvt_pk_bf16_f32 v162, v132, v133
    v_pk_add_f32 v[134:135], v[134:135], v[86:87] op_sel_hi:[1,0] neg_lo:[0,1] neg_hi:[0,1]
    v_cvt_pk_bf16_f32 v134, v134, v135
    v_and_b32 v135, 0xffff0000, v134
    v_lshlrev_b32 v134, 16, v134
    v_pk_mul_f32 v[134:135], v[134:135], v[136:137] op_sel_hi:[1,0]
    v_cvt_pk_bf16_f32 v163, v134, v135
    buffer_store_dwordx4 v[160:163], v84, s[32:35], s45 offen sc1
    s_add_u32 s45, s45, 4096
    s_lshl_b32 s45, s37, 5
    s_add_u32 s45, s45, s36
    s_lshl_b32 s45, s45, 1
    s_add_u32 s45, s45, s38
    s_lshl_b32 s45, s45, 7
    s_add_u32 s45, s45, 295040
    s_waitcnt lgkmcnt(0)
    s_add_u32 s100, s100, 1
    v_mov_b32 v37, s100
    s_waitcnt vmcnt(0)
    s_mov_b32 exec_hi, 0
    buffer_store_dword v37, v62, s[92:95], s45 offen sc1
    s_mov_b32 exec_hi, -1
L_setup:
    s_add_u32 s46, s37, 1
    s_mul_i32 s46, s46, 327680
    s_mov_b32 s4, s80
    s_mov_b32 s5, s81
    s_mov_b32 s6, s46
    s_mov_b32 s7, 0x00020000
    s_add_u32 s88, s80, 50331648
    s_addc_u32 s89, s81, 0
    s_mov_b32 s90, 9830400
    s_mov_b32 s91, 0x00020000
    s_add_u32 s24, s80, 4194304
    s_addc_u32 s25, s81, 0
    s_mov_b32 s26, 6291456
    s_mov_b32 s27, 0x00020000
    s_mul_i32 s45, s36, 786432
    s_add_u32 s16, s60, s45
    s_addc_u32 s17, s61, 0
    s_mov_b32 s18, 0
    s_mov_b32 s19, 0x00020000
    s_add_u32 s20, s62, s45
    s_addc_u32 s21, s63, 0
    s_mov_b32 s22, 786432
    s_mov_b32 s23, 0x00020000
    s_mov_b32 s34, 1966080
    s_cmp_lt_u32 s2, 192
    s_cselect_b32 s32, s66, s72
    s_cselect_b32 s33, s67, s73
    s_cselect_b32 s34, 7864320, s34
    s_cselect_b32 s45, 0, 192
    s_sub_u32 s45, s2, s45
    s_mul_i32 s96, s45, 40960
    s_mul_i32 s97, s2, 40960
    s_lshl_b32 s45, s38, 10
    s_add_u32 s97, s97, s45
    v_mov_b32 v37, s100
    s_and_b32 s45, s38, 1
    s_lshl_b32 s45, s45, 2
    v_mul_u32_u24 v33, 384, v27
    v_add_u32 v33, s48, v33
    v_lshrrev_b32 v34, 1, v27
    v_add_u32 v35, s45, v34
    v_xor_b32 v35, v35, v26
    v_lshl_add_u32 v18, v35, 4, v33
    v_lshlrev_b32 v35, 1, v34
    v_xor_b32 v35, v35, v26
    v_lshl_add_u32 v19, v35, 4, v33
    v_mul_u32_u24 v33, 1280, v32
    v_lshl_add_u32 v32, v35, 4, v33
    s_lshl_b32 s45, s37, 3
    v_add_u32 v52, s45, v26
    v_mul_u32_u24 v53, 3072, v52
    v_lshlrev_b32 v52, 2, v53
    s_lshl_b32 s45, s38, 7
    v_add_u32 v52, s45, v52
    v_and_b32 v54, 1, v27
    v_mul_u32_u24 v54, 124, v54
    v_add_u32 v53, v54, v53
    s_mov_b32 s31, 0x00020000
    s_cmp_eq_u32 s38, 3
    s_cselect_b32 s28, s12, s8
    s_cselect_b32 s29, s13, s9
    s_cselect_b32 s30, s14, s10
    s_cselect_b64 vcc, -1, 0
    s_mov_b32 s101, 786432
    s_cselect_b32 s101, 196608, s101
    v_cndmask_b32 v46, v52, v53, vcc
    s_cselect_b32 s39, s16, s20
    s_cselect_b32 s59, s17, s21
    s_mov_b32 s3, 2048
    s_cselect_b32 s3, 1024, s3
    s_mul_i32 s45, s37, 48
    s_mul_i32 s46, s38, 5
    s_add_u32 s45, s45, s46
    v_min_u32 v52, 5, v26
    v_add_u32 v52, s45, v52
    s_mul_i32 s45, s37, 24
    s_add_u32 s45, s45, 384
    v_add_u32 v53, s45, v26
    v_cndmask_b32 v60, v52, v53, vcc
    v_lshlrev_b32 v60, 7, v60
    s_lshl_b32 s58, s101, 2
    s_mov_b32 s49, 0
    s_mov_b32 s50, 0
    s_add_u32 s56, s48, 147456
    s_add_u32 s57, s48, 0
    s_lshl_b32 s45, s37, 4
    s_lshl_b32 s46, s38, 2
    s_add_u32 s45, s45, s46
    s_mul_i32 s45, s45, 20480
    v_lshlrev_b32 v33, 8, v29
    v_lshl_add_u32 v33, v28, 6, v33
    v_lshl_add_u32 v33, v30, 4, v33
    v_add_u32 v22, s45, v33
    v_add_u32 v23, 20480, v22
    v_add_u32 v24, 40960, v22
    v_add_u32 v25, 61440, v22
    s_mov_b32 s42, 1572864
    s_mov_b32 s43, 1966080
    s_mov_b32 s54, 393216
    s_mov_b32 s55, 491520
    s_mov_b32 s40, 49152
    s_mov_b32 s52, 0
    s_add_u32 s41, s48, 24576
    s_add_u32 s53, s53, 16384
    v_mul_u32_u24 v33, 3072, v28
    v_lshl_add_u32 v33, v29, 7, v33
    v_add_u32 v33, 73728, v33
    v_lshrrev_b32 v34, 1, v29
    v_lshlrev_b32 v35, 2, v34
    v_xor_b32 v35, v35, v30
    v_lshl_add_u32 v12, v35, 4, v33
    v_xor_b32 v13, 64, v12
    v_add_u32 v6, 49152, v12
    v_add_u32 v7, 49152, v13
    v_lshlrev_b32 v33, 10, v28
    v_lshl_add_u32 v33, v29, 7, v33
    v_add_u32 v33, 49152, v33
    v_and_b32 v35, 1, v30
    v_lshl_add_u32 v33, v35, 3, v33
    v_lshrrev_b32 v35, 1, v30
    v_lshl_add_u32 v33, v35, 4, v33
    v_and_b32 v35, 1, v28
    v_lshl_add_u32 v35, v35, 1, v34
    v_lshl_add_u32 v14, v35, 5, v33
    v_xor_b32 v15, 32, v14
    v_xor_b32 v16, 64, v14
    v_mov_b32 v8, v14
    v_mov_b32 v9, v15
    v_mov_b32 v10, v16
    v_mov_b32 v48, 0
    v_mov_b32 v49, 0
    v_mov_b32 v50, 0
    v_mov_b32 v51, 0
    s_cmp_eq_u32 s51, 0
    s_cbranch_scc1 L_nw
    s_waitcnt vmcnt(0)
L_nw:
    v_mfma_f32_32x32x16_bf16 v[64:79], v[48:51], v[48:51], 0
    v_mfma_f32_32x32x16_bf16 v[80:95], v[48:51], v[48:51], 0
    v_mfma_f32_32x32x16_bf16 v[96:111], v[48:51], v[48:51], 0
    v_mfma_f32_32x32x16_bf16 v[112:127], v[48:51], v[48:51], 0
    v_mfma_f32_32x32x16_bf16 v[128:143], v[48:51], v[48:51], 0
    v_mfma_f32_32x32x16_bf16 v[144:159], v[48:51], v[48:51], 0
    v_mfma_f32_32x32x16_bf16 v[160:175], v[48:51], v[48:51], 0
    v_mfma_f32_32x32x16_bf16 v[176:191], v[48:51], v[48:51], 0
    v_mfma_f32_32x32x16_bf16 v[192:207], v[48:51], v[48:51], 0
    v_mfma_f32_32x32x16_bf16 v[208:223], v[48:51], v[48:51], 0
    v_mfma_f32_32x32x16_bf16 v[224:239], v[48:51], v[48:51], 0
    v_mfma_f32_32x32x16_bf16 v[240:255], v[48:51], v[48:51], 0
    v_lshlrev_b32 v52, 16, v40
    v_and_b32 v53, 0xffff0000, v40
    v_lshlrev_b32 v54, 16, v41
    v_and_b32 v55, 0xffff0000, v41
    v_mul_f32 v52, 0x3dd53b95, v52
    v_mul_f32 v53, 0x3dd53b95, v53
    v_mul_f32 v54, 0x3dd53b95, v54
    v_mul_f32 v55, 0x3dd53b95, v55
    v_accvgpr_write_b32 a0, v52
    v_accvgpr_write_b32 a1, v53
    v_accvgpr_write_b32 a2, v54
    v_accvgpr_write_b32 a3, v55
    v_accvgpr_write_b32 a4, v52
    v_accvgpr_write_b32 a5, v53
    v_accvgpr_write_b32 a6, v54
    v_accvgpr_write_b32 a7, v55
    v_accvgpr_write_b32 a8, v52
    v_accvgpr_write_b32 a9, v53
    v_accvgpr_write_b32 a10, v54
    v_accvgpr_write_b32 a11, v55
    v_accvgpr_write_b32 a12, v52
    v_accvgpr_write_b32 a13, v53
    v_accvgpr_write_b32 a14, v54
    v_accvgpr_write_b32 a15, v55
    v_lshlrev_b32 v52, 16, v42
    v_and_b32 v53, 0xffff0000, v42
    v_lshlrev_b32 v54, 16, v43
    v_and_b32 v55, 0xffff0000, v43
    v_mul_f32 v52, 0x3dd53b95, v52
    v_mul_f32 v53, 0x3dd53b95, v53
    v_mul_f32 v54, 0x3dd53b95, v54
    v_mul_f32 v55, 0x3dd53b95, v55
    v_accvgpr_write_b32 a16, v52
    v_accvgpr_write_b32 a17, v53
    v_accvgpr_write_b32 a18, v54
    v_accvgpr_write_b32 a19, v55
    v_accvgpr_write_b32 a20, v52
    v_accvgpr_write_b32 a21, v53
    v_accvgpr_write_b32 a22, v54
    v_accvgpr_write_b32 a23, v55
    v_accvgpr_write_b32 a24, v52
    v_accvgpr_write_b32 a25, v53
    v_accvgpr_write_b32 a26, v54
    v_accvgpr_write_b32 a27, v55
    v_accvgpr_write_b32 a28, v52
    v_accvgpr_write_b32 a29, v53
    v_accvgpr_write_b32 a30, v54
    v_accvgpr_write_b32 a31, v55
    v_lshlrev_b32 v52, 16, v44
    v_and_b32 v53, 0xffff0000, v44
    v_lshlrev_b32 v54, 16, v45
    v_and_b32 v55, 0xffff0000, v45
    v_mul_f32 v52, 0x3dd53b95, v52
    v_mul_f32 v53, 0x3dd53b95, v53
    v_mul_f32 v54, 0x3dd53b95, v54
    v_mul_f32 v55, 0x3dd53b95, v55
    v_accvgpr_write_b32 a32, v52
    v_accvgpr_write_b32 a33, v53
    v_accvgpr_write_b32 a34, v54
    v_accvgpr_write_b32 a35, v55
    v_accvgpr_write_b32 a36, v52
    v_accvgpr_write_b32 a37, v53
    v_accvgpr_write_b32 a38, v54
    v_accvgpr_write_b32 a39, v55
    v_accvgpr_write_b32 a40, v52
    v_accvgpr_write_b32 a41, v53
    v_accvgpr_write_b32 a42, v54
    v_accvgpr_write_b32 a43, v55
    v_accvgpr_write_b32 a44, v52
    v_accvgpr_write_b32 a45, v53
    v_accvgpr_write_b32 a46, v54
    v_accvgpr_write_b32 a47, v55
    s_cmp_lg_u32 s51, 0
    s_cbranch_scc1 L_p1go
    s_lshl_b32 s45, s37, 13
    s_lshl_b32 s46, s38, 11
    s_add_u32 s45, s45, s46
    s_add_u32 s45, s45, 295040
    v_and_b32 v53, 1920, v63
L_poll1:
    buffer_load_dword v52, v53, s[92:95], s45 offen sc1
    s_waitcnt vmcnt(0)
    v_cmp_ne_u32 vcc, v52, v37
    s_cbranch_vccnz L_poll1
L_p1go:
    buffer_load_dwordx4 a[88:91], v22, s[4:7], 0 offen offset:0 sc1
    buffer_load_dwordx4 a[92:95], v23, s[4:7], 0 offen offset:0 sc1
    buffer_load_dwordx4 a[96:99], v24, s[4:7], 0 offen offset:0 sc1
    buffer_load_dwordx4 a[100:103], v25, s[4:7], 0 offen offset:0 sc1
    buffer_load_dwordx4 a[104:107], v22, s[4:7], 0 offen offset:1024 sc1
    buffer_load_dwordx4 a[108:111], v23, s[4:7], 0 offen offset:1024 sc1
    buffer_load_dwordx4 a[112:115], v24, s[4:7], 0 offen offset:1024 sc1
    buffer_load_dwordx4 a[116:119], v25, s[4:7], 0 offen offset:1024 sc1
    s_barrier
    ds_read_b64_tr_b16 a[48:49], v6 offset:0
    ds_read_b64_tr_b16 a[50:51], v6 offset:512
    ds_read_b64_tr_b16 a[52:53], v6 offset:12288
    ds_read_b64_tr_b16 a[54:55], v6 offset:12800
    ds_read_b64_tr_b16 a[56:57], v6 offset:8
    ds_read_b64_tr_b16 a[58:59], v6 offset:520
    ds_read_b64_tr_b16 a[60:61], v6 offset:12296
    ds_read_b64_tr_b16 a[62:63], v6 offset:12808
    s_mov_b32 s47, 2048
    s_mov_b32 s44, 5
    s_waitcnt vmcnt(0) lgkmcnt(4)
.p2align 6
L_p1_loop:
    v_mfma_f32_16x16x32_bf16 v[64:67], a[48:51], a[88:91], v[64:67]
    ds_read_b64_tr_b16 a[64:65], v7 offset:0
    v_mfma_f32_16x16x32_bf16 v[64:67], a[52:55], a[104:107], v[64:67]
    ds_read_b64_tr_b16 a[66:67], v7 offset:512
    v_mfma_f32_16x16x32_bf16 v[72:75], a[48:51], a[92:95], v[72:75]
    ds_read_b64_tr_b16 a[68:69], v7 offset:12288
    v_mfma_f32_16x16x32_bf16 v[72:75], a[52:55], a[108:111], v[72:75]
    ds_read_b64_tr_b16 a[70:71], v7 offset:12800
    v_mfma_f32_16x16x32_bf16 v[80:83], a[48:51], a[96:99], v[80:83]
    ds_read_b64_tr_b16 a[72:73], v7 offset:8
    v_mfma_f32_16x16x32_bf16 v[80:83], a[52:55], a[112:115], v[80:83]
    ds_read_b64_tr_b16 a[74:75], v7 offset:520
    v_mfma_f32_16x16x32_bf16 v[88:91], a[48:51], a[100:103], v[88:91]
    buffer_load_dwordx4 a[120:123], v22, s[4:7], s47 offen offset:0 sc1
    v_mfma_f32_16x16x32_bf16 v[88:91], a[52:55], a[116:119], v[88:91]
    s_waitcnt lgkmcnt(6)
    v_mfma_f32_16x16x32_bf16 v[68:71], a[56:59], a[88:91], v[68:71]
    ds_read_b64_tr_b16 a[76:77], v7 offset:12296
    v_mfma_f32_16x16x32_bf16 v[68:71], a[60:63], a[104:107], v[68:71]
    ds_read_b64_tr_b16 a[78:79], v7 offset:12808
    v_mfma_f32_16x16x32_bf16 v[76:79], a[56:59], a[92:95], v[76:79]
    ds_read_b64_tr_b16 a[80:81], v6 offset:1024
    v_mfma_f32_16x16x32_bf16 v[76:79], a[60:63], a[108:111], v[76:79]
    ds_read_b64_tr_b16 a[82:83], v6 offset:1536
    v_mfma_f32_16x16x32_bf16 v[84:87], a[56:59], a[96:99], v[84:87]
    ds_read_b64_tr_b16 a[84:85], v6 offset:13312
    v_mfma_f32_16x16x32_bf16 v[84:87], a[60:63], a[112:115], v[84:87]
    ds_read_b64_tr_b16 a[86:87], v6 offset:13824
    v_mfma_f32_16x16x32_bf16 v[92:95], a[56:59], a[100:103], v[92:95]
    buffer_load_dwordx4 a[124:127], v23, s[4:7], s47 offen offset:0 sc1
    v_mfma_f32_16x16x32_bf16 v[92:95], a[60:63], a[116:119], v[92:95]
    s_waitcnt lgkmcnt(8)
    v_mfma_f32_16x16x32_bf16 v[96:99], a[64:67], a[88:91], v[96:99]
    ds_read_b64_tr_b16 a[48:49], v6 offset:1032
    v_mfma_f32_16x16x32_bf16 v[96:99], a[68:71], a[104:107], v[96:99]
    ds_read_b64_tr_b16 a[50:51], v6 offset:1544
    v_mfma_f32_16x16x32_bf16 v[104:107], a[64:67], a[92:95], v[104:107]
    ds_read_b64_tr_b16 a[52:53], v6 offset:13320
    v_mfma_f32_16x16x32_bf16 v[104:107], a[68:71], a[108:111], v[104:107]
    ds_read_b64_tr_b16 a[54:55], v6 offset:13832
    v_mfma_f32_16x16x32_bf16 v[112:115], a[64:67], a[96:99], v[112:115]
    ds_read_b64_tr_b16 a[56:57], v7 offset:1024
    v_mfma_f32_16x16x32_bf16 v[112:115], a[68:71], a[112:115], v[112:115]
    ds_read_b64_tr_b16 a[58:59], v7 offset:1536
    v_mfma_f32_16x16x32_bf16 v[120:123], a[64:67], a[100:103], v[120:123]
    buffer_load_dwordx4 a[128:131], v24, s[4:7], s47 offen offset:0 sc1
    v_mfma_f32_16x16x32_bf16 v[120:123], a[68:71], a[116:119], v[120:123]
    s_waitcnt lgkmcnt(10)
    v_mfma_f32_16x16x32_bf16 v[100:103], a[72:75], a[88:91], v[100:103]
    ds_read_b64_tr_b16 a[60:61], v7 offset:13312
    v_mfma_f32_16x16x32_bf16 v[100:103], a[76:79], a[104:107], v[100:103]
    ds_read_b64_tr_b16 a[62:63], v7 offset:13824
    v_mfma_f32_16x16x32_bf16 v[108:111], a[72:75], a[92:95], v[108:111]
    ds_read_b64_tr_b16 a[64:65], v7 offset:1032
    v_mfma_f32_16x16x32_bf16 v[108:111], a[76:79], a[108:111], v[108:111]
    ds_read_b64_tr_b16 a[66:67], v7 offset:1544
    v_mfma_f32_16x16x32_bf16 v[116:119], a[72:75], a[96:99], v[116:119]
    ds_read_b64_tr_b16 a[68:69], v7 offset:13320
    v_mfma_f32_16x16x32_bf16 v[116:119], a[76:79], a[112:115], v[116:119]
    ds_read_b64_tr_b16 a[70:71], v7 offset:13832
    v_mfma_f32_16x16x32_bf16 v[124:127], a[72:75], a[100:103], v[124:127]
    buffer_load_dwordx4 a[132:135], v25, s[4:7], s47 offen offset:0 sc1
    v_mfma_f32_16x16x32_bf16 v[124:127], a[76:79], a[116:119], v[124:127]
    s_waitcnt lgkmcnt(12)
    v_mfma_f32_16x16x32_bf16 v[128:131], a[80:83], a[88:91], v[128:131]
    ds_read_b64_tr_b16 a[72:73], v6 offset:2048
    v_mfma_f32_16x16x32_bf16 v[128:131], a[84:87], a[104:107], v[128:131]
    ds_read_b64_tr_b16 a[74:75], v6 offset:2560
    v_mfma_f32_16x16x32_bf16 v[136:139], a[80:83], a[92:95], v[136:139]
    ds_read_b64_tr_b16 a[76:77], v6 offset:14336
    v_mfma_f32_16x16x32_bf16 v[136:139], a[84:87], a[108:111], v[136:139]
    ds_read_b64_tr_b16 a[78:79], v6 offset:14848
    v_mfma_f32_16x16x32_bf16 v[144:147], a[80:83], a[96:99], v[144:147]
    s_add_u32 m0, s41, 73728
    v_mfma_f32_16x16x32_bf16 v[144:147], a[84:87], a[112:115], v[144:147]
    buffer_load_dwordx4 v20, s[8:11], s42 offen offset:0 lds
    v_mfma_f32_16x16x32_bf16 v[152:155], a[80:83], a[100:103], v[152:155]
    buffer_load_dwordx4 a[136:139], v22, s[4:7], s47 offen offset:1024 sc1
    v_mfma_f32_16x16x32_bf16 v[152:155], a[84:87], a[116:119], v[152:155]
    s_waitcnt lgkmcnt(12)
    v_mfma_f32_16x16x32_bf16 v[132:135], a[48:51], a[88:91], v[132:135]
    ds_read_b64_tr_b16 a[80:81], v6 offset:2056
    v_mfma_f32_16x16x32_bf16 v[132:135], a[52:55], a[104:107], v[132:135]
    ds_read_b64_tr_b16 a[82:83], v6 offset:2568
    v_mfma_f32_16x16x32_bf16 v[140:143], a[48:51], a[92:95], v[140:143]
    ds_read_b64_tr_b16 a[84:85], v6 offset:14344
    v_mfma_f32_16x16x32_bf16 v[140:143], a[52:55], a[108:111], v[140:143]
    ds_read_b64_tr_b16 a[86:87], v6 offset:14856
    v_mfma_f32_16x16x32_bf16 v[148:151], a[48:51], a[96:99], v[148:151]
    s_add_u32 m0, s41, 74624
    v_mfma_f32_16x16x32_bf16 v[148:151], a[52:55], a[112:115], v[148:151]
    buffer_load_dwordx4 v20, s[8:11], s42 offen offset:128 lds
    v_mfma_f32_16x16x32_bf16 v[156:159], a[48:51], a[100:103], v[156:159]
    buffer_load_dwordx4 a[140:143], v23, s[4:7], s47 offen offset:1024 sc1
    v_mfma_f32_16x16x32_bf16 v[156:159], a[52:55], a[116:119], v[156:159]
    s_waitcnt lgkmcnt(12)
    v_mfma_f32_16x16x32_bf16 v[160:163], a[56:59], a[88:91], v[160:163]
    ds_read_b64_tr_b16 a[48:49], v7 offset:2048
    v_mfma_f32_16x16x32_bf16 v[160:163], a[60:63], a[104:107], v[160:163]
    ds_read_b64_tr_b16 a[50:51], v7 offset:2560
    v_mfma_f32_16x16x32_bf16 v[168:171], a[56:59], a[92:95], v[168:171]
    ds_read_b64_tr_b16 a[52:53], v7 offset:14336
    v_mfma_f32_16x16x32_bf16 v[168:171], a[60:63], a[108:111], v[168:171]
    ds_read_b64_tr_b16 a[54:55], v7 offset:14848
    v_mfma_f32_16x16x32_bf16 v[176:179], a[56:59], a[96:99], v[176:179]
    s_add_u32 m0, s41, 75520
    v_mfma_f32_16x16x32_bf16 v[176:179], a[60:63], a[112:115], v[176:179]
    buffer_load_dwordx4 v20, s[8:11], s42 offen offset:256 lds
    v_mfma_f32_16x16x32_bf16 v[184:187], a[56:59], a[100:103], v[184:187]
    buffer_load_dwordx4 a[144:147], v24, s[4:7], s47 offen offset:1024 sc1
    v_mfma_f32_16x16x32_bf16 v[184:187], a[60:63], a[116:119], v[184:187]
    s_waitcnt lgkmcnt(12)
    v_mfma_f32_16x16x32_bf16 v[164:167], a[64:67], a[88:91], v[164:167]
    ds_read_b64_tr_b16 a[56:57], v7 offset:2056
    v_mfma_f32_16x16x32_bf16 v[164:167], a[68:71], a[104:107], v[164:167]
    ds_read_b64_tr_b16 a[58:59], v7 offset:2568
    v_mfma_f32_16x16x32_bf16 v[172:175], a[64:67], a[92:95], v[172:175]
    ds_read_b64_tr_b16 a[60:61], v7 offset:14344
    v_mfma_f32_16x16x32_bf16 v[172:175], a[68:71], a[108:111], v[172:175]
    ds_read_b64_tr_b16 a[62:63], v7 offset:14856
    v_mfma_f32_16x16x32_bf16 v[180:183], a[64:67], a[96:99], v[180:183]
    s_add_u32 m0, s41, 86016
    v_mfma_f32_16x16x32_bf16 v[180:183], a[68:71], a[112:115], v[180:183]
    buffer_load_dwordx4 v20, s[8:11], s43 offen offset:0 lds
    v_mfma_f32_16x16x32_bf16 v[188:191], a[64:67], a[100:103], v[188:191]
    buffer_load_dwordx4 a[148:151], v25, s[4:7], s47 offen offset:1024 sc1
    v_mfma_f32_16x16x32_bf16 v[188:191], a[68:71], a[116:119], v[188:191]
    s_waitcnt lgkmcnt(12)
    v_mfma_f32_16x16x32_bf16 v[192:195], a[72:75], a[88:91], v[192:195]
    ds_read_b64_tr_b16 a[64:65], v8 offset:0
    v_mfma_f32_16x16x32_bf16 v[192:195], a[76:79], a[104:107], v[192:195]
    ds_read_b64_tr_b16 a[66:67], v8 offset:512
    v_mfma_f32_16x16x32_bf16 v[200:203], a[72:75], a[92:95], v[200:203]
    ds_read_b64_tr_b16 a[68:69], v8 offset:4096
    v_mfma_f32_16x16x32_bf16 v[200:203], a[76:79], a[108:111], v[200:203]
    ds_read_b64_tr_b16 a[70:71], v8 offset:4608
    v_mfma_f32_16x16x32_bf16 v[208:211], a[72:75], a[96:99], v[208:211]
    s_add_u32 m0, s41, 86912
    v_mfma_f32_16x16x32_bf16 v[208:211], a[76:79], a[112:115], v[208:211]
    buffer_load_dwordx4 v20, s[8:11], s43 offen offset:128 lds
    v_mfma_f32_16x16x32_bf16 v[216:219], a[72:75], a[100:103], v[216:219]
    s_add_u32 s42, s42, 786432
    v_mfma_f32_16x16x32_bf16 v[216:219], a[76:79], a[116:119], v[216:219]
    s_waitcnt lgkmcnt(12)
    v_mfma_f32_16x16x32_bf16 v[196:199], a[80:83], a[88:91], v[196:199]
    ds_read_b64_tr_b16 a[72:73], v9 offset:0
    v_mfma_f32_16x16x32_bf16 v[196:199], a[84:87], a[104:107], v[196:199]
    ds_read_b64_tr_b16 a[74:75], v9 offset:512
    v_mfma_f32_16x16x32_bf16 v[204:207], a[80:83], a[92:95], v[204:207]
    ds_read_b64_tr_b16 a[76:77], v9 offset:4096
    v_mfma_f32_16x16x32_bf16 v[204:207], a[84:87], a[108:111], v[204:207]
    ds_read_b64_tr_b16 a[78:79], v9 offset:4608
    v_mfma_f32_16x16x32_bf16 v[212:215], a[80:83], a[96:99], v[212:215]
    s_add_u32 m0, s41, 87808
    v_mfma_f32_16x16x32_bf16 v[212:215], a[84:87], a[112:115], v[212:215]
    buffer_load_dwordx4 v20, s[8:11], s43 offen offset:256 lds
    v_mfma_f32_16x16x32_bf16 v[220:223], a[80:83], a[100:103], v[220:223]
    s_mov_b32 s46, s40
    s_add_u32 s40, s40, 24576
    s_add_u32 s47, s47, 2048
    v_mfma_f32_16x16x32_bf16 v[220:223], a[84:87], a[116:119], v[220:223]
    s_waitcnt lgkmcnt(12)
    v_mfma_f32_16x16x32_bf16 v[224:227], a[48:51], a[88:91], v[224:227]
    ds_read_b64_tr_b16 a[80:81], v10 offset:0
    v_mfma_f32_16x16x32_bf16 v[224:227], a[52:55], a[104:107], v[224:227]
    ds_read_b64_tr_b16 a[82:83], v10 offset:512
    v_mfma_f32_16x16x32_bf16 v[232:235], a[48:51], a[92:95], v[232:235]
    ds_read_b64_tr_b16 a[84:85], v10 offset:4096
    v_mfma_f32_16x16x32_bf16 v[232:235], a[52:55], a[108:111], v[232:235]
    ds_read_b64_tr_b16 a[86:87], v10 offset:4608
    v_mfma_f32_16x16x32_bf16 v[240:243], a[48:51], a[96:99], v[240:243]
    s_add_u32 m0, s53, 49152
    v_mfma_f32_16x16x32_bf16 v[240:243], a[52:55], a[112:115], v[240:243]
    buffer_load_dwordx4 v21, s[12:15], s54 offen lds
    v_mfma_f32_16x16x32_bf16 v[248:251], a[48:51], a[100:103], v[248:251]
    s_cmp_eq_u32 s40, 73728
    s_cselect_b32 s40, 0, s40
    s_add_u32 s41, s46, s48
    v_mfma_f32_16x16x32_bf16 v[248:251], a[52:55], a[116:119], v[248:251]
    s_waitcnt lgkmcnt(12)
    v_mfma_f32_16x16x32_bf16 v[228:231], a[56:59], a[88:91], v[228:231]
    s_add_u32 m0, s53, 53248
    v_mfma_f32_16x16x32_bf16 v[228:231], a[60:63], a[104:107], v[228:231]
    buffer_load_dwordx4 v21, s[12:15], s55 offen lds
    v_mfma_f32_16x16x32_bf16 v[236:239], a[56:59], a[92:95], v[236:239]
    s_add_u32 m0, s56, 0
    v_mfma_f32_16x16x32_bf16 v[236:239], a[60:63], a[108:111], v[236:239]
    buffer_load_dwordx4 v18, s[16:19], s49 offen offset:0 lds
    v_mfma_f32_16x16x32_bf16 v[244:247], a[56:59], a[96:99], v[244:247]
    s_add_u32 m0, s56, 896
    v_mfma_f32_16x16x32_bf16 v[244:247], a[60:63], a[112:115], v[244:247]
    buffer_load_dwordx4 v18, s[16:19], s49 offen offset:128 lds
    v_mfma_f32_16x16x32_bf16 v[252:255], a[56:59], a[100:103], v[252:255]
    s_lshl_b32 s45, s38, 10
    s_add_u32 s53, s52, s45
    s_add_u32 s52, s52, 8192
    v_mfma_f32_16x16x32_bf16 v[252:255], a[60:63], a[116:119], v[252:255]
    s_waitcnt lgkmcnt(8)
    v_mfma_f32_16x16x32_bf16 a[0:3], a[64:67], a[88:91], a[0:3]
    s_add_u32 m0, s56, 1792
    v_mfma_f32_16x16x32_bf16 a[0:3], a[68:71], a[104:107], a[0:3]
    buffer_load_dwordx4 v18, s[16:19], s49 offen offset:256 lds
    v_mfma_f32_16x16x32_bf16 a[4:7], a[64:67], a[92:95], a[4:7]
    s_cmp_eq_u32 s52, 24576
    s_cselect_b32 s52, 0, s52
    v_mfma_f32_16x16x32_bf16 a[4:7], a[68:71], a[108:111], a[4:7]
    v_add_u32 v6, s40, v12
    v_add_u32 v7, s40, v13
    v_mfma_f32_16x16x32_bf16 a[8:11], a[64:67], a[96:99], a[8:11]
    s_waitcnt vmcnt(16) lgkmcnt(0)
    v_add_u32 v10, s52, v16
    v_mfma_f32_16x16x32_bf16 a[8:11], a[68:71], a[112:115], a[8:11]
    s_barrier
    v_mfma_f32_16x16x32_bf16 a[12:15], a[64:67], a[100:103], a[12:15]
    buffer_load_dword v47, v46, s[28:31], s58 offen
    v_mfma_f32_16x16x32_bf16 a[12:15], a[68:71], a[116:119], a[12:15]
    s_add_u32 s43, s43, 786432
    v_add_u32 v8, s52, v14
    v_add_u32 v9, s52, v15
    v_mfma_f32_16x16x32_bf16 a[16:19], a[72:75], a[88:91], a[16:19]
    ds_read_b64_tr_b16 a[48:49], v6 offset:0
    v_mfma_f32_16x16x32_bf16 a[16:19], a[76:79], a[104:107], a[16:19]
    ds_read_b64_tr_b16 a[50:51], v6 offset:512
    v_mfma_f32_16x16x32_bf16 a[20:23], a[72:75], a[92:95], a[20:23]
    ds_read_b64_tr_b16 a[52:53], v6 offset:12288
    v_mfma_f32_16x16x32_bf16 a[20:23], a[76:79], a[108:111], a[20:23]
    ds_read_b64_tr_b16 a[54:55], v6 offset:12800
    v_mfma_f32_16x16x32_bf16 a[24:27], a[72:75], a[96:99], a[24:27]
    s_mov_b32 s49, s50
    s_add_u32 s50, s50, 12288
    v_mfma_f32_16x16x32_bf16 a[24:27], a[76:79], a[112:115], a[24:27]
    s_mov_b32 s56, s57
    s_add_u32 s57, s57, 12288
    s_mov_b32 s18, 786432
    v_mfma_f32_16x16x32_bf16 a[28:31], a[72:75], a[100:103], a[28:31]
    v_mfma_f32_16x16x32_bf16 a[28:31], a[76:79], a[116:119], a[28:31]
    s_add_u32 s58, s58, s101
    v_mfma_f32_16x16x32_bf16 a[32:35], a[80:83], a[88:91], a[32:35]
    ds_read_b64_tr_b16 a[56:57], v6 offset:8
    v_mfma_f32_16x16x32_bf16 a[32:35], a[84:87], a[104:107], a[32:35]
    ds_read_b64_tr_b16 a[58:59], v6 offset:520
    v_mfma_f32_16x16x32_bf16 a[36:39], a[80:83], a[92:95], a[36:39]
    ds_read_b64_tr_b16 a[60:61], v6 offset:12296
    v_mfma_f32_16x16x32_bf16 a[36:39], a[84:87], a[108:111], a[36:39]
    ds_read_b64_tr_b16 a[62:63], v6 offset:12808
    v_mfma_f32_16x16x32_bf16 a[40:43], a[80:83], a[96:99], a[40:43]
    s_add_u32 s54, s54, 196608
    s_add_u32 s55, s55, 196608
    v_mfma_f32_16x16x32_bf16 a[40:43], a[84:87], a[112:115], a[40:43]
    v_mfma_f32_16x16x32_bf16 a[44:47], a[80:83], a[100:103], a[44:47]
    s_cmp_eq_u32 s44, 1
    v_mfma_f32_16x16x32_bf16 a[44:47], a[84:87], a[116:119], a[44:47]
    s_waitcnt vmcnt(8) lgkmcnt(4)
    s_cbranch_scc1 L_p1_last
    v_mfma_f32_16x16x32_bf16 v[64:67], a[48:51], a[120:123], v[64:67]
    ds_read_b64_tr_b16 a[64:65], v7 offset:0
    v_mfma_f32_16x16x32_bf16 v[64:67], a[52:55], a[136:139], v[64:67]
    ds_read_b64_tr_b16 a[66:67], v7 offset:512
    v_mfma_f32_16x16x32_bf16 v[72:75], a[48:51], a[124:127], v[72:75]
    ds_read_b64_tr_b16 a[68:69], v7 offset:12288
    v_mfma_f32_16x16x32_bf16 v[72:75], a[52:55], a[140:143], v[72:75]
    ds_read_b64_tr_b16 a[70:71], v7 offset:12800
    v_mfma_f32_16x16x32_bf16 v[80:83], a[48:51], a[128:131], v[80:83]
    ds_read_b64_tr_b16 a[72:73], v7 offset:8
    v_mfma_f32_16x16x32_bf16 v[80:83], a[52:55], a[144:147], v[80:83]
    ds_read_b64_tr_b16 a[74:75], v7 offset:520
    v_mfma_f32_16x16x32_bf16 v[88:91], a[48:51], a[132:135], v[88:91]
    buffer_load_dwordx4 a[88:91], v22, s[4:7], s47 offen offset:0 sc1
    v_mfma_f32_16x16x32_bf16 v[88:91], a[52:55], a[148:151], v[88:91]
    s_waitcnt lgkmcnt(6)
    v_mfma_f32_16x16x32_bf16 v[68:71], a[56:59], a[120:123], v[68:71]
    ds_read_b64_tr_b16 a[76:77], v7 offset:12296
    v_mfma_f32_16x16x32_bf16 v[68:71], a[60:63], a[136:139], v[68:71]
    ds_read_b64_tr_b16 a[78:79], v7 offset:12808
    v_mfma_f32_16x16x32_bf16 v[76:79], a[56:59], a[124:127], v[76:79]
    ds_read_b64_tr_b16 a[80:81], v6 offset:1024
    v_mfma_f32_16x16x32_bf16 v[76:79], a[60:63], a[140:143], v[76:79]
    ds_read_b64_tr_b16 a[82:83], v6 offset:1536
    v_mfma_f32_16x16x32_bf16 v[84:87], a[56:59], a[128:131], v[84:87]
    ds_read_b64_tr_b16 a[84:85], v6 offset:13312
    v_mfma_f32_16x16x32_bf16 v[84:87], a[60:63], a[144:147], v[84:87]
    ds_read_b64_tr_b16 a[86:87], v6 offset:13824
    v_mfma_f32_16x16x32_bf16 v[92:95], a[56:59], a[132:135], v[92:95]
    buffer_load_dwordx4 a[92:95], v23, s[4:7], s47 offen offset:0 sc1
    v_mfma_f32_16x16x32_bf16 v[92:95], a[60:63], a[148:151], v[92:95]
    s_waitcnt lgkmcnt(8)
    v_mfma_f32_16x16x32_bf16 v[96:99], a[64:67], a[120:123], v[96:99]
    ds_read_b64_tr_b16 a[48:49], v6 offset:1032
    v_mfma_f32_16x16x32_bf16 v[96:99], a[68:71], a[136:139], v[96:99]
    ds_read_b64_tr_b16 a[50:51], v6 offset:1544
    v_mfma_f32_16x16x32_bf16 v[104:107], a[64:67], a[124:127], v[104:107]
    ds_read_b64_tr_b16 a[52:53], v6 offset:13320
    v_mfma_f32_16x16x32_bf16 v[104:107], a[68:71], a[140:143], v[104:107]
    ds_read_b64_tr_b16 a[54:55], v6 offset:13832
    v_mfma_f32_16x16x32_bf16 v[112:115], a[64:67], a[128:131], v[112:115]
    ds_read_b64_tr_b16 a[56:57], v7 offset:1024
    v_mfma_f32_16x16x32_bf16 v[112:115], a[68:71], a[144:147], v[112:115]
    ds_read_b64_tr_b16 a[58:59], v7 offset:1536
    v_mfma_f32_16x16x32_bf16 v[120:123], a[64:67], a[132:135], v[120:123]
    buffer_load_dwordx4 a[96:99], v24, s[4:7], s47 offen offset:0 sc1
    v_mfma_f32_16x16x32_bf16 v[120:123], a[68:71], a[148:151], v[120:123]
    s_waitcnt lgkmcnt(10)
    v_mfma_f32_16x16x32_bf16 v[100:103], a[72:75], a[120:123], v[100:103]
    ds_read_b64_tr_b16 a[60:61], v7 offset:13312
    v_mfma_f32_16x16x32_bf16 v[100:103], a[76:79], a[136:139], v[100:103]
    ds_read_b64_tr_b16 a[62:63], v7 offset:13824
    v_mfma_f32_16x16x32_bf16 v[108:111], a[72:75], a[124:127], v[108:111]
    ds_read_b64_tr_b16 a[64:65], v7 offset:1032
    v_mfma_f32_16x16x32_bf16 v[108:111], a[76:79], a[140:143], v[108:111]
    ds_read_b64_tr_b16 a[66:67], v7 offset:1544
    v_mfma_f32_16x16x32_bf16 v[116:119], a[72:75], a[128:131], v[116:119]
    ds_read_b64_tr_b16 a[68:69], v7 offset:13320
    v_mfma_f32_16x16x32_bf16 v[116:119], a[76:79], a[144:147], v[116:119]
    ds_read_b64_tr_b16 a[70:71], v7 offset:13832
    v_mfma_f32_16x16x32_bf16 v[124:127], a[72:75], a[132:135], v[124:127]
    buffer_load_dwordx4 a[100:103], v25, s[4:7], s47 offen offset:0 sc1
    v_mfma_f32_16x16x32_bf16 v[124:127], a[76:79], a[148:151], v[124:127]
    s_waitcnt lgkmcnt(12)
    v_mfma_f32_16x16x32_bf16 v[128:131], a[80:83], a[120:123], v[128:131]
    ds_read_b64_tr_b16 a[72:73], v6 offset:2048
    v_mfma_f32_16x16x32_bf16 v[128:131], a[84:87], a[136:139], v[128:131]
    ds_read_b64_tr_b16 a[74:75], v6 offset:2560
    v_mfma_f32_16x16x32_bf16 v[136:139], a[80:83], a[124:127], v[136:139]
    ds_read_b64_tr_b16 a[76:77], v6 offset:14336
    v_mfma_f32_16x16x32_bf16 v[136:139], a[84:87], a[140:143], v[136:139]
    ds_read_b64_tr_b16 a[78:79], v6 offset:14848
    v_mfma_f32_16x16x32_bf16 v[144:147], a[80:83], a[128:131], v[144:147]
    s_add_u32 m0, s41, 73728
    v_mfma_f32_16x16x32_bf16 v[144:147], a[84:87], a[144:147], v[144:147]
    buffer_load_dwordx4 v20, s[8:11], s42 offen offset:0 lds
    v_mfma_f32_16x16x32_bf16 v[152:155], a[80:83], a[132:135], v[152:155]
    buffer_load_dwordx4 a[104:107], v22, s[4:7], s47 offen offset:1024 sc1
    v_mfma_f32_16x16x32_bf16 v[152:155], a[84:87], a[148:151], v[152:155]
    s_waitcnt lgkmcnt(12)
    v_mfma_f32_16x16x32_bf16 v[132:135], a[48:51], a[120:123], v[132:135]
    ds_read_b64_tr_b16 a[80:81], v6 offset:2056
    v_mfma_f32_16x16x32_bf16 v[132:135], a[52:55], a[136:139], v[132:135]
    ds_read_b64_tr_b16 a[82:83], v6 offset:2568
    v_mfma_f32_16x16x32_bf16 v[140:143], a[48:51], a[124:127], v[140:143]
    ds_read_b64_tr_b16 a[84:85], v6 offset:14344
    v_mfma_f32_16x16x32_bf16 v[140:143], a[52:55], a[140:143], v[140:143]
    ds_read_b64_tr_b16 a[86:87], v6 offset:14856
    v_mfma_f32_16x16x32_bf16 v[148:151], a[48:51], a[128:131], v[148:151]
    s_add_u32 m0, s41, 74624
    v_mfma_f32_16x16x32_bf16 v[148:151], a[52:55], a[144:147], v[148:151]
    buffer_load_dwordx4 v20, s[8:11], s42 offen offset:128 lds
    v_mfma_f32_16x16x32_bf16 v[156:159], a[48:51], a[132:135], v[156:159]
    buffer_load_dwordx4 a[108:111], v23, s[4:7], s47 offen offset:1024 sc1
    v_mfma_f32_16x16x32_bf16 v[156:159], a[52:55], a[148:151], v[156:159]
    s_waitcnt lgkmcnt(12)
    v_mfma_f32_16x16x32_bf16 v[160:163], a[56:59], a[120:123], v[160:163]
    ds_read_b64_tr_b16 a[48:49], v7 offset:2048
    v_mfma_f32_16x16x32_bf16 v[160:163], a[60:63], a[136:139], v[160:163]
    ds_read_b64_tr_b16 a[50:51], v7 offset:2560
    v_mfma_f32_16x16x32_bf16 v[168:171], a[56:59], a[124:127], v[168:171]
    ds_read_b64_tr_b16 a[52:53], v7 offset:14336
    v_mfma_f32_16x16x32_bf16 v[168:171], a[60:63], a[140:143], v[168:171]
    ds_read_b64_tr_b16 a[54:55], v7 offset:14848
    v_mfma_f32_16x16x32_bf16 v[176:179], a[56:59], a[128:131], v[176:179]
    s_add_u32 m0, s41, 75520
    v_mfma_f32_16x16x32_bf16 v[176:179], a[60:63], a[144:147], v[176:179]
    buffer_load_dwordx4 v20, s[8:11], s42 offen offset:256 lds
    v_mfma_f32_16x16x32_bf16 v[184:187], a[56:59], a[132:135], v[184:187]
    buffer_load_dwordx4 a[112:115], v24, s[4:7], s47 offen offset:1024 sc1
    v_mfma_f32_16x16x32_bf16 v[184:187], a[60:63], a[148:151], v[184:187]
    s_waitcnt lgkmcnt(12)
    v_mfma_f32_16x16x32_bf16 v[164:167], a[64:67], a[120:123], v[164:167]
    ds_read_b64_tr_b16 a[56:57], v7 offset:2056
    v_mfma_f32_16x16x32_bf16 v[164:167], a[68:71], a[136:139], v[164:167]
    ds_read_b64_tr_b16 a[58:59], v7 offset:2568
    v_mfma_f32_16x16x32_bf16 v[172:175], a[64:67], a[124:127], v[172:175]
    ds_read_b64_tr_b16 a[60:61], v7 offset:14344
    v_mfma_f32_16x16x32_bf16 v[172:175], a[68:71], a[140:143], v[172:175]
    ds_read_b64_tr_b16 a[62:63], v7 offset:14856
    v_mfma_f32_16x16x32_bf16 v[180:183], a[64:67], a[128:131], v[180:183]
    s_add_u32 m0, s41, 86016
    v_mfma_f32_16x16x32_bf16 v[180:183], a[68:71], a[144:147], v[180:183]
    buffer_load_dwordx4 v20, s[8:11], s43 offen offset:0 lds
    v_mfma_f32_16x16x32_bf16 v[188:191], a[64:67], a[132:135], v[188:191]
    buffer_load_dwordx4 a[116:119], v25, s[4:7], s47 offen offset:1024 sc1
    v_mfma_f32_16x16x32_bf16 v[188:191], a[68:71], a[148:151], v[188:191]
    s_waitcnt lgkmcnt(12)
    v_mfma_f32_16x16x32_bf16 v[192:195], a[72:75], a[120:123], v[192:195]
    ds_read_b64_tr_b16 a[64:65], v8 offset:0
    v_mfma_f32_16x16x32_bf16 v[192:195], a[76:79], a[136:139], v[192:195]
    ds_read_b64_tr_b16 a[66:67], v8 offset:512
    v_mfma_f32_16x16x32_bf16 v[200:203], a[72:75], a[124:127], v[200:203]
    ds_read_b64_tr_b16 a[68:69], v8 offset:4096
    v_mfma_f32_16x16x32_bf16 v[200:203], a[76:79], a[140:143], v[200:203]
    ds_read_b64_tr_b16 a[70:71], v8 offset:4608
    v_mfma_f32_16x16x32_bf16 v[208:211], a[72:75], a[128:131], v[208:211]
    s_add_u32 m0, s41, 86912
    v_mfma_f32_16x16x32_bf16 v[208:211], a[76:79], a[144:147], v[208:211]
    buffer_load_dwordx4 v20, s[8:11], s43 offen offset:128 lds
    v_mfma_f32_16x16x32_bf16 v[216:219], a[72:75], a[132:135], v[216:219]
    s_add_u32 s42, s42, 786432
    v_mfma_f32_16x16x32_bf16 v[216:219], a[76:79], a[148:151], v[216:219]
    s_waitcnt lgkmcnt(12)
    v_mfma_f32_16x16x32_bf16 v[196:199], a[80:83], a[120:123], v[196:199]
    ds_read_b64_tr_b16 a[72:73], v9 offset:0
    v_mfma_f32_16x16x32_bf16 v[196:199], a[84:87], a[136:139], v[196:199]
    ds_read_b64_tr_b16 a[74:75], v9 offset:512
    v_mfma_f32_16x16x32_bf16 v[204:207], a[80:83], a[124:127], v[204:207]
    ds_read_b64_tr_b16 a[76:77], v9 offset:4096
    v_mfma_f32_16x16x32_bf16 v[204:207], a[84:87], a[140:143], v[204:207]
    ds_read_b64_tr_b16 a[78:79], v9 offset:4608
    v_mfma_f32_16x16x32_bf16 v[212:215], a[80:83], a[128:131], v[212:215]
    s_add_u32 m0, s41, 87808
    v_mfma_f32_16x16x32_bf16 v[212:215], a[84:87], a[144:147], v[212:215]
    buffer_load_dwordx4 v20, s[8:11], s43 offen offset:256 lds
    v_mfma_f32_16x16x32_bf16 v[220:223], a[80:83], a[132:135], v[220:223]
    s_mov_b32 s46, s40
    s_add_u32 s40, s40, 24576
    s_add_u32 s47, s47, 2048
    v_mfma_f32_16x16x32_bf16 v[220:223], a[84:87], a[148:151], v[220:223]
    s_waitcnt lgkmcnt(12)
    v_mfma_f32_16x16x32_bf16 v[224:227], a[48:51], a[120:123], v[224:227]
    ds_read_b64_tr_b16 a[80:81], v10 offset:0
    v_mfma_f32_16x16x32_bf16 v[224:227], a[52:55], a[136:139], v[224:227]
    ds_read_b64_tr_b16 a[82:83], v10 offset:512
    v_mfma_f32_16x16x32_bf16 v[232:235], a[48:51], a[124:127], v[232:235]
    ds_read_b64_tr_b16 a[84:85], v10 offset:4096
    v_mfma_f32_16x16x32_bf16 v[232:235], a[52:55], a[140:143], v[232:235]
    ds_read_b64_tr_b16 a[86:87], v10 offset:4608
    v_mfma_f32_16x16x32_bf16 v[240:243], a[48:51], a[128:131], v[240:243]
    s_add_u32 m0, s53, 49152
    v_mfma_f32_16x16x32_bf16 v[240:243], a[52:55], a[144:147], v[240:243]
    buffer_load_dwordx4 v21, s[12:15], s54 offen lds
    v_mfma_f32_16x16x32_bf16 v[248:251], a[48:51], a[132:135], v[248:251]
    s_cmp_eq_u32 s40, 73728
    s_cselect_b32 s40, 0, s40
    s_add_u32 s41, s46, s48
    v_mfma_f32_16x16x32_bf16 v[248:251], a[52:55], a[148:151], v[248:251]
    s_waitcnt lgkmcnt(12)
    v_mfma_f32_16x16x32_bf16 v[228:231], a[56:59], a[120:123], v[228:231]
    s_add_u32 m0, s53, 53248
    v_mfma_f32_16x16x32_bf16 v[228:231], a[60:63], a[136:139], v[228:231]
    buffer_load_dwordx4 v21, s[12:15], s55 offen lds
    v_mfma_f32_16x16x32_bf16 v[236:239], a[56:59], a[124:127], v[236:239]
    v_mfma_f32_16x16x32_bf16 v[236:239], a[60:63], a[140:143], v[236:239]
    v_mfma_f32_16x16x32_bf16 v[244:247], a[56:59], a[128:131], v[244:247]
    v_mfma_f32_16x16x32_bf16 v[244:247], a[60:63], a[144:147], v[244:247]
    v_mfma_f32_16x16x32_bf16 v[252:255], a[56:59], a[132:135], v[252:255]
    s_lshl_b32 s45, s38, 10
    s_add_u32 s53, s52, s45
    s_add_u32 s52, s52, 8192
    v_mfma_f32_16x16x32_bf16 v[252:255], a[60:63], a[148:151], v[252:255]
    s_waitcnt lgkmcnt(8)
    v_mfma_f32_16x16x32_bf16 a[0:3], a[64:67], a[120:123], a[0:3]
    v_mfma_f32_16x16x32_bf16 a[0:3], a[68:71], a[136:139], a[0:3]
    v_mfma_f32_16x16x32_bf16 a[4:7], a[64:67], a[124:127], a[4:7]
    s_cmp_eq_u32 s52, 24576
    s_cselect_b32 s52, 0, s52
    v_mfma_f32_16x16x32_bf16 a[4:7], a[68:71], a[140:143], a[4:7]
    v_add_u32 v6, s40, v12
    v_add_u32 v7, s40, v13
    v_mfma_f32_16x16x32_bf16 a[8:11], a[64:67], a[128:131], a[8:11]
    s_waitcnt vmcnt(16) lgkmcnt(0)
    v_add_u32 v10, s52, v16
    v_mfma_f32_16x16x32_bf16 a[8:11], a[68:71], a[144:147], a[8:11]
    s_barrier
    v_mfma_f32_16x16x32_bf16 a[12:15], a[64:67], a[132:135], a[12:15]
    buffer_load_dword v47, v46, s[28:31], s58 offen
    v_mfma_f32_16x16x32_bf16 a[12:15], a[68:71], a[148:151], a[12:15]
    s_add_u32 s43, s43, 786432
    v_add_u32 v8, s52, v14
    v_add_u32 v9, s52, v15
    v_mfma_f32_16x16x32_bf16 a[16:19], a[72:75], a[120:123], a[16:19]
    ds_read_b64_tr_b16 a[48:49], v6 offset:0
    v_mfma_f32_16x16x32_bf16 a[16:19], a[76:79], a[136:139], a[16:19]
    ds_read_b64_tr_b16 a[50:51], v6 offset:512
    v_mfma_f32_16x16x32_bf16 a[20:23], a[72:75], a[124:127], a[20:23]
    ds_read_b64_tr_b16 a[52:53], v6 offset:12288
    v_mfma_f32_16x16x32_bf16 a[20:23], a[76:79], a[140:143], a[20:23]
    ds_read_b64_tr_b16 a[54:55], v6 offset:12800
    v_mfma_f32_16x16x32_bf16 a[24:27], a[72:75], a[128:131], a[24:27]
    s_sub_u32 s44, s44, 1
    v_mfma_f32_16x16x32_bf16 a[24:27], a[76:79], a[144:147], a[24:27]
    s_cmp_eq_u32 s44, 2
    s_cselect_b32 s28, s39, s28
    s_cselect_b32 s29, s59, s29
    v_mfma_f32_16x16x32_bf16 a[28:31], a[72:75], a[132:135], a[28:31]
    s_cselect_b32 s30, s22, s30
    s_cselect_b32 s101, s3, s101
    s_cselect_b64 vcc, -1, 0
    v_mfma_f32_16x16x32_bf16 a[28:31], a[76:79], a[148:151], a[28:31]
    s_add_u32 s58, s58, s101
    v_mfma_f32_16x16x32_bf16 a[32:35], a[80:83], a[120:123], a[32:35]
    ds_read_b64_tr_b16 a[56:57], v6 offset:8
    v_mfma_f32_16x16x32_bf16 a[32:35], a[84:87], a[136:139], a[32:35]
    ds_read_b64_tr_b16 a[58:59], v6 offset:520
    v_mfma_f32_16x16x32_bf16 a[36:39], a[80:83], a[124:127], a[36:39]
    ds_read_b64_tr_b16 a[60:61], v6 offset:12296
    v_mfma_f32_16x16x32_bf16 a[36:39], a[84:87], a[140:143], a[36:39]
    ds_read_b64_tr_b16 a[62:63], v6 offset:12808
    v_mfma_f32_16x16x32_bf16 a[40:43], a[80:83], a[128:131], a[40:43]
    s_add_u32 s54, s54, 196608
    s_add_u32 s55, s55, 196608
    v_mfma_f32_16x16x32_bf16 a[40:43], a[84:87], a[144:147], a[40:43]
    s_cmp_eq_u32 s44, 2
    s_cselect_b32 s58, 0, s58
    v_cndmask_b32 v46, v46, v60, vcc
    v_mfma_f32_16x16x32_bf16 a[44:47], a[80:83], a[132:135], a[44:47]
    v_mfma_f32_16x16x32_bf16 a[44:47], a[84:87], a[148:151], a[44:47]
    s_waitcnt vmcnt(5) lgkmcnt(4)
    s_branch L_p1_loop
L_p1_last:
    v_mfma_f32_16x16x32_bf16 v[64:67], a[48:51], a[120:123], v[64:67]
    ds_read_b64_tr_b16 a[64:65], v7 offset:0
    v_mfma_f32_16x16x32_bf16 v[64:67], a[52:55], a[136:139], v[64:67]
    ds_read_b64_tr_b16 a[66:67], v7 offset:512
    v_mfma_f32_16x16x32_bf16 v[72:75], a[48:51], a[124:127], v[72:75]
    ds_read_b64_tr_b16 a[68:69], v7 offset:12288
    v_mfma_f32_16x16x32_bf16 v[72:75], a[52:55], a[140:143], v[72:75]
    ds_read_b64_tr_b16 a[70:71], v7 offset:12800
    v_mfma_f32_16x16x32_bf16 v[80:83], a[48:51], a[128:131], v[80:83]
    ds_read_b64_tr_b16 a[72:73], v7 offset:8
    v_mfma_f32_16x16x32_bf16 v[80:83], a[52:55], a[144:147], v[80:83]
    ds_read_b64_tr_b16 a[74:75], v7 offset:520
    s_mov_b32 s49, 0
    s_add_u32 m0, s48, 73728
    v_mfma_f32_16x16x32_bf16 v[88:91], a[48:51], a[132:135], v[88:91]
    buffer_load_dwordx4 v19, s[20:23], s49 offen offset:0 lds
    v_mfma_f32_16x16x32_bf16 v[88:91], a[52:55], a[148:151], v[88:91]
    s_waitcnt lgkmcnt(6)
    v_mfma_f32_16x16x32_bf16 v[68:71], a[56:59], a[120:123], v[68:71]
    ds_read_b64_tr_b16 a[76:77], v7 offset:12296
    v_mfma_f32_16x16x32_bf16 v[68:71], a[60:63], a[136:139], v[68:71]
    ds_read_b64_tr_b16 a[78:79], v7 offset:12808
    v_mfma_f32_16x16x32_bf16 v[76:79], a[56:59], a[124:127], v[76:79]
    ds_read_b64_tr_b16 a[80:81], v6 offset:1024
    v_mfma_f32_16x16x32_bf16 v[76:79], a[60:63], a[140:143], v[76:79]
    ds_read_b64_tr_b16 a[82:83], v6 offset:1536
    v_mfma_f32_16x16x32_bf16 v[84:87], a[56:59], a[128:131], v[84:87]
    ds_read_b64_tr_b16 a[84:85], v6 offset:13312
    v_mfma_f32_16x16x32_bf16 v[84:87], a[60:63], a[144:147], v[84:87]
    ds_read_b64_tr_b16 a[86:87], v6 offset:13824
    s_add_u32 m0, s48, 74624
    v_mfma_f32_16x16x32_bf16 v[92:95], a[56:59], a[132:135], v[92:95]
    buffer_load_dwordx4 v19, s[20:23], s49 offen offset:128 lds
    v_mfma_f32_16x16x32_bf16 v[92:95], a[60:63], a[148:151], v[92:95]
    s_waitcnt lgkmcnt(8)
    v_cvt_pk_bf16_f32 v64, v64, v65
    v_cvt_pk_bf16_f32 v65, v66, v67
    v_mfma_f32_16x16x32_bf16 v[96:99], a[64:67], a[120:123], v[96:99]
    ds_read_b64_tr_b16 a[48:49], v6 offset:1032
    v_cvt_pk_bf16_f32 v66, v68, v69
    v_mfma_f32_16x16x32_bf16 v[96:99], a[68:71], a[136:139], v[96:99]
    ds_read_b64_tr_b16 a[50:51], v6 offset:1544
    v_cvt_pk_bf16_f32 v67, v70, v71
    v_mfma_f32_16x16x32_bf16 v[104:107], a[64:67], a[124:127], v[104:107]
    ds_read_b64_tr_b16 a[52:53], v6 offset:13320
    v_cvt_pk_bf16_f32 v68, v72, v73
    v_mfma_f32_16x16x32_bf16 v[104:107], a[68:71], a[140:143], v[104:107]
    ds_read_b64_tr_b16 a[54:55], v6 offset:13832
    v_cvt_pk_bf16_f32 v69, v74, v75
    v_mfma_f32_16x16x32_bf16 v[112:115], a[64:67], a[128:131], v[112:115]
    ds_read_b64_tr_b16 a[56:57], v7 offset:1024
    v_cvt_pk_bf16_f32 v70, v76, v77
    v_mfma_f32_16x16x32_bf16 v[112:115], a[68:71], a[144:147], v[112:115]
    ds_read_b64_tr_b16 a[58:59], v7 offset:1536
    s_add_u32 m0, s48, 75520
    v_mfma_f32_16x16x32_bf16 v[120:123], a[64:67], a[132:135], v[120:123]
    buffer_load_dwordx4 v19, s[20:23], s49 offen offset:256 lds
    v_mfma_f32_16x16x32_bf16 v[120:123], a[68:71], a[148:151], v[120:123]
    s_waitcnt lgkmcnt(10)
    v_cvt_pk_bf16_f32 v71, v78, v79
    v_cvt_pk_bf16_f32 v72, v80, v81
    v_mfma_f32_16x16x32_bf16 v[100:103], a[72:75], a[120:123], v[100:103]
    ds_read_b64_tr_b16 a[60:61], v7 offset:13312
    v_cvt_pk_bf16_f32 v73, v82, v83
    v_mfma_f32_16x16x32_bf16 v[100:103], a[76:79], a[136:139], v[100:103]
    ds_read_b64_tr_b16 a[62:63], v7 offset:13824
    v_cvt_pk_bf16_f32 v74, v84, v85
    v_mfma_f32_16x16x32_bf16 v[108:111], a[72:75], a[124:127], v[108:111]
    ds_read_b64_tr_b16 a[64:65], v7 offset:1032
    v_cvt_pk_bf16_f32 v75, v86, v87
    v_mfma_f32_16x16x32_bf16 v[108:111], a[76:79], a[140:143], v[108:111]
    ds_read_b64_tr_b16 a[66:67], v7 offset:1544
    v_cvt_pk_bf16_f32 v76, v88, v89
    v_mfma_f32_16x16x32_bf16 v[116:119], a[72:75], a[128:131], v[116:119]
    ds_read_b64_tr_b16 a[68:69], v7 offset:13320
    v_cvt_pk_bf16_f32 v77, v90, v91
    v_mfma_f32_16x16x32_bf16 v[116:119], a[76:79], a[144:147], v[116:119]
    ds_read_b64_tr_b16 a[70:71], v7 offset:13832
    s_mov_b32 s50, 12288
    s_add_u32 m0, s48, 86016
    v_mfma_f32_16x16x32_bf16 v[124:127], a[72:75], a[132:135], v[124:127]
    buffer_load_dwordx4 v19, s[20:23], s50 offen offset:0 lds
    v_mfma_f32_16x16x32_bf16 v[124:127], a[76:79], a[148:151], v[124:127]
    s_waitcnt lgkmcnt(12)
    v_cvt_pk_bf16_f32 v78, v92, v93
    v_cvt_pk_bf16_f32 v79, v94, v95
    v_mfma_f32_16x16x32_bf16 v[128:131], a[80:83], a[120:123], v[128:131]
    ds_read_b64_tr_b16 a[72:73], v6 offset:2048
    v_cvt_pk_bf16_f32 v80, v96, v97
    v_mfma_f32_16x16x32_bf16 v[128:131], a[84:87], a[136:139], v[128:131]
    ds_read_b64_tr_b16 a[74:75], v6 offset:2560
    v_cvt_pk_bf16_f32 v81, v98, v99
    v_mfma_f32_16x16x32_bf16 v[136:139], a[80:83], a[124:127], v[136:139]
    ds_read_b64_tr_b16 a[76:77], v6 offset:14336
    v_cvt_pk_bf16_f32 v82, v100, v101
    v_mfma_f32_16x16x32_bf16 v[136:139], a[84:87], a[140:143], v[136:139]
    ds_read_b64_tr_b16 a[78:79], v6 offset:14848
    v_cvt_pk_bf16_f32 v83, v102, v103
    v_mfma_f32_16x16x32_bf16 v[144:147], a[80:83], a[128:131], v[144:147]
    s_add_u32 m0, s48, 86912
    v_cvt_pk_bf16_f32 v84, v104, v105
    v_cvt_pk_bf16_f32 v85, v106, v107
    v_mfma_f32_16x16x32_bf16 v[144:147], a[84:87], a[144:147], v[144:147]
    buffer_load_dwordx4 v19, s[20:23], s50 offen offset:128 lds
    v_mfma_f32_16x16x32_bf16 v[152:155], a[80:83], a[132:135], v[152:155]
    v_cvt_pk_bf16_f32 v86, v108, v109
    v_cvt_pk_bf16_f32 v87, v110, v111
    v_mfma_f32_16x16x32_bf16 v[152:155], a[84:87], a[148:151], v[152:155]
    s_waitcnt lgkmcnt(12)
    v_cvt_pk_bf16_f32 v88, v112, v113
    v_cvt_pk_bf16_f32 v89, v114, v115
    v_mfma_f32_16x16x32_bf16 v[132:135], a[48:51], a[120:123], v[132:135]
    ds_read_b64_tr_b16 a[80:81], v6 offset:2056
    v_cvt_pk_bf16_f32 v90, v116, v117
    v_mfma_f32_16x16x32_bf16 v[132:135], a[52:55], a[136:139], v[132:135]
    ds_read_b64_tr_b16 a[82:83], v6 offset:2568
    v_cvt_pk_bf16_f32 v91, v118, v119
    v_mfma_f32_16x16x32_bf16 v[140:143], a[48:51], a[124:127], v[140:143]
    ds_read_b64_tr_b16 a[84:85], v6 offset:14344
    v_cvt_pk_bf16_f32 v92, v120, v121
    v_mfma_f32_16x16x32_bf16 v[140:143], a[52:55], a[140:143], v[140:143]
    ds_read_b64_tr_b16 a[86:87], v6 offset:14856
    v_cvt_pk_bf16_f32 v93, v122, v123
    v_mfma_f32_16x16x32_bf16 v[148:151], a[48:51], a[128:131], v[148:151]
    s_add_u32 m0, s48, 87808
    v_cvt_pk_bf16_f32 v94, v124, v125
    v_cvt_pk_bf16_f32 v95, v126, v127
    v_mfma_f32_16x16x32_bf16 v[148:151], a[52:55], a[144:147], v[148:151]
    buffer_load_dwordx4 v19, s[20:23], s50 offen offset:256 lds
    v_mfma_f32_16x16x32_bf16 v[156:159], a[48:51], a[132:135], v[156:159]
    v_cvt_pk_bf16_f32 v96, v128, v129
    v_cvt_pk_bf16_f32 v97, v130, v131
    v_mfma_f32_16x16x32_bf16 v[156:159], a[52:55], a[148:151], v[156:159]
    s_waitcnt lgkmcnt(12)
    v_cvt_pk_bf16_f32 v98, v132, v133
    v_cvt_pk_bf16_f32 v99, v134, v135
    v_mfma_f32_16x16x32_bf16 v[160:163], a[56:59], a[120:123], v[160:163]
    ds_read_b64_tr_b16 a[48:49], v7 offset:2048
    v_cvt_pk_bf16_f32 v100, v136, v137
    v_mfma_f32_16x16x32_bf16 v[160:163], a[60:63], a[136:139], v[160:163]
    ds_read_b64_tr_b16 a[50:51], v7 offset:2560
    v_cvt_pk_bf16_f32 v101, v138, v139
    v_mfma_f32_16x16x32_bf16 v[168:171], a[56:59], a[124:127], v[168:171]
    ds_read_b64_tr_b16 a[52:53], v7 offset:14336
    v_cvt_pk_bf16_f32 v102, v140, v141
    v_mfma_f32_16x16x32_bf16 v[168:171], a[60:63], a[140:143], v[168:171]
    ds_read_b64_tr_b16 a[54:55], v7 offset:14848
    v_cvt_pk_bf16_f32 v103, v142, v143
    v_mfma_f32_16x16x32_bf16 v[176:179], a[56:59], a[128:131], v[176:179]
    s_mov_b32 s49, 24576
    s_add_u32 m0, s48, 98304
    v_cvt_pk_bf16_f32 v104, v144, v145
    v_mfma_f32_16x16x32_bf16 v[176:179], a[60:63], a[144:147], v[176:179]
    buffer_load_dwordx4 v19, s[20:23], s49 offen offset:0 lds
    v_mfma_f32_16x16x32_bf16 v[184:187], a[56:59], a[132:135], v[184:187]
    v_cvt_pk_bf16_f32 v105, v146, v147
    v_cvt_pk_bf16_f32 v106, v148, v149
    v_mfma_f32_16x16x32_bf16 v[184:187], a[60:63], a[148:151], v[184:187]
    s_waitcnt lgkmcnt(12)
    v_cvt_pk_bf16_f32 v107, v150, v151
    v_cvt_pk_bf16_f32 v108, v152, v153
    v_mfma_f32_16x16x32_bf16 v[164:167], a[64:67], a[120:123], v[164:167]
    ds_read_b64_tr_b16 a[56:57], v7 offset:2056
    v_cvt_pk_bf16_f32 v109, v154, v155
    v_mfma_f32_16x16x32_bf16 v[164:167], a[68:71], a[136:139], v[164:167]
    ds_read_b64_tr_b16 a[58:59], v7 offset:2568
    v_cvt_pk_bf16_f32 v110, v156, v157
    v_mfma_f32_16x16x32_bf16 v[172:175], a[64:67], a[124:127], v[172:175]
    ds_read_b64_tr_b16 a[60:61], v7 offset:14344
    v_cvt_pk_bf16_f32 v111, v158, v159
    v_mfma_f32_16x16x32_bf16 v[172:175], a[68:71], a[140:143], v[172:175]
    ds_read_b64_tr_b16 a[62:63], v7 offset:14856
    v_mfma_f32_16x16x32_bf16 v[180:183], a[64:67], a[128:131], v[180:183]
    s_add_u32 m0, s48, 99200
    v_mfma_f32_16x16x32_bf16 v[180:183], a[68:71], a[144:147], v[180:183]
    buffer_load_dwordx4 v19, s[20:23], s49 offen offset:128 lds
    v_mfma_f32_16x16x32_bf16 v[188:191], a[64:67], a[132:135], v[188:191]
    v_cvt_pk_bf16_f32 v112, v160, v161
    v_cvt_pk_bf16_f32 v113, v162, v163
    v_mfma_f32_16x16x32_bf16 v[188:191], a[68:71], a[148:151], v[188:191]
    s_waitcnt lgkmcnt(12)
    v_cvt_pk_bf16_f32 v114, v164, v165
    v_cvt_pk_bf16_f32 v115, v166, v167
    v_mfma_f32_16x16x32_bf16 v[192:195], a[72:75], a[120:123], v[192:195]
    ds_read_b64_tr_b16 a[64:65], v8 offset:0
    v_cvt_pk_bf16_f32 v116, v168, v169
    v_mfma_f32_16x16x32_bf16 v[192:195], a[76:79], a[136:139], v[192:195]
    ds_read_b64_tr_b16 a[66:67], v8 offset:512
    v_cvt_pk_bf16_f32 v117, v170, v171
    v_mfma_f32_16x16x32_bf16 v[200:203], a[72:75], a[124:127], v[200:203]
    ds_read_b64_tr_b16 a[68:69], v8 offset:4096
    v_cvt_pk_bf16_f32 v118, v172, v173
    v_mfma_f32_16x16x32_bf16 v[200:203], a[76:79], a[140:143], v[200:203]
    ds_read_b64_tr_b16 a[70:71], v8 offset:4608
    v_cvt_pk_bf16_f32 v119, v174, v175
    v_mfma_f32_16x16x32_bf16 v[208:211], a[72:75], a[128:131], v[208:211]
    s_add_u32 m0, s48, 100096
    v_cvt_pk_bf16_f32 v120, v176, v177
    v_cvt_pk_bf16_f32 v121, v178, v179
    v_mfma_f32_16x16x32_bf16 v[208:211], a[76:79], a[144:147], v[208:211]
    buffer_load_dwordx4 v19, s[20:23], s49 offen offset:256 lds
    v_mfma_f32_16x16x32_bf16 v[216:219], a[72:75], a[132:135], v[216:219]
    v_cvt_pk_bf16_f32 v122, v180, v181
    v_cvt_pk_bf16_f32 v123, v182, v183
    v_mfma_f32_16x16x32_bf16 v[216:219], a[76:79], a[148:151], v[216:219]
    s_waitcnt lgkmcnt(12)
    v_cvt_pk_bf16_f32 v124, v184, v185
    v_cvt_pk_bf16_f32 v125, v186, v187
    v_mfma_f32_16x16x32_bf16 v[196:199], a[80:83], a[120:123], v[196:199]
    ds_read_b64_tr_b16 a[72:73], v9 offset:0
    v_cvt_pk_bf16_f32 v126, v188, v189
    v_mfma_f32_16x16x32_bf16 v[196:199], a[84:87], a[136:139], v[196:199]
    ds_read_b64_tr_b16 a[74:75], v9 offset:512
    v_cvt_pk_bf16_f32 v127, v190, v191
    v_mfma_f32_16x16x32_bf16 v[204:207], a[80:83], a[124:127], v[204:207]
    ds_read_b64_tr_b16 a[76:77], v9 offset:4096
    v_mfma_f32_16x16x32_bf16 v[204:207], a[84:87], a[140:143], v[204:207]
    ds_read_b64_tr_b16 a[78:79], v9 offset:4608
    v_mfma_f32_16x16x32_bf16 v[212:215], a[80:83], a[128:131], v[212:215]
    s_mov_b32 s50, 36864
    s_add_u32 m0, s48, 110592
    v_mfma_f32_16x16x32_bf16 v[212:215], a[84:87], a[144:147], v[212:215]
    buffer_load_dwordx4 v19, s[20:23], s50 offen offset:0 lds
    v_mfma_f32_16x16x32_bf16 v[220:223], a[80:83], a[132:135], v[220:223]
    v_cvt_pk_bf16_f32 v128, v192, v193
    v_cvt_pk_bf16_f32 v129, v194, v195
    v_mfma_f32_16x16x32_bf16 v[220:223], a[84:87], a[148:151], v[220:223]
    s_waitcnt lgkmcnt(12)
    v_cvt_pk_bf16_f32 v130, v196, v197
    v_cvt_pk_bf16_f32 v131, v198, v199
    v_mfma_f32_16x16x32_bf16 v[224:227], a[48:51], a[120:123], v[224:227]
    ds_read_b64_tr_b16 a[80:81], v10 offset:0
    v_accvgpr_write_b32 a224, v128
    v_mfma_f32_16x16x32_bf16 v[224:227], a[52:55], a[136:139], v[224:227]
    ds_read_b64_tr_b16 a[82:83], v10 offset:512
    v_accvgpr_write_b32 a225, v129
    v_mfma_f32_16x16x32_bf16 v[232:235], a[48:51], a[124:127], v[232:235]
    ds_read_b64_tr_b16 a[84:85], v10 offset:4096
    v_accvgpr_write_b32 a226, v130
    v_mfma_f32_16x16x32_bf16 v[232:235], a[52:55], a[140:143], v[232:235]
    ds_read_b64_tr_b16 a[86:87], v10 offset:4608
    v_accvgpr_write_b32 a227, v131
    v_mfma_f32_16x16x32_bf16 v[240:243], a[48:51], a[128:131], v[240:243]
    s_add_u32 m0, s48, 111488
    v_cvt_pk_bf16_f32 v132, v200, v201
    v_cvt_pk_bf16_f32 v133, v202, v203
    v_mfma_f32_16x16x32_bf16 v[240:243], a[52:55], a[144:147], v[240:243]
    buffer_load_dwordx4 v19, s[20:23], s50 offen offset:128 lds
    v_mfma_f32_16x16x32_bf16 v[248:251], a[48:51], a[132:135], v[248:251]
    v_cvt_pk_bf16_f32 v134, v204, v205
    v_cvt_pk_bf16_f32 v135, v206, v207
    v_mfma_f32_16x16x32_bf16 v[248:251], a[52:55], a[148:151], v[248:251]
    s_waitcnt lgkmcnt(12)
    v_accvgpr_write_b32 a228, v132
    v_accvgpr_write_b32 a229, v133
    v_mfma_f32_16x16x32_bf16 v[228:231], a[56:59], a[120:123], v[228:231]
    v_accvgpr_write_b32 a230, v134
    v_accvgpr_write_b32 a231, v135
    v_mfma_f32_16x16x32_bf16 v[228:231], a[60:63], a[136:139], v[228:231]
    v_cvt_pk_bf16_f32 v136, v208, v209
    v_cvt_pk_bf16_f32 v137, v210, v211
    v_mfma_f32_16x16x32_bf16 v[236:239], a[56:59], a[124:127], v[236:239]
    v_cvt_pk_bf16_f32 v138, v212, v213
    v_cvt_pk_bf16_f32 v139, v214, v215
    v_mfma_f32_16x16x32_bf16 v[236:239], a[60:63], a[140:143], v[236:239]
    v_accvgpr_write_b32 a232, v136
    v_accvgpr_write_b32 a233, v137
    v_mfma_f32_16x16x32_bf16 v[244:247], a[56:59], a[128:131], v[244:247]
    s_add_u32 m0, s48, 112384
    v_accvgpr_write_b32 a234, v138
    v_accvgpr_write_b32 a235, v139
    v_mfma_f32_16x16x32_bf16 v[244:247], a[60:63], a[144:147], v[244:247]
    buffer_load_dwordx4 v19, s[20:23], s50 offen offset:256 lds
    v_mfma_f32_16x16x32_bf16 v[252:255], a[56:59], a[132:135], v[252:255]
    v_cvt_pk_bf16_f32 v140, v216, v217
    v_cvt_pk_bf16_f32 v141, v218, v219
    v_mfma_f32_16x16x32_bf16 v[252:255], a[60:63], a[148:151], v[252:255]
    s_waitcnt vmcnt(13) lgkmcnt(0)
    v_cvt_pk_bf16_f32 v142, v220, v221
    v_cvt_pk_bf16_f32 v143, v222, v223
    v_mfma_f32_16x16x32_bf16 a[0:3], a[64:67], a[120:123], a[0:3]
    s_barrier
    v_accvgpr_write_b32 a236, v140
    v_accvgpr_write_b32 a237, v141
    v_mfma_f32_16x16x32_bf16 a[0:3], a[68:71], a[136:139], a[0:3]
    v_accvgpr_write_b32 a238, v142
    v_accvgpr_write_b32 a239, v143
    v_mfma_f32_16x16x32_bf16 a[4:7], a[64:67], a[124:127], a[4:7]
    s_mov_b32 s42, 49152
    s_add_u32 m0, s48, 49152
    v_cvt_pk_bf16_f32 v144, v224, v225
    v_mfma_f32_16x16x32_bf16 a[4:7], a[68:71], a[140:143], a[4:7]
    buffer_load_dwordx4 v18, s[16:19], s42 offen offset:0 lds
    v_mfma_f32_16x16x32_bf16 a[8:11], a[64:67], a[128:131], a[8:11]
    v_cvt_pk_bf16_f32 v145, v226, v227
    v_cvt_pk_bf16_f32 v146, v228, v229
    v_mfma_f32_16x16x32_bf16 a[8:11], a[68:71], a[144:147], a[8:11]
    s_add_u32 m0, s48, 50048
    v_cvt_pk_bf16_f32 v147, v230, v231
    v_accvgpr_write_b32 a240, v144
    v_mfma_f32_16x16x32_bf16 a[12:15], a[64:67], a[132:135], a[12:15]
    buffer_load_dwordx4 v18, s[16:19], s42 offen offset:128 lds
    v_mfma_f32_16x16x32_bf16 a[12:15], a[68:71], a[148:151], a[12:15]
    v_accvgpr_write_b32 a241, v145
    v_accvgpr_write_b32 a242, v146
    v_mfma_f32_16x16x32_bf16 a[16:19], a[72:75], a[120:123], a[16:19]
    s_add_u32 m0, s48, 50944
    v_accvgpr_write_b32 a243, v147
    v_cvt_pk_bf16_f32 v148, v232, v233
    v_mfma_f32_16x16x32_bf16 a[16:19], a[76:79], a[136:139], a[16:19]
    buffer_load_dwordx4 v18, s[16:19], s42 offen offset:256 lds
    v_mfma_f32_16x16x32_bf16 a[20:23], a[72:75], a[124:127], a[20:23]
    v_cvt_pk_bf16_f32 v149, v234, v235
    v_cvt_pk_bf16_f32 v150, v236, v237
    v_mfma_f32_16x16x32_bf16 a[20:23], a[76:79], a[140:143], a[20:23]
    s_mov_b32 s43, 61440
    s_add_u32 m0, s48, 61440
    v_cvt_pk_bf16_f32 v151, v238, v239
    v_mfma_f32_16x16x32_bf16 a[24:27], a[72:75], a[128:131], a[24:27]
    buffer_load_dwordx4 v18, s[16:19], s43 offen offset:0 lds
    v_mfma_f32_16x16x32_bf16 a[24:27], a[76:79], a[144:147], a[24:27]
    v_accvgpr_write_b32 a244, v148
    v_accvgpr_write_b32 a245, v149
    v_mfma_f32_16x16x32_bf16 a[28:31], a[72:75], a[132:135], a[28:31]
    s_add_u32 m0, s48, 62336
    v_accvgpr_write_b32 a246, v150
    v_accvgpr_write_b32 a247, v151
    v_mfma_f32_16x16x32_bf16 a[28:31], a[76:79], a[148:151], a[28:31]
    buffer_load_dwordx4 v18, s[16:19], s43 offen offset:128 lds
    v_mfma_f32_16x16x32_bf16 a[32:35], a[80:83], a[120:123], a[32:35]
    v_cvt_pk_bf16_f32 v152, v240, v241
    v_cvt_pk_bf16_f32 v153, v242, v243
    v_mfma_f32_16x16x32_bf16 a[32:35], a[84:87], a[136:139], a[32:35]
    s_add_u32 m0, s48, 63232
    v_cvt_pk_bf16_f32 v154, v244, v245
    v_cvt_pk_bf16_f32 v155, v246, v247
    v_mfma_f32_16x16x32_bf16 a[36:39], a[80:83], a[124:127], a[36:39]
    buffer_load_dwordx4 v18, s[16:19], s43 offen offset:256 lds
    v_mfma_f32_16x16x32_bf16 a[36:39], a[84:87], a[140:143], a[36:39]
    v_accvgpr_write_b32 a248, v152
    v_accvgpr_write_b32 a249, v153
    v_mfma_f32_16x16x32_bf16 a[40:43], a[80:83], a[128:131], a[40:43]
    v_accvgpr_write_b32 a250, v154
    v_accvgpr_write_b32 a251, v155
    v_mfma_f32_16x16x32_bf16 a[40:43], a[84:87], a[144:147], a[40:43]
    v_cvt_pk_bf16_f32 v156, v248, v249
    v_cvt_pk_bf16_f32 v157, v250, v251
    v_mfma_f32_16x16x32_bf16 a[44:47], a[80:83], a[132:135], a[44:47]
    v_cvt_pk_bf16_f32 v158, v252, v253
    v_cvt_pk_bf16_f32 v159, v254, v255
    v_mfma_f32_16x16x32_bf16 a[44:47], a[84:87], a[148:151], a[44:47]
    v_accvgpr_write_b32 a252, v156
    v_accvgpr_write_b32 a253, v157
    s_nop 3
    v_accvgpr_write_b32 a254, v158
    v_accvgpr_write_b32 a255, v159
    s_add_u32 s28, s80, 16777216
    s_addc_u32 s29, s81, 0
    s_mov_b32 s30, 25165824
    s_mov_b32 s31, 0x00020000
    s_mov_b32 s42, 73728
    s_mov_b32 s43, 86016
    s_mov_b32 s49, 49152
    s_mov_b32 s50, 61440
    s_lshl_b32 s45, s37, 4
    s_lshl_b32 s46, s38, 2
    s_add_u32 s45, s45, s46
    s_mul_i32 s45, s45, 49152
    v_add_u32 v52, s45, v1
    v_add_u32 v53, 49152, v52
    v_add_u32 v54, 98304, v52
    v_add_u32 v55, 147456, v52
    v_mov_b32 v56, 0xc2b669c2
    v_mov_b32 v57, 0xc1b0e49c
    v_mov_b32 v58, 0x3dd53b95
    s_cmp_lg_u32 s51, 0
    s_cbranch_scc1 L_nogelu
    s_mul_i32 s45, s36, 3
    s_add_u32 s45, s45, 0
    s_lshr_b32 s46, s45, 1
    s_lshl_b32 s46, s46, 10
    s_and_b32 s45, s45, 1
    s_lshl_b32 s45, s45, 3
    s_add_u32 s58, s45, s46
    v_accvgpr_read_b32 v216, a0
    v_accvgpr_read_b32 v217, a1
    v_accvgpr_read_b32 v218, a2
    v_accvgpr_read_b32 v219, a3
    v_accvgpr_read_b32 v220, a4
    v_accvgpr_read_b32 v221, a5
    v_accvgpr_read_b32 v222, a6
    v_accvgpr_read_b32 v223, a7
    v_accvgpr_read_b32 v224, a8
    v_accvgpr_read_b32 v225, a9
    v_accvgpr_read_b32 v226, a10
    v_accvgpr_read_b32 v227, a11
    v_accvgpr_read_b32 v228, a12
    v_accvgpr_read_b32 v229, a13
    v_accvgpr_read_b32 v230, a14
    v_accvgpr_read_b32 v231, a15
    v_mfma_f32_32x32x16_bf16 a[0:15], v[48:51], v[48:51], 0
    v_pk_mul_f32 v[232:233], v[216:217], v[216:217]
    v_pk_mul_f32 v[234:235], v[218:219], v[218:219]
    v_pk_mul_f32 v[236:237], v[220:221], v[220:221]
    v_pk_mul_f32 v[238:239], v[222:223], v[222:223]
    v_pk_mul_f32 v[240:241], v[224:225], v[224:225]
    v_pk_mul_f32 v[242:243], v[226:227], v[226:227]
    v_pk_mul_f32 v[244:245], v[228:229], v[228:229]
    v_pk_mul_f32 v[246:247], v[230:231], v[230:231]
    v_pk_fma_f32 v[232:233], v[232:233], v[56:57], v[56:57] op_sel:[0,0,1] op_sel_hi:[1,0,1]
    v_pk_fma_f32 v[234:235], v[234:235], v[56:57], v[56:57] op_sel:[0,0,1] op_sel_hi:[1,0,1]
    v_pk_fma_f32 v[236:237], v[236:237], v[56:57], v[56:57] op_sel:[0,0,1] op_sel_hi:[1,0,1]
    v_pk_fma_f32 v[238:239], v[238:239], v[56:57], v[56:57] op_sel:[0,0,1] op_sel_hi:[1,0,1]
    v_pk_fma_f32 v[240:241], v[240:241], v[56:57], v[56:57] op_sel:[0,0,1] op_sel_hi:[1,0,1]
    v_pk_fma_f32 v[242:243], v[242:243], v[56:57], v[56:57] op_sel:[0,0,1] op_sel_hi:[1,0,1]
    v_pk_fma_f32 v[244:245], v[244:245], v[56:57], v[56:57] op_sel:[0,0,1] op_sel_hi:[1,0,1]
    v_pk_fma_f32 v[246:247], v[246:247], v[56:57], v[56:57] op_sel:[0,0,1] op_sel_hi:[1,0,1]
    v_pk_mul_f32 v[232:233], v[232:233], v[216:217]
    v_pk_mul_f32 v[234:235], v[234:235], v[218:219]
    v_pk_mul_f32 v[236:237], v[236:237], v[220:221]
    v_pk_mul_f32 v[238:239], v[238:239], v[222:223]
    v_pk_mul_f32 v[240:241], v[240:241], v[224:225]
    v_pk_mul_f32 v[242:243], v[242:243], v[226:227]
    v_pk_mul_f32 v[244:245], v[244:245], v[228:229]
    v_pk_mul_f32 v[246:247], v[246:247], v[230:231]
    v_exp_f32 v232, v232
    v_exp_f32 v233, v233
    v_exp_f32 v234, v234
    v_exp_f32 v235, v235
    v_mfma_f32_32x32x16_bf16 a[176:191], v[48:51], v[48:51], 0
    v_exp_f32 v236, v236
    v_exp_f32 v237, v237
    v_exp_f32 v238, v238
    v_exp_f32 v239, v239
    v_exp_f32 v240, v240
    v_exp_f32 v241, v241
    v_mfma_f32_32x32x16_bf16 a[160:175], v[48:51], v[48:51], 0
    v_exp_f32 v242, v242
    v_exp_f32 v243, v243
    v_exp_f32 v244, v244
    v_exp_f32 v245, v245
    v_exp_f32 v246, v246
    v_exp_f32 v247, v247
    v_mfma_f32_32x32x16_bf16 a[144:159], v[48:51], v[48:51], 0
    v_pk_fma_f32 v[232:233], v[232:233], v[58:59], v[58:59] op_sel_hi:[1,0,0]
    v_pk_fma_f32 v[234:235], v[234:235], v[58:59], v[58:59] op_sel_hi:[1,0,0]
    v_pk_fma_f32 v[236:237], v[236:237], v[58:59], v[58:59] op_sel_hi:[1,0,0]
    v_pk_fma_f32 v[238:239], v[238:239], v[58:59], v[58:59] op_sel_hi:[1,0,0]
    v_pk_fma_f32 v[240:241], v[240:241], v[58:59], v[58:59] op_sel_hi:[1,0,0]
    v_pk_fma_f32 v[242:243], v[242:243], v[58:59], v[58:59] op_sel_hi:[1,0,0]
    v_pk_fma_f32 v[244:245], v[244:245], v[58:59], v[58:59] op_sel_hi:[1,0,0]
    v_pk_fma_f32 v[246:247], v[246:247], v[58:59], v[58:59] op_sel_hi:[1,0,0]
    v_rcp_f32 v232, v232
    v_rcp_f32 v233, v233
    v_rcp_f32 v234, v234
    v_rcp_f32 v235, v235
    v_mfma_f32_32x32x16_bf16 a[128:143], v[48:51], v[48:51], 0
    v_rcp_f32 v236, v236
    v_rcp_f32 v237, v237
    v_rcp_f32 v238, v238
    v_rcp_f32 v239, v239
    v_rcp_f32 v240, v240
    v_rcp_f32 v241, v241
    v_mfma_f32_32x32x16_bf16 a[112:127], v[48:51], v[48:51], 0
    v_rcp_f32 v242, v242
    v_rcp_f32 v243, v243
    v_rcp_f32 v244, v244
    v_rcp_f32 v245, v245
    v_rcp_f32 v246, v246
    v_rcp_f32 v247, v247
    v_mfma_f32_32x32x16_bf16 a[96:111], v[48:51], v[48:51], 0
    v_pk_mul_f32 v[216:217], v[232:233], v[216:217]
    v_pk_mul_f32 v[218:219], v[234:235], v[218:219]
    v_pk_mul_f32 v[220:221], v[236:237], v[220:221]
    v_pk_mul_f32 v[222:223], v[238:239], v[222:223]
    v_pk_mul_f32 v[224:225], v[240:241], v[224:225]
    v_pk_mul_f32 v[226:227], v[242:243], v[226:227]
    v_pk_mul_f32 v[228:229], v[244:245], v[228:229]
    v_pk_mul_f32 v[230:231], v[246:247], v[230:231]
    v_cvt_pk_bf16_f32 v192, v216, v217
    v_cvt_pk_bf16_f32 v193, v218, v219
    v_cvt_pk_bf16_f32 v194, v220, v221
    v_cvt_pk_bf16_f32 v195, v222, v223
    v_cvt_pk_bf16_f32 v196, v224, v225
    v_cvt_pk_bf16_f32 v197, v226, v227
    v_cvt_pk_bf16_f32 v198, v228, v229
    v_cvt_pk_bf16_f32 v199, v230, v231
    buffer_store_dwordx2 v[192:193], v52, s[24:27], s58 offen sc1
    buffer_store_dwordx2 v[194:195], v53, s[24:27], s58 offen sc1
    buffer_store_dwordx2 v[196:197], v54, s[24:27], s58 offen sc1
    buffer_store_dwordx2 v[198:199], v55, s[24:27], s58 offen sc1
    s_mul_i32 s45, s36, 3
    s_add_u32 s45, s45, 1
    s_lshr_b32 s46, s45, 1
    s_lshl_b32 s46, s46, 10
    s_and_b32 s45, s45, 1
    s_lshl_b32 s45, s45, 3
    s_add_u32 s58, s45, s46
    v_accvgpr_read_b32 v216, a16
    v_accvgpr_read_b32 v217, a17
    v_accvgpr_read_b32 v218, a18
    v_accvgpr_read_b32 v219, a19
    v_accvgpr_read_b32 v220, a20
    v_accvgpr_read_b32 v221, a21
    v_accvgpr_read_b32 v222, a22
    v_accvgpr_read_b32 v223, a23
    v_accvgpr_read_b32 v224, a24
    v_accvgpr_read_b32 v225, a25
    v_accvgpr_read_b32 v226, a26
    v_accvgpr_read_b32 v227, a27
    v_accvgpr_read_b32 v228, a28
    v_accvgpr_read_b32 v229, a29
    v_accvgpr_read_b32 v230, a30
    v_accvgpr_read_b32 v231, a31
    v_mfma_f32_32x32x16_bf16 a[16:31], v[48:51], v[48:51], 0
    v_pk_mul_f32 v[232:233], v[216:217], v[216:217]
    v_pk_mul_f32 v[234:235], v[218:219], v[218:219]
    v_pk_mul_f32 v[236:237], v[220:221], v[220:221]
    v_pk_mul_f32 v[238:239], v[222:223], v[222:223]
    v_pk_mul_f32 v[240:241], v[224:225], v[224:225]
    v_pk_mul_f32 v[242:243], v[226:227], v[226:227]
    v_pk_mul_f32 v[244:245], v[228:229], v[228:229]
    v_pk_mul_f32 v[246:247], v[230:231], v[230:231]
    v_pk_fma_f32 v[232:233], v[232:233], v[56:57], v[56:57] op_sel:[0,0,1] op_sel_hi:[1,0,1]
    v_pk_fma_f32 v[234:235], v[234:235], v[56:57], v[56:57] op_sel:[0,0,1] op_sel_hi:[1,0,1]
    v_pk_fma_f32 v[236:237], v[236:237], v[56:57], v[56:57] op_sel:[0,0,1] op_sel_hi:[1,0,1]
    v_pk_fma_f32 v[238:239], v[238:239], v[56:57], v[56:57] op_sel:[0,0,1] op_sel_hi:[1,0,1]
    v_pk_fma_f32 v[240:241], v[240:241], v[56:57], v[56:57] op_sel:[0,0,1] op_sel_hi:[1,0,1]
    v_pk_fma_f32 v[242:243], v[242:243], v[56:57], v[56:57] op_sel:[0,0,1] op_sel_hi:[1,0,1]
    v_pk_fma_f32 v[244:245], v[244:245], v[56:57], v[56:57] op_sel:[0,0,1] op_sel_hi:[1,0,1]
    v_pk_fma_f32 v[246:247], v[246:247], v[56:57], v[56:57] op_sel:[0,0,1] op_sel_hi:[1,0,1]
    v_pk_mul_f32 v[232:233], v[232:233], v[216:217]
    v_pk_mul_f32 v[234:235], v[234:235], v[218:219]
    v_pk_mul_f32 v[236:237], v[236:237], v[220:221]
    v_pk_mul_f32 v[238:239], v[238:239], v[222:223]
    v_pk_mul_f32 v[240:241], v[240:241], v[224:225]
    v_pk_mul_f32 v[242:243], v[242:243], v[226:227]
    v_pk_mul_f32 v[244:245], v[244:245], v[228:229]
    v_pk_mul_f32 v[246:247], v[246:247], v[230:231]
    v_exp_f32 v232, v232
    v_exp_f32 v233, v233
    v_exp_f32 v234, v234
    v_exp_f32 v235, v235
    v_mfma_f32_32x32x16_bf16 a[80:95], v[48:51], v[48:51], 0
    v_exp_f32 v236, v236
    v_exp_f32 v237, v237
    v_exp_f32 v238, v238
    v_exp_f32 v239, v239
    v_exp_f32 v240, v240
    v_exp_f32 v241, v241
    v_mfma_f32_32x32x16_bf16 a[64:79], v[48:51], v[48:51], 0
    v_exp_f32 v242, v242
    v_exp_f32 v243, v243
    v_exp_f32 v244, v244
    v_exp_f32 v245, v245
    v_exp_f32 v246, v246
    v_exp_f32 v247, v247
    v_mfma_f32_32x32x16_bf16 a[48:63], v[48:51], v[48:51], 0
    v_pk_fma_f32 v[232:233], v[232:233], v[58:59], v[58:59] op_sel_hi:[1,0,0]
    v_pk_fma_f32 v[234:235], v[234:235], v[58:59], v[58:59] op_sel_hi:[1,0,0]
    v_pk_fma_f32 v[236:237], v[236:237], v[58:59], v[58:59] op_sel_hi:[1,0,0]
    v_pk_fma_f32 v[238:239], v[238:239], v[58:59], v[58:59] op_sel_hi:[1,0,0]
    v_pk_fma_f32 v[240:241], v[240:241], v[58:59], v[58:59] op_sel_hi:[1,0,0]
    v_pk_fma_f32 v[242:243], v[242:243], v[58:59], v[58:59] op_sel_hi:[1,0,0]
    v_pk_fma_f32 v[244:245], v[244:245], v[58:59], v[58:59] op_sel_hi:[1,0,0]
    v_pk_fma_f32 v[246:247], v[246:247], v[58:59], v[58:59] op_sel_hi:[1,0,0]
    v_rcp_f32 v232, v232
    v_rcp_f32 v233, v233
    v_rcp_f32 v234, v234
    v_rcp_f32 v235, v235
    v_rcp_f32 v236, v236
    v_rcp_f32 v237, v237
    v_rcp_f32 v238, v238
    v_rcp_f32 v239, v239
    v_rcp_f32 v240, v240
    v_rcp_f32 v241, v241
    v_rcp_f32 v242, v242
    v_rcp_f32 v243, v243
    v_rcp_f32 v244, v244
    v_rcp_f32 v245, v245
    v_rcp_f32 v246, v246
    v_rcp_f32 v247, v247
    v_pk_mul_f32 v[216:217], v[232:233], v[216:217]
    v_pk_mul_f32 v[218:219], v[234:235], v[218:219]
    v_pk_mul_f32 v[220:221], v[236:237], v[220:221]
    v_pk_mul_f32 v[222:223], v[238:239], v[222:223]
    v_pk_mul_f32 v[224:225], v[240:241], v[224:225]
    v_pk_mul_f32 v[226:227], v[242:243], v[226:227]
    v_pk_mul_f32 v[228:229], v[244:245], v[228:229]
    v_pk_mul_f32 v[230:231], v[246:247], v[230:231]
    v_cvt_pk_bf16_f32 v200, v216, v217
    v_cvt_pk_bf16_f32 v201, v218, v219
    v_cvt_pk_bf16_f32 v202, v220, v221
    v_cvt_pk_bf16_f32 v203, v222, v223
    v_cvt_pk_bf16_f32 v204, v224, v225
    v_cvt_pk_bf16_f32 v205, v226, v227
    v_cvt_pk_bf16_f32 v206, v228, v229
    v_cvt_pk_bf16_f32 v207, v230, v231
    buffer_store_dwordx2 v[200:201], v52, s[24:27], s58 offen sc1
    buffer_store_dwordx2 v[202:203], v53, s[24:27], s58 offen sc1
    buffer_store_dwordx2 v[204:205], v54, s[24:27], s58 offen sc1
    buffer_store_dwordx2 v[206:207], v55, s[24:27], s58 offen sc1
L_nogelu:
    v_lshrrev_b32 v33, 3, v31
    v_mul_u32_u24 v33, 3072, v33
    v_lshl_add_u32 v33, v26, 7, v33
    v_lshrrev_b32 v34, 1, v31
    v_xor_b32 v34, v34, v28
    v_lshl_add_u32 v12, v34, 4, v33
    v_xor_b32 v13, 64, v12
    v_mov_b32 v6, v12
    v_mov_b32 v7, v13
    v_lshrrev_b32 v33, 1, v28
    v_mul_u32_u24 v33, 3072, v33
    v_add_u32 v33, 73728, v33
    v_and_b32 v34, 1, v28
    v_lshl_add_u32 v34, v34, 2, v29
    v_lshl_add_u32 v33, v34, 7, v33
    v_and_b32 v35, 1, v30
    v_lshl_add_u32 v33, v35, 3, v33
    v_lshrrev_b32 v35, 1, v30
    v_lshl_add_u32 v33, v35, 4, v33
    v_lshrrev_b32 v34, 1, v34
    v_lshl_add_u32 v14, v34, 5, v33
    v_xor_b32 v15, 32, v14
    v_xor_b32 v16, 64, v14
    v_xor_b32 v17, 96, v14
    v_mov_b32 v34, 159744
    ds_write_b32 v34, v36
    s_lshl_b32 s45, s38, 5
    v_xor_b32 v33, s45, v14
    v_add_u32 v33, 73728, v33
    s_lshr_b32 s45, s2, 3
    s_or_b32 s45, s45, s38
    s_cmp_eq_u32 s45, 0
    s_cselect_b32 s3, 7, 3
    s_mov_b32 s59, 0
    s_cmp_eq_u32 s51, 0
    s_cselect_b32 s39, 19, 3
    s_mov_b32 s101, 128
    s_mov_b32 s90, 0
    s_sub_u32 s97, s97, 4096
    s_cmp_eq_u32 s51, 0
    v_mov_b32 v2, 0
    v_mov_b32 v20, 0xff800000
    v_mov_b32 v3, 0
    v_mov_b32 v21, 0xff800000
    v_mov_b32 v4, 0
    v_mov_b32 v22, 0xff800000
    v_mov_b32 v5, 0
    v_mov_b32 v23, 0xff800000
    s_cbranch_scc0 L_maxfirst
    s_mul_i32 s45, s36, 3
    s_add_u32 s45, s45, 2
    s_lshr_b32 s46, s45, 1
    s_lshl_b32 s46, s46, 10
    s_and_b32 s45, s45, 1
    s_lshl_b32 s45, s45, 3
    s_add_u32 s58, s45, s46
    v_accvgpr_read_b32 v216, a32
    v_accvgpr_read_b32 v217, a33
    v_accvgpr_read_b32 v218, a34
    v_accvgpr_read_b32 v219, a35
    v_accvgpr_read_b32 v220, a36
    v_accvgpr_read_b32 v221, a37
    v_accvgpr_read_b32 v222, a38
    v_accvgpr_read_b32 v223, a39
    v_accvgpr_read_b32 v224, a40
    v_accvgpr_read_b32 v225, a41
    v_accvgpr_read_b32 v226, a42
    v_accvgpr_read_b32 v227, a43
    v_accvgpr_read_b32 v228, a44
    v_accvgpr_read_b32 v229, a45
    v_accvgpr_read_b32 v230, a46
    v_accvgpr_read_b32 v231, a47
    v_mfma_f32_32x32x16_bf16 a[32:47], v[48:51], v[48:51], 0
    ds_read_b128 a[192:195], v6 offset:0
    ds_read_b128 a[196:199], v7 offset:0
    ds_read_b128 a[200:203], v6 offset:1024
    ds_read_b128 a[204:207], v7 offset:1024
    ds_read_b128 a[208:211], v6 offset:2048
    ds_read_b128 a[212:215], v7 offset:2048
    s_waitcnt lgkmcnt(4)
    v_mfma_f32_16x16x32_bf16 v[128:131], a[192:195], v[64:67], 0
    v_mul_f32 v232, v216, v216
    v_mul_f32 v233, v217, v217
    v_mfma_f32_16x16x32_bf16 v[128:131], a[196:199], v[80:83], v[128:131]
    v_mul_f32 v234, v218, v218
    v_mul_f32 v235, v219, v219
    v_mfma_f32_16x16x32_bf16 v[132:135], a[192:195], v[68:71], 0
    v_mul_f32 v236, v220, v220
    v_mul_f32 v237, v221, v221
    v_mfma_f32_16x16x32_bf16 v[132:135], a[196:199], v[84:87], v[132:135]
    v_mul_f32 v238, v222, v222
    v_mul_f32 v239, v223, v223
    v_mfma_f32_16x16x32_bf16 v[136:139], a[192:195], v[72:75], 0
    v_mul_f32 v240, v224, v224
    v_mul_f32 v241, v225, v225
    v_mfma_f32_16x16x32_bf16 v[136:139], a[196:199], v[88:91], v[136:139]
    v_mul_f32 v242, v226, v226
    v_mul_f32 v243, v227, v227
    v_mfma_f32_16x16x32_bf16 v[140:143], a[192:195], v[76:79], 0
    v_mul_f32 v244, v228, v228
    v_mul_f32 v245, v229, v229
    v_mfma_f32_16x16x32_bf16 v[140:143], a[196:199], v[92:95], v[140:143]
    s_waitcnt lgkmcnt(2)
    v_mul_f32 v246, v230, v230
    v_mul_f32 v247, v231, v231
    v_mfma_f32_16x16x32_bf16 v[128:131], a[200:203], v[96:99], v[128:131]
    ds_read_b128 a[216:219], v6 offset:6144
    v_fma_f32 v232, v232, v56, v57
    v_mfma_f32_16x16x32_bf16 v[128:131], a[204:207], v[112:115], v[128:131]
    ds_read_b128 a[220:223], v7 offset:6144
    v_fma_f32 v233, v233, v56, v57
    v_mfma_f32_16x16x32_bf16 v[132:135], a[200:203], v[100:103], v[132:135]
    v_fma_f32 v234, v234, v56, v57
    v_fma_f32 v235, v235, v56, v57
    v_mfma_f32_16x16x32_bf16 v[132:135], a[204:207], v[116:119], v[132:135]
    v_fma_f32 v236, v236, v56, v57
    v_fma_f32 v237, v237, v56, v57
    v_mfma_f32_16x16x32_bf16 v[136:139], a[200:203], v[104:107], v[136:139]
    v_fma_f32 v238, v238, v56, v57
    v_fma_f32 v239, v239, v56, v57
    v_mfma_f32_16x16x32_bf16 v[136:139], a[204:207], v[120:123], v[136:139]
    v_fma_f32 v240, v240, v56, v57
    v_fma_f32 v241, v241, v56, v57
    v_mfma_f32_16x16x32_bf16 v[140:143], a[200:203], v[108:111], v[140:143]
    v_fma_f32 v242, v242, v56, v57
    v_fma_f32 v243, v243, v56, v57
    v_mfma_f32_16x16x32_bf16 v[140:143], a[204:207], v[124:127], v[140:143]
    s_waitcnt lgkmcnt(2)
    v_fma_f32 v244, v244, v56, v57
    v_fma_f32 v245, v245, v56, v57
    v_mfma_f32_16x16x32_bf16 v[128:131], a[208:211], a[224:227], v[128:131]
    ds_read_b128 a[192:195], v6 offset:7168
    v_fma_f32 v246, v246, v56, v57
    v_mfma_f32_16x16x32_bf16 v[128:131], a[212:215], a[240:243], v[128:131]
    ds_read_b128 a[196:199], v7 offset:7168
    v_fma_f32 v247, v247, v56, v57
    v_mfma_f32_16x16x32_bf16 v[132:135], a[208:211], a[228:231], v[132:135]
    v_mul_f32 v232, v232, v216
    v_mul_f32 v233, v233, v217
    v_mfma_f32_16x16x32_bf16 v[132:135], a[212:215], a[244:247], v[132:135]
    v_mul_f32 v234, v234, v218
    v_mul_f32 v235, v235, v219
    v_mfma_f32_16x16x32_bf16 v[136:139], a[208:211], a[232:235], v[136:139]
    v_mul_f32 v236, v236, v220
    v_mul_f32 v237, v237, v221
    v_mfma_f32_16x16x32_bf16 v[136:139], a[212:215], a[248:251], v[136:139]
    v_mul_f32 v238, v238, v222
    v_mul_f32 v239, v239, v223
    v_mfma_f32_16x16x32_bf16 v[140:143], a[208:211], a[236:239], v[140:143]
    v_mul_f32 v240, v240, v224
    v_mul_f32 v241, v241, v225
    v_mfma_f32_16x16x32_bf16 v[140:143], a[212:215], a[252:255], v[140:143]
    s_waitcnt lgkmcnt(2)
    v_mul_f32 v242, v242, v226
    v_mul_f32 v243, v243, v227
    v_mfma_f32_16x16x32_bf16 v[144:147], a[216:219], v[64:67], 0
    ds_read_b128 a[200:203], v6 offset:8192
    v_mul_f32 v244, v244, v228
    v_mfma_f32_16x16x32_bf16 v[144:147], a[220:223], v[80:83], v[144:147]
    ds_read_b128 a[204:207], v7 offset:8192
    v_mul_f32 v245, v245, v229
    v_mfma_f32_16x16x32_bf16 v[148:151], a[216:219], v[68:71], 0
    v_mul_f32 v246, v246, v230
    v_mul_f32 v247, v247, v231
    v_mfma_f32_16x16x32_bf16 v[148:151], a[220:223], v[84:87], v[148:151]
    v_exp_f32 v232, v232
    v_mfma_f32_16x16x32_bf16 v[152:155], a[216:219], v[72:75], 0
    v_exp_f32 v233, v233
    v_mfma_f32_16x16x32_bf16 v[152:155], a[220:223], v[88:91], v[152:155]
    v_exp_f32 v234, v234
    v_mfma_f32_16x16x32_bf16 v[156:159], a[216:219], v[76:79], 0
    v_exp_f32 v235, v235
    v_mfma_f32_16x16x32_bf16 v[156:159], a[220:223], v[92:95], v[156:159]
    s_waitcnt lgkmcnt(2)
    v_exp_f32 v236, v236
    v_mfma_f32_16x16x32_bf16 v[144:147], a[192:195], v[96:99], v[144:147]
    ds_read_b128 a[208:211], v6 offset:12288
    v_max3_f32 v20, v20, v128, v129
    v_mfma_f32_16x16x32_bf16 v[144:147], a[196:199], v[112:115], v[144:147]
    ds_read_b128 a[212:215], v7 offset:12288
    v_max3_f32 v20, v20, v130, v131
    v_mfma_f32_16x16x32_bf16 v[148:151], a[192:195], v[100:103], v[148:151]
    v_max3_f32 v21, v21, v132, v133
    v_max3_f32 v21, v21, v134, v135
    v_mfma_f32_16x16x32_bf16 v[148:151], a[196:199], v[116:119], v[148:151]
    v_max3_f32 v22, v22, v136, v137
    v_max3_f32 v22, v22, v138, v139
    v_mfma_f32_16x16x32_bf16 v[152:155], a[192:195], v[104:107], v[152:155]
    v_max3_f32 v23, v23, v140, v141
    v_max3_f32 v23, v23, v142, v143
    v_mfma_f32_16x16x32_bf16 v[152:155], a[196:199], v[120:123], v[152:155]
    v_exp_f32 v237, v237
    v_mfma_f32_16x16x32_bf16 v[156:159], a[192:195], v[108:111], v[156:159]
    v_exp_f32 v238, v238
    v_mfma_f32_16x16x32_bf16 v[156:159], a[196:199], v[124:127], v[156:159]
    s_waitcnt lgkmcnt(2)
    v_exp_f32 v239, v239
    v_mfma_f32_16x16x32_bf16 v[144:147], a[200:203], a[224:227], v[144:147]
    ds_read_b128 a[216:219], v6 offset:13312
    v_mfma_f32_16x16x32_bf16 v[144:147], a[204:207], a[240:243], v[144:147]
    ds_read_b128 a[220:223], v7 offset:13312
    v_mfma_f32_16x16x32_bf16 v[148:151], a[200:203], a[228:231], v[148:151]
    v_exp_f32 v240, v240
    v_mfma_f32_16x16x32_bf16 v[148:151], a[204:207], a[244:247], v[148:151]
    v_exp_f32 v241, v241
    v_mfma_f32_16x16x32_bf16 v[152:155], a[200:203], a[232:235], v[152:155]
    v_exp_f32 v242, v242
    v_mfma_f32_16x16x32_bf16 v[152:155], a[204:207], a[248:251], v[152:155]
    v_exp_f32 v243, v243
    v_mfma_f32_16x16x32_bf16 v[156:159], a[200:203], a[236:239], v[156:159]
    v_exp_f32 v244, v244
    v_mfma_f32_16x16x32_bf16 v[156:159], a[204:207], a[252:255], v[156:159]
    s_waitcnt lgkmcnt(2)
    v_exp_f32 v245, v245
    v_mfma_f32_16x16x32_bf16 v[160:163], a[208:211], v[64:67], 0
    ds_read_b128 a[192:195], v6 offset:14336
    v_mfma_f32_16x16x32_bf16 v[160:163], a[212:215], v[80:83], v[160:163]
    ds_read_b128 a[196:199], v7 offset:14336
    v_mfma_f32_16x16x32_bf16 v[164:167], a[208:211], v[68:71], 0
    v_exp_f32 v246, v246
    v_mfma_f32_16x16x32_bf16 v[164:167], a[212:215], v[84:87], v[164:167]
    v_exp_f32 v247, v247
    v_mfma_f32_16x16x32_bf16 v[168:171], a[208:211], v[72:75], 0
    v_fma_f32 v232, v232, v58, v58
    v_fma_f32 v233, v233, v58, v58
    v_mfma_f32_16x16x32_bf16 v[168:171], a[212:215], v[88:91], v[168:171]
    v_fma_f32 v234, v234, v58, v58
    v_fma_f32 v235, v235, v58, v58
    v_mfma_f32_16x16x32_bf16 v[172:175], a[208:211], v[76:79], 0
    v_fma_f32 v236, v236, v58, v58
    v_fma_f32 v237, v237, v58, v58
    v_mfma_f32_16x16x32_bf16 v[172:175], a[212:215], v[92:95], v[172:175]
    s_waitcnt lgkmcnt(2)
    v_fma_f32 v238, v238, v58, v58
    v_fma_f32 v239, v239, v58, v58
    v_mfma_f32_16x16x32_bf16 v[160:163], a[216:219], v[96:99], v[160:163]
    ds_read_b128 a[200:203], v6 offset:18432
    v_max3_f32 v20, v20, v144, v145
    v_mfma_f32_16x16x32_bf16 v[160:163], a[220:223], v[112:115], v[160:163]
    ds_read_b128 a[204:207], v7 offset:18432
    v_max3_f32 v20, v20, v146, v147
    v_mfma_f32_16x16x32_bf16 v[164:167], a[216:219], v[100:103], v[164:167]
    v_max3_f32 v21, v21, v148, v149
    v_max3_f32 v21, v21, v150, v151
    v_mfma_f32_16x16x32_bf16 v[164:167], a[220:223], v[116:119], v[164:167]
    v_max3_f32 v22, v22, v152, v153
    v_max3_f32 v22, v22, v154, v155
    v_mfma_f32_16x16x32_bf16 v[168:171], a[216:219], v[104:107], v[168:171]
    v_max3_f32 v23, v23, v156, v157
    v_max3_f32 v23, v23, v158, v159
    v_mfma_f32_16x16x32_bf16 v[168:171], a[220:223], v[120:123], v[168:171]
    v_fma_f32 v240, v240, v58, v58
    v_fma_f32 v241, v241, v58, v58
    v_mfma_f32_16x16x32_bf16 v[172:175], a[216:219], v[108:111], v[172:175]
    v_fma_f32 v242, v242, v58, v58
    v_fma_f32 v243, v243, v58, v58
    v_mfma_f32_16x16x32_bf16 v[172:175], a[220:223], v[124:127], v[172:175]
    s_waitcnt lgkmcnt(2)
    v_fma_f32 v244, v244, v58, v58
    v_fma_f32 v245, v245, v58, v58
    v_mfma_f32_16x16x32_bf16 v[160:163], a[192:195], a[224:227], v[160:163]
    ds_read_b128 a[208:211], v6 offset:19456
    v_fma_f32 v246, v246, v58, v58
    v_mfma_f32_16x16x32_bf16 v[160:163], a[196:199], a[240:243], v[160:163]
    ds_read_b128 a[212:215], v7 offset:19456
    v_fma_f32 v247, v247, v58, v58
    v_mfma_f32_16x16x32_bf16 v[164:167], a[192:195], a[228:231], v[164:167]
    v_rcp_f32 v232, v232
    v_mfma_f32_16x16x32_bf16 v[164:167], a[196:199], a[244:247], v[164:167]
    v_rcp_f32 v233, v233
    v_mfma_f32_16x16x32_bf16 v[168:171], a[192:195], a[232:235], v[168:171]
    v_rcp_f32 v234, v234
    v_mfma_f32_16x16x32_bf16 v[168:171], a[196:199], a[248:251], v[168:171]
    v_rcp_f32 v235, v235
    v_mfma_f32_16x16x32_bf16 v[172:175], a[192:195], a[236:239], v[172:175]
    v_rcp_f32 v236, v236
    v_mfma_f32_16x16x32_bf16 v[172:175], a[196:199], a[252:255], v[172:175]
    s_waitcnt lgkmcnt(2)
    v_rcp_f32 v237, v237
    v_mfma_f32_16x16x32_bf16 v[176:179], a[200:203], v[64:67], 0
    ds_read_b128 a[216:219], v6 offset:20480
    v_mfma_f32_16x16x32_bf16 v[176:179], a[204:207], v[80:83], v[176:179]
    ds_read_b128 a[220:223], v7 offset:20480
    v_mfma_f32_16x16x32_bf16 v[180:183], a[200:203], v[68:71], 0
    v_rcp_f32 v238, v238
    v_mfma_f32_16x16x32_bf16 v[180:183], a[204:207], v[84:87], v[180:183]
    v_rcp_f32 v239, v239
    v_mfma_f32_16x16x32_bf16 v[184:187], a[200:203], v[72:75], 0
    v_rcp_f32 v240, v240
    v_mfma_f32_16x16x32_bf16 v[184:187], a[204:207], v[88:91], v[184:187]
    v_rcp_f32 v241, v241
    v_mfma_f32_16x16x32_bf16 v[188:191], a[200:203], v[76:79], 0
    v_rcp_f32 v242, v242
    v_mfma_f32_16x16x32_bf16 v[188:191], a[204:207], v[92:95], v[188:191]
    s_waitcnt lgkmcnt(2)
    v_rcp_f32 v243, v243
    v_mfma_f32_16x16x32_bf16 v[176:179], a[208:211], v[96:99], v[176:179]
    v_max3_f32 v20, v20, v160, v161
    v_max3_f32 v20, v20, v162, v163
    v_mfma_f32_16x16x32_bf16 v[176:179], a[212:215], v[112:115], v[176:179]
    v_max3_f32 v21, v21, v164, v165
    v_max3_f32 v21, v21, v166, v167
    v_mfma_f32_16x16x32_bf16 v[180:183], a[208:211], v[100:103], v[180:183]
    v_max3_f32 v22, v22, v168, v169
    v_max3_f32 v22, v22, v170, v171
    v_mfma_f32_16x16x32_bf16 v[180:183], a[212:215], v[116:119], v[180:183]
    v_max3_f32 v23, v23, v172, v173
    v_max3_f32 v23, v23, v174, v175
    v_mfma_f32_16x16x32_bf16 v[184:187], a[208:211], v[104:107], v[184:187]
    v_rcp_f32 v244, v244
    v_mfma_f32_16x16x32_bf16 v[184:187], a[212:215], v[120:123], v[184:187]
    v_rcp_f32 v245, v245
    v_mfma_f32_16x16x32_bf16 v[188:191], a[208:211], v[108:111], v[188:191]
    v_rcp_f32 v246, v246
    v_mfma_f32_16x16x32_bf16 v[188:191], a[212:215], v[124:127], v[188:191]
    s_waitcnt lgkmcnt(0)
    v_rcp_f32 v247, v247
    v_mfma_f32_16x16x32_bf16 v[176:179], a[216:219], a[224:227], v[176:179]
    v_mul_f32 v216, v232, v216
    v_mul_f32 v217, v233, v217
    v_mfma_f32_16x16x32_bf16 v[176:179], a[220:223], a[240:243], v[176:179]
    v_mul_f32 v218, v234, v218
    v_mul_f32 v219, v235, v219
    v_mfma_f32_16x16x32_bf16 v[180:183], a[216:219], a[228:231], v[180:183]
    v_mul_f32 v220, v236, v220
    v_mul_f32 v221, v237, v221
    v_mfma_f32_16x16x32_bf16 v[180:183], a[220:223], a[244:247], v[180:183]
    v_mul_f32 v222, v238, v222
    v_mul_f32 v223, v239, v223
    v_mfma_f32_16x16x32_bf16 v[184:187], a[216:219], a[232:235], v[184:187]
    v_mul_f32 v224, v240, v224
    v_mul_f32 v225, v241, v225
    v_mfma_f32_16x16x32_bf16 v[184:187], a[220:223], a[248:251], v[184:187]
    v_mul_f32 v226, v242, v226
    v_mul_f32 v227, v243, v227
    v_mfma_f32_16x16x32_bf16 v[188:191], a[216:219], a[236:239], v[188:191]
    v_mul_f32 v228, v244, v228
    v_mul_f32 v229, v245, v229
    v_mfma_f32_16x16x32_bf16 v[188:191], a[220:223], a[252:255], v[188:191]
    v_mul_f32 v230, v246, v230
    v_mul_f32 v231, v247, v231
    v_cvt_pk_bf16_f32 v208, v216, v217
    v_cvt_pk_bf16_f32 v209, v218, v219
    v_cvt_pk_bf16_f32 v210, v220, v221
    v_cvt_pk_bf16_f32 v211, v222, v223
    v_cvt_pk_bf16_f32 v212, v224, v225
    v_cvt_pk_bf16_f32 v213, v226, v227
    v_cvt_pk_bf16_f32 v214, v228, v229
    v_cvt_pk_bf16_f32 v215, v230, v231
    buffer_store_dwordx2 v[208:209], v52, s[24:27], s58 offen sc1
    buffer_store_dwordx2 v[210:211], v53, s[24:27], s58 offen sc1
    buffer_store_dwordx2 v[212:213], v54, s[24:27], s58 offen sc1
    buffer_store_dwordx2 v[214:215], v55, s[24:27], s58 offen sc1
    s_waitcnt vmcnt(24)
    s_barrier
    s_cmp_lg_u32 s59, 0
    v_add_u32 v6, 24576, v12
    v_add_u32 v7, 24576, v13
    s_nop 1
    v_max3_f32 v20, v20, v176, v177
    v_max3_f32 v20, v20, v178, v179
    v_max3_f32 v21, v21, v180, v181
    v_max3_f32 v21, v21, v182, v183
    v_max3_f32 v22, v22, v184, v185
    v_max3_f32 v22, v22, v186, v187
    v_max3_f32 v23, v23, v188, v189
    v_max3_f32 v23, v23, v190, v191
L_qkdone:
    ds_read_b128 a[192:195], v6 offset:0
    ds_read_b128 a[196:199], v7 offset:0
    ds_read_b128 a[200:203], v6 offset:1024
    ds_read_b128 a[204:207], v7 offset:1024
    v_mov_b32 v24, v20
    v_mov_b32 v25, v21
    s_nop 0
    v_mov_b32 v26, v22
    v_mov_b32 v27, v23
    s_nop 0
    v_permlane32_swap_b32 v20, v24
    v_permlane32_swap_b32 v21, v25
    s_nop 0
    v_permlane32_swap_b32 v22, v26
    v_permlane32_swap_b32 v23, v27
    s_nop 0
    v_max_f32 v20, v20, v24
    v_max_f32 v21, v21, v25
    s_nop 0
    v_max_f32 v22, v22, v26
    v_max_f32 v23, v23, v27
    s_nop 0
    v_mov_b32 v24, v20
    v_mov_b32 v25, v21
    s_nop 0
    v_mov_b32 v26, v22
    v_mov_b32 v27, v23
    s_nop 0
    v_permlane16_swap_b32 v20, v24
    v_permlane16_swap_b32 v21, v25
    s_nop 0
    v_permlane16_swap_b32 v22, v26
    v_permlane16_swap_b32 v23, v27
    s_nop 0
    v_max_f32 v20, v20, v24
    v_max_f32 v21, v21, v25
    s_nop 0
    v_max_f32 v22, v22, v26
    v_max_f32 v23, v23, v27
    s_nop 0
    s_cmp_eq_u32 s51, 0
    s_cselect_b32 s45, 0xc2cc0000, 0
    v_sub_f32 v40, s45, v20
    v_sub_f32 v44, s45, v21
    v_sub_f32 v48, s45, v22
    v_sub_f32 v52, s45, v23
    v_mov_b32 v41, v40
    v_mov_b32 v42, v40
    v_mov_b32 v43, v40
    v_mov_b32 v45, v44
    v_mov_b32 v46, v44
    v_mov_b32 v47, v44
    v_mov_b32 v49, v48
    v_mov_b32 v50, v48
    v_mov_b32 v51, v48
    v_mov_b32 v53, v52
    v_mov_b32 v54, v52
    v_mov_b32 v55, v52
    v_pk_add_f32 v[128:129], v[128:129], v[40:41]
    v_pk_add_f32 v[130:131], v[130:131], v[40:41]
    v_pk_add_f32 v[132:133], v[132:133], v[44:45]
    v_pk_add_f32 v[134:135], v[134:135], v[44:45]
    v_pk_add_f32 v[136:137], v[136:137], v[48:49]
    v_pk_add_f32 v[138:139], v[138:139], v[48:49]
    v_pk_add_f32 v[140:141], v[140:141], v[52:53]
    v_pk_add_f32 v[142:143], v[142:143], v[52:53]
    v_pk_add_f32 v[144:145], v[144:145], v[40:41]
    v_pk_add_f32 v[146:147], v[146:147], v[40:41]
    v_pk_add_f32 v[148:149], v[148:149], v[44:45]
    v_pk_add_f32 v[150:151], v[150:151], v[44:45]
    v_pk_add_f32 v[152:153], v[152:153], v[48:49]
    v_pk_add_f32 v[154:155], v[154:155], v[48:49]
    v_pk_add_f32 v[156:157], v[156:157], v[52:53]
    v_pk_add_f32 v[158:159], v[158:159], v[52:53]
    v_pk_add_f32 v[160:161], v[160:161], v[40:41]
    v_pk_add_f32 v[162:163], v[162:163], v[40:41]
    v_pk_add_f32 v[164:165], v[164:165], v[44:45]
    v_pk_add_f32 v[166:167], v[166:167], v[44:45]
    v_pk_add_f32 v[168:169], v[168:169], v[48:49]
    v_pk_add_f32 v[170:171], v[170:171], v[48:49]
    v_pk_add_f32 v[172:173], v[172:173], v[52:53]
    v_pk_add_f32 v[174:175], v[174:175], v[52:53]
    v_pk_add_f32 v[176:177], v[176:177], v[40:41]
    v_pk_add_f32 v[178:179], v[178:179], v[40:41]
    v_pk_add_f32 v[180:181], v[180:181], v[44:45]
    v_pk_add_f32 v[182:183], v[182:183], v[44:45]
    v_pk_add_f32 v[184:185], v[184:185], v[48:49]
    v_pk_add_f32 v[186:187], v[186:187], v[48:49]
    v_pk_add_f32 v[188:189], v[188:189], v[52:53]
    v_pk_add_f32 v[190:191], v[190:191], v[52:53]
    v_exp_f32 v128, v128
    v_exp_f32 v129, v129
    v_exp_f32 v130, v130
    v_exp_f32 v131, v131
    v_exp_f32 v132, v132
    v_exp_f32 v133, v133
    v_exp_f32 v134, v134
    v_exp_f32 v135, v135
    v_exp_f32 v136, v136
    v_exp_f32 v137, v137
    v_exp_f32 v138, v138
    v_exp_f32 v139, v139
    v_exp_f32 v140, v140
    v_exp_f32 v141, v141
    v_exp_f32 v142, v142
    v_exp_f32 v143, v143
    v_exp_f32 v144, v144
    v_exp_f32 v145, v145
    v_exp_f32 v146, v146
    v_exp_f32 v147, v147
    v_exp_f32 v148, v148
    v_exp_f32 v149, v149
    v_exp_f32 v150, v150
    v_exp_f32 v151, v151
    v_exp_f32 v152, v152
    v_exp_f32 v153, v153
    v_exp_f32 v154, v154
    v_exp_f32 v155, v155
    v_exp_f32 v156, v156
    v_exp_f32 v157, v157
    v_exp_f32 v158, v158
    v_exp_f32 v159, v159
    v_exp_f32 v160, v160
    v_exp_f32 v161, v161
    v_exp_f32 v162, v162
    v_exp_f32 v163, v163
    v_exp_f32 v164, v164
    v_exp_f32 v165, v165
    v_exp_f32 v166, v166
    v_exp_f32 v167, v167
    v_exp_f32 v168, v168
    v_exp_f32 v169, v169
    v_exp_f32 v170, v170
    v_exp_f32 v171, v171
    v_exp_f32 v172, v172
    v_exp_f32 v173, v173
    v_exp_f32 v174, v174
    v_exp_f32 v175, v175
    v_exp_f32 v176, v176
    v_exp_f32 v177, v177
    v_exp_f32 v178, v178
    v_exp_f32 v179, v179
    v_exp_f32 v180, v180
    v_exp_f32 v181, v181
    v_exp_f32 v182, v182
    s_nop 0
    v_add_f32 v2, v128, v2
    v_cvt_pk_bf16_f32 v192, v128, v129
    v_add_f32 v2, v129, v2
    v_add_f32 v2, v130, v2
    v_cvt_pk_bf16_f32 v193, v130, v131
    v_add_f32 v2, v131, v2
    v_add_f32 v3, v132, v3
    v_cvt_pk_bf16_f32 v196, v132, v133
    v_add_f32 v3, v133, v3
    v_add_f32 v3, v134, v3
    v_cvt_pk_bf16_f32 v197, v134, v135
    v_add_f32 v3, v135, v3
    v_add_f32 v4, v136, v4
    v_cvt_pk_bf16_f32 v200, v136, v137
    v_add_f32 v4, v137, v4
    v_add_f32 v4, v138, v4
    v_cvt_pk_bf16_f32 v201, v138, v139
    v_add_f32 v4, v139, v4
    v_add_f32 v5, v140, v5
    v_cvt_pk_bf16_f32 v204, v140, v141
    v_add_f32 v5, v141, v5
    v_add_f32 v5, v142, v5
    v_cvt_pk_bf16_f32 v205, v142, v143
    v_add_f32 v5, v143, v5
    v_add_f32 v2, v144, v2
    v_cvt_pk_bf16_f32 v194, v144, v145
    v_add_f32 v2, v145, v2
    v_add_f32 v2, v146, v2
    v_cvt_pk_bf16_f32 v195, v146, v147
    v_add_f32 v2, v147, v2
    v_add_f32 v3, v148, v3
    v_cvt_pk_bf16_f32 v198, v148, v149
    v_add_f32 v3, v149, v3
    v_add_f32 v3, v150, v3
    v_cvt_pk_bf16_f32 v199, v150, v151
    v_add_f32 v3, v151, v3
    v_add_f32 v4, v152, v4
    v_cvt_pk_bf16_f32 v202, v152, v153
    v_add_f32 v4, v153, v4
    v_add_f32 v4, v154, v4
    v_cvt_pk_bf16_f32 v203, v154, v155
    v_add_f32 v4, v155, v4
    v_add_f32 v5, v156, v5
    v_cvt_pk_bf16_f32 v206, v156, v157
    v_add_f32 v5, v157, v5
    v_add_f32 v5, v158, v5
    v_cvt_pk_bf16_f32 v207, v158, v159
    v_add_f32 v5, v159, v5
    v_add_f32 v2, v160, v2
    v_cvt_pk_bf16_f32 v208, v160, v161
    v_add_f32 v2, v161, v2
    v_add_f32 v2, v162, v2
    v_cvt_pk_bf16_f32 v209, v162, v163
    v_add_f32 v2, v163, v2
    v_add_f32 v3, v164, v3
    v_cvt_pk_bf16_f32 v212, v164, v165
    v_add_f32 v3, v165, v3
    v_add_f32 v3, v166, v3
    v_cvt_pk_bf16_f32 v213, v166, v167
    v_add_f32 v3, v167, v3
    v_add_f32 v4, v168, v4
    v_cvt_pk_bf16_f32 v216, v168, v169
    v_add_f32 v4, v169, v4
    v_add_f32 v4, v170, v4
    v_cvt_pk_bf16_f32 v217, v170, v171
    v_add_f32 v4, v171, v4
    v_add_f32 v5, v172, v5
    v_cvt_pk_bf16_f32 v220, v172, v173
    v_add_f32 v5, v173, v5
    v_add_f32 v5, v174, v5
    v_cvt_pk_bf16_f32 v221, v174, v175
    v_add_f32 v5, v175, v5
    v_add_f32 v2, v176, v2
    v_cvt_pk_bf16_f32 v210, v176, v177
    v_add_f32 v2, v177, v2
    v_add_f32 v2, v178, v2
    v_cvt_pk_bf16_f32 v211, v178, v179
    v_add_f32 v2, v179, v2
    v_add_f32 v3, v180, v3
    v_cvt_pk_bf16_f32 v214, v180, v181
    v_add_f32 v3, v181, v3
    s_mov_b32 s40, 0
    s_mov_b32 s52, 24576
    s_mov_b32 s53, 49152
    s_add_u32 s58, s48, 73728
    s_mov_b32 s41, s48
    s_add_u32 s47, s58, 49152
    s_mov_b32 s44, 31
    s_waitcnt lgkmcnt(2)
.p2align 6
L_att_loop:
    v_mfma_f32_16x16x32_bf16 v[128:131], a[192:195], v[64:67], v[40:43]
    ds_read_b128 a[208:211], v6 offset:2048
    v_add_f32 v3, v182, v3
    v_mfma_f32_16x16x32_bf16 v[128:131], a[196:199], v[80:83], v[128:131]
    ds_read_b128 a[212:215], v7 offset:2048
    v_add_u32 v8, s40, v14
    v_mfma_f32_16x16x32_bf16 v[132:135], a[192:195], v[68:71], v[44:47]
    s_add_u32 m0, s41, 0
    v_exp_f32 v183, v183
    v_mfma_f32_16x16x32_bf16 v[132:135], a[196:199], v[84:87], v[132:135]
    buffer_load_dwordx4 v18, s[16:19], s42 offen offset:0 lds
    v_mfma_f32_16x16x32_bf16 v[136:139], a[192:195], v[72:75], v[48:51]
    v_cvt_pk_bf16_f32 v215, v182, v183
    v_add_f32 v3, v183, v3
    v_mfma_f32_16x16x32_bf16 v[136:139], a[196:199], v[88:91], v[136:139]
    v_exp_f32 v184, v184
    v_mfma_f32_16x16x32_bf16 v[140:143], a[192:195], v[76:79], v[52:55]
    v_exp_f32 v185, v185
    v_mfma_f32_16x16x32_bf16 v[140:143], a[196:199], v[92:95], v[140:143]
    s_waitcnt lgkmcnt(2)
    v_add_f32 v4, v184, v4
    v_cvt_pk_bf16_f32 v218, v184, v185
    v_mfma_f32_16x16x32_bf16 v[128:131], a[200:203], v[96:99], v[128:131]
    ds_read_b128 a[216:219], v6 offset:6144
    v_add_f32 v4, v185, v4
    v_mfma_f32_16x16x32_bf16 v[128:131], a[204:207], v[112:115], v[128:131]
    ds_read_b128 a[220:223], v7 offset:6144
    v_add_u32 v9, s40, v15
    v_mfma_f32_16x16x32_bf16 v[132:135], a[200:203], v[100:103], v[132:135]
    s_add_u32 m0, s48, 147456
    v_exp_f32 v186, v186
    v_mfma_f32_16x16x32_bf16 v[132:135], a[204:207], v[116:119], v[132:135]
    buffer_load_dwordx4 v32, s[32:35], s96 offen sc1 lds
    v_mfma_f32_16x16x32_bf16 v[136:139], a[200:203], v[104:107], v[136:139]
    s_add_u32 s96, s96, s101
    v_exp_f32 v187, v187
    v_mfma_f32_16x16x32_bf16 v[136:139], a[204:207], v[120:123], v[136:139]
    v_add_f32 v4, v186, v4
    v_cvt_pk_bf16_f32 v219, v186, v187
    v_mfma_f32_16x16x32_bf16 v[140:143], a[200:203], v[108:111], v[140:143]
    v_exp_f32 v188, v188
    v_mfma_f32_16x16x32_bf16 v[140:143], a[204:207], v[124:127], v[140:143]
    s_waitcnt lgkmcnt(2)
    v_add_f32 v4, v187, v4
    v_add_f32 v5, v188, v5
    v_mfma_f32_16x16x32_bf16 v[128:131], a[208:211], a[224:227], v[128:131]
    ds_read_b128 a[192:195], v6 offset:7168
    v_add_u32 v10, s40, v16
    v_mfma_f32_16x16x32_bf16 v[128:131], a[212:215], a[240:243], v[128:131]
    ds_read_b128 a[196:199], v7 offset:7168
    v_add_u32 v11, s40, v17
    v_mfma_f32_16x16x32_bf16 v[132:135], a[208:211], a[228:231], v[132:135]
    s_add_u32 m0, s41, 896
    v_exp_f32 v189, v189
    v_mfma_f32_16x16x32_bf16 v[132:135], a[212:215], a[244:247], v[132:135]
    buffer_load_dwordx4 v18, s[16:19], s42 offen offset:128 lds
    v_mfma_f32_16x16x32_bf16 v[136:139], a[208:211], a[232:235], v[136:139]
    v_exp_f32 v190, v190
    v_mfma_f32_16x16x32_bf16 v[136:139], a[212:215], a[248:251], v[136:139]
    v_cvt_pk_bf16_f32 v222, v188, v189
    v_add_f32 v5, v189, v5
    v_mfma_f32_16x16x32_bf16 v[140:143], a[208:211], a[236:239], v[140:143]
    v_exp_f32 v191, v191
    v_mfma_f32_16x16x32_bf16 v[140:143], a[212:215], a[252:255], v[140:143]
    s_waitcnt lgkmcnt(2)
    v_add_f32 v5, v190, v5
    v_cvt_pk_bf16_f32 v223, v190, v191
    v_mfma_f32_16x16x32_bf16 v[144:147], a[216:219], v[64:67], v[40:43]
    ds_read_b128 a[200:203], v6 offset:8192
    v_add_f32 v5, v191, v5
    v_mfma_f32_16x16x32_bf16 v[144:147], a[220:223], v[80:83], v[144:147]
    ds_read_b128 a[204:207], v7 offset:8192
    v_mfma_f32_16x16x32_bf16 v[148:151], a[216:219], v[68:71], v[44:47]
    ds_read_b64_tr_b16 v[28:29], v33 offset:1024
    v_mfma_f32_16x16x32_bf16 v[148:151], a[220:223], v[84:87], v[148:151]
    ds_read_b64_tr_b16 v[30:31], v33 offset:7168
    v_mfma_f32_16x16x32_bf16 v[152:155], a[216:219], v[72:75], v[48:51]
    v_exp_f32 v128, v128
    v_mfma_f32_16x16x32_bf16 v[152:155], a[220:223], v[88:91], v[152:155]
    v_exp_f32 v129, v129
    v_mfma_f32_16x16x32_bf16 v[156:159], a[216:219], v[76:79], v[52:55]
    v_add_f32 v2, v128, v2
    v_cvt_pk_bf16_f32 v224, v128, v129
    v_mfma_f32_16x16x32_bf16 v[156:159], a[220:223], v[92:95], v[156:159]
    s_waitcnt lgkmcnt(4)
    v_exp_f32 v130, v130
    v_mfma_f32_16x16x32_bf16 v[144:147], a[192:195], v[96:99], v[144:147]
    ds_read_b128 a[208:211], v6 offset:12288
    v_add_f32 v2, v129, v2
    v_mfma_f32_16x16x32_bf16 v[144:147], a[196:199], v[112:115], v[144:147]
    ds_read_b128 a[212:215], v7 offset:12288
    v_add_f32 v2, v130, v2
    v_mfma_f32_16x16x32_bf16 v[148:151], a[192:195], v[100:103], v[148:151]
    s_add_u32 m0, s41, 1792
    v_exp_f32 v131, v131
    v_mfma_f32_16x16x32_bf16 v[148:151], a[196:199], v[116:119], v[148:151]
    buffer_load_dwordx4 v18, s[16:19], s42 offen offset:256 lds
    v_mfma_f32_16x16x32_bf16 v[152:155], a[192:195], v[104:107], v[152:155]
    v_cvt_pk_bf16_f32 v225, v130, v131
    v_add_f32 v2, v131, v2
    v_mfma_f32_16x16x32_bf16 v[152:155], a[196:199], v[120:123], v[152:155]
    v_exp_f32 v132, v132
    v_mfma_f32_16x16x32_bf16 v[156:159], a[192:195], v[108:111], v[156:159]
    s_cmp_eq_u32 s44, 22
    s_cselect_b32 s34, 0, s34
    v_add_f32 v3, v132, v3
    v_mfma_f32_16x16x32_bf16 v[156:159], a[196:199], v[124:127], v[156:159]
    s_waitcnt lgkmcnt(4)
    v_exp_f32 v133, v133
    v_mfma_f32_16x16x32_bf16 v[144:147], a[200:203], a[224:227], v[144:147]
    ds_read_b128 a[216:219], v6 offset:13312
    v_cvt_pk_bf16_f32 v228, v132, v133
    v_mfma_f32_16x16x32_bf16 v[144:147], a[204:207], a[240:243], v[144:147]
    ds_read_b128 a[220:223], v7 offset:13312
    v_add_f32 v3, v133, v3
    v_mfma_f32_16x16x32_bf16 v[148:151], a[200:203], a[228:231], v[148:151]
    v_exp_f32 v134, v134
    v_mfma_f32_16x16x32_bf16 v[148:151], a[204:207], a[244:247], v[148:151]
    s_cmp_eq_u32 s44, s39
    s_cbranch_scc1 L_hooka
L_hret:
    v_add_f32 v3, v134, v3
    v_mfma_f32_16x16x32_bf16 v[152:155], a[200:203], a[232:235], v[152:155]
    v_exp_f32 v135, v135
    v_mfma_f32_16x16x32_bf16 v[152:155], a[204:207], a[248:251], v[152:155]
    v_cvt_pk_bf16_f32 v229, v134, v135
    v_add_f32 v3, v135, v3
    v_mfma_f32_16x16x32_bf16 v[156:159], a[200:203], a[236:239], v[156:159]
    v_exp_f32 v136, v136
    v_mfma_f32_16x16x32_bf16 v[156:159], a[204:207], a[252:255], v[156:159]
    s_waitcnt lgkmcnt(2)
    v_exp_f32 v137, v137
    v_mfma_f32_16x16x32_bf16 v[160:163], a[208:211], v[64:67], v[40:43]
    ds_read_b128 a[192:195], v6 offset:14336
    v_add_f32 v4, v136, v4
    v_mfma_f32_16x16x32_bf16 v[160:163], a[212:215], v[80:83], v[160:163]
    ds_read_b128 a[196:199], v7 offset:14336
    v_cvt_pk_bf16_f32 v232, v136, v137
    v_mfma_f32_16x16x32_bf16 v[164:167], a[208:211], v[68:71], v[44:47]
    s_add_u32 m0, s41, 12288
    v_add_f32 v4, v137, v4
    v_mfma_f32_16x16x32_bf16 v[164:167], a[212:215], v[84:87], v[164:167]
    buffer_load_dwordx4 v18, s[16:19], s43 offen offset:0 lds
    v_mfma_f32_16x16x32_bf16 v[168:171], a[208:211], v[72:75], v[48:51]
    v_exp_f32 v138, v138
    v_mfma_f32_16x16x32_bf16 v[168:171], a[212:215], v[88:91], v[168:171]
    buffer_store_dwordx4 v[28:31], v1, s[88:91], s97 offen sc1
    v_mfma_f32_16x16x32_bf16 v[172:175], a[208:211], v[76:79], v[52:55]
    s_add_u32 s97, s97, 4096
    v_exp_f32 v139, v139
    v_mfma_f32_16x16x32_bf16 v[172:175], a[212:215], v[92:95], v[172:175]
    s_waitcnt lgkmcnt(2)
    v_add_f32 v4, v138, v4
    v_cvt_pk_bf16_f32 v233, v138, v139
    v_mfma_f32_16x16x32_bf16 v[160:163], a[216:219], v[96:99], v[160:163]
    ds_read_b128 a[200:203], v6 offset:18432
    v_add_f32 v4, v139, v4
    v_mfma_f32_16x16x32_bf16 v[160:163], a[220:223], v[112:115], v[160:163]
    ds_read_b128 a[204:207], v7 offset:18432
    v_mfma_f32_16x16x32_bf16 v[164:167], a[216:219], v[100:103], v[164:167]
    s_add_u32 m0, s41, 13184
    v_exp_f32 v140, v140
    v_mfma_f32_16x16x32_bf16 v[164:167], a[220:223], v[116:119], v[164:167]
    buffer_load_dwordx4 v18, s[16:19], s43 offen offset:128 lds
    v_mfma_f32_16x16x32_bf16 v[168:171], a[216:219], v[104:107], v[168:171]
    s_cmp_gt_u32 s44, 21
    s_cselect_b32 s90, 9830400, 0
    v_add_f32 v5, v140, v5
    v_mfma_f32_16x16x32_bf16 v[168:171], a[220:223], v[120:123], v[168:171]
    v_exp_f32 v141, v141
    v_mfma_f32_16x16x32_bf16 v[172:175], a[216:219], v[108:111], v[172:175]
    v_exp_f32 v142, v142
    v_mfma_f32_16x16x32_bf16 v[172:175], a[220:223], v[124:127], v[172:175]
    s_waitcnt lgkmcnt(2)
    v_cvt_pk_bf16_f32 v236, v140, v141
    v_add_f32 v5, v141, v5
    v_mfma_f32_16x16x32_bf16 v[160:163], a[192:195], a[224:227], v[160:163]
    ds_read_b128 a[208:211], v6 offset:19456
    v_add_f32 v5, v142, v5
    v_mfma_f32_16x16x32_bf16 v[160:163], a[196:199], a[240:243], v[160:163]
    ds_read_b128 a[212:215], v7 offset:19456
    v_mfma_f32_16x16x32_bf16 v[164:167], a[192:195], a[228:231], v[164:167]
    s_add_u32 m0, s41, 14080
    v_exp_f32 v143, v143
    v_mfma_f32_16x16x32_bf16 v[164:167], a[196:199], a[244:247], v[164:167]
    buffer_load_dwordx4 v18, s[16:19], s43 offen offset:256 lds
    v_mfma_f32_16x16x32_bf16 v[168:171], a[192:195], a[232:235], v[168:171]
    v_cvt_pk_bf16_f32 v237, v142, v143
    v_add_f32 v5, v143, v5
    v_mfma_f32_16x16x32_bf16 v[168:171], a[196:199], a[248:251], v[168:171]
    v_exp_f32 v144, v144
    v_mfma_f32_16x16x32_bf16 v[172:175], a[192:195], a[236:239], v[172:175]
    v_exp_f32 v145, v145
    v_mfma_f32_16x16x32_bf16 v[172:175], a[196:199], a[252:255], v[172:175]
    s_waitcnt lgkmcnt(2)
    v_add_f32 v2, v144, v2
    v_cvt_pk_bf16_f32 v226, v144, v145
    v_mfma_f32_16x16x32_bf16 v[176:179], a[200:203], v[64:67], v[40:43]
    ds_read_b128 a[216:219], v6 offset:20480
    v_add_f32 v2, v145, v2
    v_mfma_f32_16x16x32_bf16 v[176:179], a[204:207], v[80:83], v[176:179]
    ds_read_b128 a[220:223], v7 offset:20480
    v_mfma_f32_16x16x32_bf16 v[180:183], a[200:203], v[68:71], v[44:47]
    ds_read_b64_tr_b16 a[192:193], v8 offset:0
    v_mfma_f32_16x16x32_bf16 v[180:183], a[204:207], v[84:87], v[180:183]
    ds_read_b64_tr_b16 a[194:195], v8 offset:6144
    v_mfma_f32_16x16x32_bf16 v[184:187], a[200:203], v[72:75], v[48:51]
    ds_read_b64_tr_b16 a[196:197], v8 offset:12288
    v_mfma_f32_16x16x32_bf16 v[184:187], a[204:207], v[88:91], v[184:187]
    ds_read_b64_tr_b16 a[198:199], v8 offset:18432
    v_mfma_f32_16x16x32_bf16 v[188:191], a[200:203], v[76:79], v[52:55]
    s_add_u32 s42, s42, 24576
    v_exp_f32 v146, v146
    v_mfma_f32_16x16x32_bf16 v[188:191], a[204:207], v[92:95], v[188:191]
    s_waitcnt lgkmcnt(6)
    v_exp_f32 v147, v147
    v_mfma_f32_16x16x32_bf16 v[176:179], a[208:211], v[96:99], v[176:179]
    ds_read_b64_tr_b16 a[200:201], v9 offset:0
    v_add_f32 v2, v146, v2
    v_mfma_f32_16x16x32_bf16 v[176:179], a[212:215], v[112:115], v[176:179]
    ds_read_b64_tr_b16 a[202:203], v9 offset:6144
    v_cvt_pk_bf16_f32 v227, v146, v147
    v_mfma_f32_16x16x32_bf16 v[180:183], a[208:211], v[100:103], v[180:183]
    ds_read_b64_tr_b16 a[204:205], v9 offset:12288
    v_add_f32 v2, v147, v2
    v_mfma_f32_16x16x32_bf16 v[180:183], a[212:215], v[116:119], v[180:183]
    ds_read_b64_tr_b16 a[206:207], v9 offset:18432
    v_mfma_f32_16x16x32_bf16 v[184:187], a[208:211], v[104:107], v[184:187]
    s_add_u32 s43, s43, 24576
    v_mfma_f32_16x16x32_bf16 v[184:187], a[212:215], v[120:123], v[184:187]
    s_mov_b32 s59, s40
    v_exp_f32 v148, v148
    v_mfma_f32_16x16x32_bf16 v[188:191], a[208:211], v[108:111], v[188:191]
    s_mov_b32 s40, s52
    v_add_f32 v3, v148, v3
    v_mfma_f32_16x16x32_bf16 v[188:191], a[212:215], v[124:127], v[188:191]
    s_waitcnt lgkmcnt(8)
    v_exp_f32 v149, v149
    v_mfma_f32_16x16x32_bf16 v[176:179], a[216:219], a[224:227], v[176:179]
    ds_read_b64_tr_b16 a[208:209], v10 offset:0
    v_cvt_pk_bf16_f32 v230, v148, v149
    v_mfma_f32_16x16x32_bf16 v[176:179], a[220:223], a[240:243], v[176:179]
    ds_read_b64_tr_b16 a[210:211], v10 offset:6144
    v_add_f32 v3, v149, v3
    v_mfma_f32_16x16x32_bf16 v[180:183], a[216:219], a[228:231], v[180:183]
    ds_read_b64_tr_b16 a[212:213], v10 offset:12288
    v_mfma_f32_16x16x32_bf16 v[180:183], a[220:223], a[244:247], v[180:183]
    ds_read_b64_tr_b16 a[214:215], v10 offset:18432
    v_mfma_f32_16x16x32_bf16 v[184:187], a[216:219], a[232:235], v[184:187]
    s_add_u32 m0, s47, 0
    v_exp_f32 v150, v150
    v_mfma_f32_16x16x32_bf16 v[184:187], a[220:223], a[248:251], v[184:187]
    buffer_load_dwordx4 v19, s[20:23], s49 offen offset:0 lds
    v_mfma_f32_16x16x32_bf16 v[188:191], a[216:219], a[236:239], v[188:191]
    s_mov_b32 s52, s53
    v_add_f32 v3, v150, v3
    v_mfma_f32_16x16x32_bf16 v[188:191], a[220:223], a[252:255], v[188:191]
    s_waitcnt lgkmcnt(8)
    v_exp_f32 v151, v151
    v_mfma_f32_16x16x32_bf16 a[0:3], a[192:195], v[192:195], a[0:3]
    ds_read_b64_tr_b16 a[216:217], v11 offset:0
    v_cvt_pk_bf16_f32 v231, v150, v151
    v_mfma_f32_16x16x32_bf16 a[0:3], a[196:199], v[208:211], a[0:3]
    ds_read_b64_tr_b16 a[218:219], v11 offset:6144
    v_add_f32 v3, v151, v3
    v_mfma_f32_16x16x32_bf16 a[4:7], a[192:195], v[196:199], a[4:7]
    ds_read_b64_tr_b16 a[220:221], v11 offset:12288
    v_mfma_f32_16x16x32_bf16 a[4:7], a[196:199], v[212:215], a[4:7]
    ds_read_b64_tr_b16 a[222:223], v11 offset:18432
    v_mfma_f32_16x16x32_bf16 a[8:11], a[192:195], v[200:203], a[8:11]
    s_mov_b32 s53, s59
    v_mfma_f32_16x16x32_bf16 a[8:11], a[196:199], v[216:219], a[8:11]
    s_add_u32 s41, s40, s48
    v_exp_f32 v152, v152
    v_mfma_f32_16x16x32_bf16 a[12:15], a[192:195], v[204:207], a[12:15]
    v_exp_f32 v153, v153
    v_mfma_f32_16x16x32_bf16 a[12:15], a[196:199], v[220:223], a[12:15]
    s_waitcnt lgkmcnt(8)
    v_add_f32 v4, v152, v4
    v_cvt_pk_bf16_f32 v234, v152, v153
    v_mfma_f32_16x16x32_bf16 a[16:19], a[200:203], v[192:195], a[16:19]
    ds_read_b64_tr_b16 a[192:193], v8 offset:1024
    v_add_f32 v4, v153, v4
    v_mfma_f32_16x16x32_bf16 a[16:19], a[204:207], v[208:211], a[16:19]
    ds_read_b64_tr_b16 a[194:195], v8 offset:7168
    v_add_u32 v6, s52, v12
    v_mfma_f32_16x16x32_bf16 a[20:23], a[200:203], v[196:199], a[20:23]
    ds_read_b64_tr_b16 a[196:197], v8 offset:13312
    v_add_u32 v7, s52, v13
    v_mfma_f32_16x16x32_bf16 a[20:23], a[204:207], v[212:215], a[20:23]
    ds_read_b64_tr_b16 a[198:199], v8 offset:19456
    v_mfma_f32_16x16x32_bf16 a[24:27], a[200:203], v[200:203], a[24:27]
    s_add_u32 m0, s47, 896
    v_exp_f32 v154, v154
    v_mfma_f32_16x16x32_bf16 a[24:27], a[204:207], v[216:219], a[24:27]
    buffer_load_dwordx4 v19, s[20:23], s49 offen offset:128 lds
    v_mfma_f32_16x16x32_bf16 a[28:31], a[200:203], v[204:207], a[28:31]
    v_exp_f32 v155, v155
    v_mfma_f32_16x16x32_bf16 a[28:31], a[204:207], v[220:223], a[28:31]
    s_waitcnt lgkmcnt(8)
    v_add_f32 v4, v154, v4
    v_cvt_pk_bf16_f32 v235, v154, v155
    v_mfma_f32_16x16x32_bf16 a[32:35], a[208:211], v[192:195], a[32:35]
    ds_read_b64_tr_b16 a[200:201], v9 offset:1024
    v_add_f32 v4, v155, v4
    v_mfma_f32_16x16x32_bf16 a[32:35], a[212:215], v[208:211], a[32:35]
    ds_read_b64_tr_b16 a[202:203], v9 offset:7168
    v_mfma_f32_16x16x32_bf16 a[36:39], a[208:211], v[196:199], a[36:39]
    ds_read_b64_tr_b16 a[204:205], v9 offset:13312
    v_mfma_f32_16x16x32_bf16 a[36:39], a[212:215], v[212:215], a[36:39]
    ds_read_b64_tr_b16 a[206:207], v9 offset:19456
    v_mfma_f32_16x16x32_bf16 a[40:43], a[208:211], v[200:203], a[40:43]
    v_exp_f32 v156, v156
    v_mfma_f32_16x16x32_bf16 a[40:43], a[212:215], v[216:219], a[40:43]
    v_add_f32 v5, v156, v5
    v_mfma_f32_16x16x32_bf16 a[44:47], a[208:211], v[204:207], a[44:47]
    v_exp_f32 v157, v157
    v_mfma_f32_16x16x32_bf16 a[44:47], a[212:215], v[220:223], a[44:47]
    s_waitcnt lgkmcnt(8)
    v_exp_f32 v158, v158
    v_mfma_f32_16x16x32_bf16 a[48:51], a[216:219], v[192:195], a[48:51]
    ds_read_b64_tr_b16 a[208:209], v10 offset:1024
    v_cvt_pk_bf16_f32 v238, v156, v157
    v_mfma_f32_16x16x32_bf16 a[48:51], a[220:223], v[208:211], a[48:51]
    ds_read_b64_tr_b16 a[210:211], v10 offset:7168
    v_add_f32 v5, v157, v5
    v_mfma_f32_16x16x32_bf16 a[52:55], a[216:219], v[196:199], a[52:55]
    ds_read_b64_tr_b16 a[212:213], v10 offset:13312
    v_add_f32 v5, v158, v5
    v_mfma_f32_16x16x32_bf16 a[52:55], a[220:223], v[212:215], a[52:55]
    ds_read_b64_tr_b16 a[214:215], v10 offset:19456
    v_mfma_f32_16x16x32_bf16 a[56:59], a[216:219], v[200:203], a[56:59]
    s_add_u32 m0, s47, 1792
    v_mfma_f32_16x16x32_bf16 a[56:59], a[220:223], v[216:219], a[56:59]
    buffer_load_dwordx4 v19, s[20:23], s49 offen offset:256 lds
    v_mfma_f32_16x16x32_bf16 a[60:63], a[216:219], v[204:207], a[60:63]
    v_exp_f32 v159, v159
    v_mfma_f32_16x16x32_bf16 a[60:63], a[220:223], v[220:223], a[60:63]
    s_waitcnt lgkmcnt(8)
    v_cvt_pk_bf16_f32 v239, v158, v159
    v_add_f32 v5, v159, v5
    v_mfma_f32_16x16x32_bf16 a[64:67], a[192:195], v[192:195], a[64:67]
    ds_read_b64_tr_b16 a[216:217], v11 offset:1024
    v_mfma_f32_16x16x32_bf16 a[64:67], a[196:199], v[208:211], a[64:67]
    ds_read_b64_tr_b16 a[218:219], v11 offset:7168
    v_mfma_f32_16x16x32_bf16 a[68:71], a[192:195], v[196:199], a[68:71]
    ds_read_b64_tr_b16 a[220:221], v11 offset:13312
    v_mfma_f32_16x16x32_bf16 a[68:71], a[196:199], v[212:215], a[68:71]
    ds_read_b64_tr_b16 a[222:223], v11 offset:19456
    v_mfma_f32_16x16x32_bf16 a[72:75], a[192:195], v[200:203], a[72:75]
    v_exp_f32 v160, v160
    v_mfma_f32_16x16x32_bf16 a[72:75], a[196:199], v[216:219], a[72:75]
    v_exp_f32 v161, v161
    v_mfma_f32_16x16x32_bf16 a[76:79], a[192:195], v[204:207], a[76:79]
    v_add_f32 v2, v160, v2
    v_cvt_pk_bf16_f32 v240, v160, v161
    v_mfma_f32_16x16x32_bf16 a[76:79], a[196:199], v[220:223], a[76:79]
    s_waitcnt lgkmcnt(8)
    v_exp_f32 v162, v162
    v_mfma_f32_16x16x32_bf16 a[80:83], a[200:203], v[192:195], a[80:83]
    ds_read_b64_tr_b16 a[192:193], v8 offset:2048
    v_add_f32 v2, v161, v2
    v_mfma_f32_16x16x32_bf16 a[80:83], a[204:207], v[208:211], a[80:83]
    ds_read_b64_tr_b16 a[194:195], v8 offset:8192
    v_add_f32 v2, v162, v2
    v_mfma_f32_16x16x32_bf16 a[84:87], a[200:203], v[196:199], a[84:87]
    ds_read_b64_tr_b16 a[196:197], v8 offset:14336
    v_mfma_f32_16x16x32_bf16 a[84:87], a[204:207], v[212:215], a[84:87]
    ds_read_b64_tr_b16 a[198:199], v8 offset:20480
    v_mfma_f32_16x16x32_bf16 a[88:91], a[200:203], v[200:203], a[88:91]
    s_add_u32 m0, s47, 12288
    v_exp_f32 v163, v163
    v_mfma_f32_16x16x32_bf16 a[88:91], a[204:207], v[216:219], a[88:91]
    buffer_load_dwordx4 v19, s[20:23], s50 offen offset:0 lds
    v_mfma_f32_16x16x32_bf16 a[92:95], a[200:203], v[204:207], a[92:95]
    v_cvt_pk_bf16_f32 v241, v162, v163
    v_add_f32 v2, v163, v2
    v_mfma_f32_16x16x32_bf16 a[92:95], a[204:207], v[220:223], a[92:95]
    s_waitcnt lgkmcnt(8)
    v_exp_f32 v164, v164
    v_mfma_f32_16x16x32_bf16 a[96:99], a[208:211], v[192:195], a[96:99]
    ds_read_b64_tr_b16 a[200:201], v9 offset:2048
    v_add_f32 v3, v164, v3
    v_mfma_f32_16x16x32_bf16 a[96:99], a[212:215], v[208:211], a[96:99]
    ds_read_b64_tr_b16 a[202:203], v9 offset:8192
    v_mfma_f32_16x16x32_bf16 a[100:103], a[208:211], v[196:199], a[100:103]
    ds_read_b64_tr_b16 a[204:205], v9 offset:14336
    v_mfma_f32_16x16x32_bf16 a[100:103], a[212:215], v[212:215], a[100:103]
    ds_read_b64_tr_b16 a[206:207], v9 offset:20480
    v_mfma_f32_16x16x32_bf16 a[104:107], a[208:211], v[200:203], a[104:107]
    s_add_u32 m0, s47, 13184
    v_mfma_f32_16x16x32_bf16 a[104:107], a[212:215], v[216:219], a[104:107]
    buffer_load_dwordx4 v19, s[20:23], s50 offen offset:128 lds
    v_mfma_f32_16x16x32_bf16 a[108:111], a[208:211], v[204:207], a[108:111]
    v_exp_f32 v165, v165
    v_mfma_f32_16x16x32_bf16 a[108:111], a[212:215], v[220:223], a[108:111]
    s_waitcnt lgkmcnt(8)
    v_exp_f32 v166, v166
    v_mfma_f32_16x16x32_bf16 a[112:115], a[216:219], v[192:195], a[112:115]
    ds_read_b64_tr_b16 a[208:209], v10 offset:2048
    v_cvt_pk_bf16_f32 v244, v164, v165
    v_mfma_f32_16x16x32_bf16 a[112:115], a[220:223], v[208:211], a[112:115]
    ds_read_b64_tr_b16 a[210:211], v10 offset:8192
    v_add_f32 v3, v165, v3
    v_mfma_f32_16x16x32_bf16 a[116:119], a[216:219], v[196:199], a[116:119]
    ds_read_b64_tr_b16 a[212:213], v10 offset:14336
    v_add_f32 v3, v166, v3
    v_mfma_f32_16x16x32_bf16 a[116:119], a[220:223], v[212:215], a[116:119]
    ds_read_b64_tr_b16 a[214:215], v10 offset:20480
    v_mfma_f32_16x16x32_bf16 a[120:123], a[216:219], v[200:203], a[120:123]
    s_add_u32 m0, s47, 14080
    v_mfma_f32_16x16x32_bf16 a[120:123], a[220:223], v[216:219], a[120:123]
    buffer_load_dwordx4 v19, s[20:23], s50 offen offset:256 lds
    v_mfma_f32_16x16x32_bf16 a[124:127], a[216:219], v[204:207], a[124:127]
    s_add_u32 s49, s49, 24576
    v_exp_f32 v167, v167
    v_mfma_f32_16x16x32_bf16 a[124:127], a[220:223], v[220:223], a[124:127]
    s_waitcnt lgkmcnt(8)
    v_cvt_pk_bf16_f32 v245, v166, v167
    v_add_f32 v3, v167, v3
    v_mfma_f32_16x16x32_bf16 a[128:131], a[192:195], v[192:195], a[128:131]
    ds_read_b64_tr_b16 a[216:217], v11 offset:2048
    v_mfma_f32_16x16x32_bf16 a[128:131], a[196:199], v[208:211], a[128:131]
    ds_read_b64_tr_b16 a[218:219], v11 offset:8192
    v_mfma_f32_16x16x32_bf16 a[132:135], a[192:195], v[196:199], a[132:135]
    ds_read_b64_tr_b16 a[220:221], v11 offset:14336
    v_mfma_f32_16x16x32_bf16 a[132:135], a[196:199], v[212:215], a[132:135]
    ds_read_b64_tr_b16 a[222:223], v11 offset:20480
    v_mfma_f32_16x16x32_bf16 a[136:139], a[192:195], v[200:203], a[136:139]
    s_add_u32 s50, s50, 24576
    v_exp_f32 v168, v168
    v_mfma_f32_16x16x32_bf16 a[136:139], a[196:199], v[216:219], a[136:139]
    s_add_u32 s47, s53, s58
    v_exp_f32 v169, v169
    v_mfma_f32_16x16x32_bf16 a[140:143], a[192:195], v[204:207], a[140:143]
    s_sub_u32 s44, s44, 1
    v_add_f32 v4, v168, v4
    v_cvt_pk_bf16_f32 v248, v168, v169
    v_mfma_f32_16x16x32_bf16 a[140:143], a[196:199], v[220:223], a[140:143]
    s_waitcnt lgkmcnt(8)
    v_exp_f32 v170, v170
    v_mfma_f32_16x16x32_bf16 a[144:147], a[200:203], v[192:195], a[144:147]
    v_exp_f32 v171, v171
    v_mfma_f32_16x16x32_bf16 a[144:147], a[204:207], v[208:211], a[144:147]
    s_waitcnt vmcnt(11) lgkmcnt(0)
    v_add_f32 v4, v169, v4
    v_add_f32 v4, v170, v4
    v_mfma_f32_16x16x32_bf16 a[148:151], a[200:203], v[196:199], a[148:151]
    s_barrier
    v_exp_f32 v172, v172
    v_mfma_f32_16x16x32_bf16 a[148:151], a[204:207], v[212:215], a[148:151]
    v_cvt_pk_bf16_f32 v249, v170, v171
    v_add_f32 v4, v171, v4
    v_mfma_f32_16x16x32_bf16 a[152:155], a[200:203], v[200:203], a[152:155]
    v_exp_f32 v173, v173
    v_mfma_f32_16x16x32_bf16 a[152:155], a[204:207], v[216:219], a[152:155]
    v_exp_f32 v174, v174
    v_mfma_f32_16x16x32_bf16 a[156:159], a[200:203], v[204:207], a[156:159]
    v_add_f32 v5, v172, v5
    v_cvt_pk_bf16_f32 v252, v172, v173
    v_mfma_f32_16x16x32_bf16 a[156:159], a[204:207], v[220:223], a[156:159]
    v_exp_f32 v175, v175
    v_mfma_f32_16x16x32_bf16 a[160:163], a[208:211], v[192:195], a[160:163]
    ds_read_b128 a[192:195], v6 offset:0
    v_add_f32 v5, v173, v5
    v_mfma_f32_16x16x32_bf16 a[160:163], a[212:215], v[208:211], a[160:163]
    ds_read_b128 a[196:199], v7 offset:0
    v_add_f32 v5, v174, v5
    v_mfma_f32_16x16x32_bf16 a[164:167], a[208:211], v[196:199], a[164:167]
    v_cvt_pk_bf16_f32 v253, v174, v175
    v_add_f32 v5, v175, v5
    v_mfma_f32_16x16x32_bf16 a[164:167], a[212:215], v[212:215], a[164:167]
    v_exp_f32 v176, v176
    v_mfma_f32_16x16x32_bf16 a[168:171], a[208:211], v[200:203], a[168:171]
    v_exp_f32 v177, v177
    v_mfma_f32_16x16x32_bf16 a[168:171], a[212:215], v[216:219], a[168:171]
    v_add_f32 v2, v176, v2
    v_cvt_pk_bf16_f32 v242, v176, v177
    v_mfma_f32_16x16x32_bf16 a[172:175], a[208:211], v[204:207], a[172:175]
    v_exp_f32 v178, v178
    v_mfma_f32_16x16x32_bf16 a[172:175], a[212:215], v[220:223], a[172:175]
    v_exp_f32 v179, v179
    v_mfma_f32_16x16x32_bf16 a[176:179], a[216:219], v[192:195], a[176:179]
    ds_read_b128 a[200:203], v6 offset:1024
    v_add_f32 v2, v177, v2
    v_mfma_f32_16x16x32_bf16 a[176:179], a[220:223], v[208:211], a[176:179]
    ds_read_b128 a[204:207], v7 offset:1024
    v_add_f32 v2, v178, v2
    v_mfma_f32_16x16x32_bf16 a[180:183], a[216:219], v[196:199], a[180:183]
    s_cmp_lg_u32 s44, 0
    v_cvt_pk_bf16_f32 v243, v178, v179
    v_add_f32 v2, v179, v2
    v_mfma_f32_16x16x32_bf16 a[180:183], a[220:223], v[212:215], a[180:183]
    v_exp_f32 v180, v180
    v_mfma_f32_16x16x32_bf16 a[184:187], a[216:219], v[200:203], a[184:187]
    v_add_f32 v3, v180, v3
    v_mfma_f32_16x16x32_bf16 a[184:187], a[220:223], v[216:219], a[184:187]
    v_exp_f32 v181, v181
    v_mfma_f32_16x16x32_bf16 a[188:191], a[216:219], v[204:207], a[188:191]
    v_exp_f32 v182, v182
    v_mfma_f32_16x16x32_bf16 a[188:191], a[220:223], v[220:223], a[188:191]
    s_waitcnt lgkmcnt(2)
    v_cvt_pk_bf16_f32 v246, v180, v181
    v_add_f32 v3, v181, v3
    s_cbranch_scc0 L_att_tail
    v_mfma_f32_16x16x32_bf16 v[128:131], a[192:195], v[64:67], v[40:43]
    ds_read_b128 a[208:211], v6 offset:2048
    v_add_f32 v3, v182, v3
    v_mfma_f32_16x16x32_bf16 v[128:131], a[196:199], v[80:83], v[128:131]
    ds_read_b128 a[212:215], v7 offset:2048
    v_add_u32 v8, s40, v14
    v_mfma_f32_16x16x32_bf16 v[132:135], a[192:195], v[68:71], v[44:47]
    s_add_u32 m0, s41, 0
    v_exp_f32 v183, v183
    v_mfma_f32_16x16x32_bf16 v[132:135], a[196:199], v[84:87], v[132:135]
    buffer_load_dwordx4 v18, s[16:19], s42 offen offset:0 lds
    v_mfma_f32_16x16x32_bf16 v[136:139], a[192:195], v[72:75], v[48:51]
    v_cvt_pk_bf16_f32 v247, v182, v183
    v_add_f32 v3, v183, v3
    v_mfma_f32_16x16x32_bf16 v[136:139], a[196:199], v[88:91], v[136:139]
    v_exp_f32 v184, v184
    v_mfma_f32_16x16x32_bf16 v[140:143], a[192:195], v[76:79], v[52:55]
    v_exp_f32 v185, v185
    v_mfma_f32_16x16x32_bf16 v[140:143], a[196:199], v[92:95], v[140:143]
    s_waitcnt lgkmcnt(2)
    v_add_f32 v4, v184, v4
    v_cvt_pk_bf16_f32 v250, v184, v185
    v_mfma_f32_16x16x32_bf16 v[128:131], a[200:203], v[96:99], v[128:131]
    ds_read_b128 a[216:219], v6 offset:6144
    v_add_f32 v4, v185, v4
    v_mfma_f32_16x16x32_bf16 v[128:131], a[204:207], v[112:115], v[128:131]
    ds_read_b128 a[220:223], v7 offset:6144
    v_add_u32 v9, s40, v15
    v_mfma_f32_16x16x32_bf16 v[132:135], a[200:203], v[100:103], v[132:135]
    s_add_u32 m0, s48, 148480
    v_exp_f32 v186, v186
    v_mfma_f32_16x16x32_bf16 v[132:135], a[204:207], v[116:119], v[132:135]
    buffer_load_dwordx4 v32, s[32:35], s96 offen sc1 lds
    v_mfma_f32_16x16x32_bf16 v[136:139], a[200:203], v[104:107], v[136:139]
    s_add_u32 s96, s96, s101
    v_exp_f32 v187, v187
    v_mfma_f32_16x16x32_bf16 v[136:139], a[204:207], v[120:123], v[136:139]
    v_add_f32 v4, v186, v4
    v_cvt_pk_bf16_f32 v251, v186, v187
    v_mfma_f32_16x16x32_bf16 v[140:143], a[200:203], v[108:111], v[140:143]
    v_exp_f32 v188, v188
    v_mfma_f32_16x16x32_bf16 v[140:143], a[204:207], v[124:127], v[140:143]
    s_waitcnt lgkmcnt(2)
    v_add_f32 v4, v187, v4
    v_add_f32 v5, v188, v5
    v_mfma_f32_16x16x32_bf16 v[128:131], a[208:211], a[224:227], v[128:131]
    ds_read_b128 a[192:195], v6 offset:7168
    v_add_u32 v10, s40, v16
    v_mfma_f32_16x16x32_bf16 v[128:131], a[212:215], a[240:243], v[128:131]
    ds_read_b128 a[196:199], v7 offset:7168
    v_add_u32 v11, s40, v17
    v_mfma_f32_16x16x32_bf16 v[132:135], a[208:211], a[228:231], v[132:135]
    s_add_u32 m0, s41, 896
    v_exp_f32 v189, v189
    v_mfma_f32_16x16x32_bf16 v[132:135], a[212:215], a[244:247], v[132:135]
    buffer_load_dwordx4 v18, s[16:19], s42 offen offset:128 lds
    v_mfma_f32_16x16x32_bf16 v[136:139], a[208:211], a[232:235], v[136:139]
    v_exp_f32 v190, v190
    v_mfma_f32_16x16x32_bf16 v[136:139], a[212:215], a[248:251], v[136:139]
    v_cvt_pk_bf16_f32 v254, v188, v189
    v_add_f32 v5, v189, v5
    v_mfma_f32_16x16x32_bf16 v[140:143], a[208:211], a[236:239], v[140:143]
    v_exp_f32 v191, v191
    v_mfma_f32_16x16x32_bf16 v[140:143], a[212:215], a[252:255], v[140:143]
    s_waitcnt lgkmcnt(2)
    v_add_f32 v5, v190, v5
    v_cvt_pk_bf16_f32 v255, v190, v191
    v_mfma_f32_16x16x32_bf16 v[144:147], a[216:219], v[64:67], v[40:43]
    ds_read_b128 a[200:203], v6 offset:8192
    v_add_f32 v5, v191, v5
    v_mfma_f32_16x16x32_bf16 v[144:147], a[220:223], v[80:83], v[144:147]
    ds_read_b128 a[204:207], v7 offset:8192
    v_mfma_f32_16x16x32_bf16 v[148:151], a[216:219], v[68:71], v[44:47]
    ds_read_b64_tr_b16 v[28:29], v33 offset:0
    v_mfma_f32_16x16x32_bf16 v[148:151], a[220:223], v[84:87], v[148:151]
    ds_read_b64_tr_b16 v[30:31], v33 offset:6144
    v_mfma_f32_16x16x32_bf16 v[152:155], a[216:219], v[72:75], v[48:51]
    v_exp_f32 v128, v128
    v_mfma_f32_16x16x32_bf16 v[152:155], a[220:223], v[88:91], v[152:155]
    v_exp_f32 v129, v129
    v_mfma_f32_16x16x32_bf16 v[156:159], a[216:219], v[76:79], v[52:55]
    v_add_f32 v2, v128, v2
    v_cvt_pk_bf16_f32 v192, v128, v129
    v_mfma_f32_16x16x32_bf16 v[156:159], a[220:223], v[92:95], v[156:159]
    s_waitcnt lgkmcnt(4)
    v_exp_f32 v130, v130
    v_mfma_f32_16x16x32_bf16 v[144:147], a[192:195], v[96:99], v[144:147]
    ds_read_b128 a[208:211], v6 offset:12288
    v_add_f32 v2, v129, v2
    v_mfma_f32_16x16x32_bf16 v[144:147], a[196:199], v[112:115], v[144:147]
    ds_read_b128 a[212:215], v7 offset:12288
    v_add_f32 v2, v130, v2
    v_mfma_f32_16x16x32_bf16 v[148:151], a[192:195], v[100:103], v[148:151]
    s_add_u32 m0, s41, 1792
    v_exp_f32 v131, v131
    v_mfma_f32_16x16x32_bf16 v[148:151], a[196:199], v[116:119], v[148:151]
    buffer_load_dwordx4 v18, s[16:19], s42 offen offset:256 lds
    v_mfma_f32_16x16x32_bf16 v[152:155], a[192:195], v[104:107], v[152:155]
    v_cvt_pk_bf16_f32 v193, v130, v131
    v_add_f32 v2, v131, v2
    v_mfma_f32_16x16x32_bf16 v[152:155], a[196:199], v[120:123], v[152:155]
    v_exp_f32 v132, v132
    v_mfma_f32_16x16x32_bf16 v[156:159], a[192:195], v[108:111], v[156:159]
    s_cmp_eq_u32 s44, 22
    s_cselect_b32 s34, 0, s34
    v_add_f32 v3, v132, v3
    v_mfma_f32_16x16x32_bf16 v[156:159], a[196:199], v[124:127], v[156:159]
    s_waitcnt lgkmcnt(4)
    v_exp_f32 v133, v133
    v_mfma_f32_16x16x32_bf16 v[144:147], a[200:203], a[224:227], v[144:147]
    ds_read_b128 a[216:219], v6 offset:13312
    v_cvt_pk_bf16_f32 v196, v132, v133
    v_mfma_f32_16x16x32_bf16 v[144:147], a[204:207], a[240:243], v[144:147]
    ds_read_b128 a[220:223], v7 offset:13312
    v_add_f32 v3, v133, v3
    v_mfma_f32_16x16x32_bf16 v[148:151], a[200:203], a[228:231], v[148:151]
    v_exp_f32 v134, v134
    v_mfma_f32_16x16x32_bf16 v[148:151], a[204:207], a[244:247], v[148:151]
    v_add_f32 v3, v134, v3
    v_mfma_f32_16x16x32_bf16 v[152:155], a[200:203], a[232:235], v[152:155]
    v_exp_f32 v135, v135
    v_mfma_f32_16x16x32_bf16 v[152:155], a[204:207], a[248:251], v[152:155]
    v_cvt_pk_bf16_f32 v197, v134, v135
    v_add_f32 v3, v135, v3
    v_mfma_f32_16x16x32_bf16 v[156:159], a[200:203], a[236:239], v[156:159]
    v_exp_f32 v136, v136
    v_mfma_f32_16x16x32_bf16 v[156:159], a[204:207], a[252:255], v[156:159]
    s_waitcnt lgkmcnt(2)
    v_exp_f32 v137, v137
    v_mfma_f32_16x16x32_bf16 v[160:163], a[208:211], v[64:67], v[40:43]
    ds_read_b128 a[192:195], v6 offset:14336
    v_add_f32 v4, v136, v4
    v_mfma_f32_16x16x32_bf16 v[160:163], a[212:215], v[80:83], v[160:163]
    ds_read_b128 a[196:199], v7 offset:14336
    v_cvt_pk_bf16_f32 v200, v136, v137
    v_mfma_f32_16x16x32_bf16 v[164:167], a[208:211], v[68:71], v[44:47]
    s_add_u32 m0, s41, 12288
    v_add_f32 v4, v137, v4
    v_mfma_f32_16x16x32_bf16 v[164:167], a[212:215], v[84:87], v[164:167]
    buffer_load_dwordx4 v18, s[16:19], s43 offen offset:0 lds
    v_mfma_f32_16x16x32_bf16 v[168:171], a[208:211], v[72:75], v[48:51]
    v_exp_f32 v138, v138
    v_mfma_f32_16x16x32_bf16 v[168:171], a[212:215], v[88:91], v[168:171]
    buffer_store_dwordx4 v[28:31], v1, s[88:91], s97 offen sc1
    v_mfma_f32_16x16x32_bf16 v[172:175], a[208:211], v[76:79], v[52:55]
    s_add_u32 s97, s97, 4096
    v_exp_f32 v139, v139
    v_mfma_f32_16x16x32_bf16 v[172:175], a[212:215], v[92:95], v[172:175]
    s_waitcnt lgkmcnt(2)
    v_add_f32 v4, v138, v4
    v_cvt_pk_bf16_f32 v201, v138, v139
    v_mfma_f32_16x16x32_bf16 v[160:163], a[216:219], v[96:99], v[160:163]
    ds_read_b128 a[200:203], v6 offset:18432
    v_add_f32 v4, v139, v4
    v_mfma_f32_16x16x32_bf16 v[160:163], a[220:223], v[112:115], v[160:163]
    ds_read_b128 a[204:207], v7 offset:18432
    v_mfma_f32_16x16x32_bf16 v[164:167], a[216:219], v[100:103], v[164:167]
    s_add_u32 m0, s41, 13184
    v_exp_f32 v140, v140
    v_mfma_f32_16x16x32_bf16 v[164:167], a[220:223], v[116:119], v[164:167]
    buffer_load_dwordx4 v18, s[16:19], s43 offen offset:128 lds
    v_mfma_f32_16x16x32_bf16 v[168:171], a[216:219], v[104:107], v[168:171]
    s_cmp_gt_u32 s44, 21
    s_cselect_b32 s90, 9830400, 0
    v_add_f32 v5, v140, v5
    v_mfma_f32_16x16x32_bf16 v[168:171], a[220:223], v[120:123], v[168:171]
    v_exp_f32 v141, v141
    v_mfma_f32_16x16x32_bf16 v[172:175], a[216:219], v[108:111], v[172:175]
    v_exp_f32 v142, v142
    v_mfma_f32_16x16x32_bf16 v[172:175], a[220:223], v[124:127], v[172:175]
    s_waitcnt lgkmcnt(2)
    v_cvt_pk_bf16_f32 v204, v140, v141
    v_add_f32 v5, v141, v5
    v_mfma_f32_16x16x32_bf16 v[160:163], a[192:195], a[224:227], v[160:163]
    ds_read_b128 a[208:211], v6 offset:19456
    v_add_f32 v5, v142, v5
    v_mfma_f32_16x16x32_bf16 v[160:163], a[196:199], a[240:243], v[160:163]
    ds_read_b128 a[212:215], v7 offset:19456
    v_mfma_f32_16x16x32_bf16 v[164:167], a[192:195], a[228:231], v[164:167]
    s_add_u32 m0, s41, 14080
    v_exp_f32 v143, v143
    v_mfma_f32_16x16x32_bf16 v[164:167], a[196:199], a[244:247], v[164:167]
    buffer_load_dwordx4 v18, s[16:19], s43 offen offset:256 lds
    v_mfma_f32_16x16x32_bf16 v[168:171], a[192:195], a[232:235], v[168:171]
    v_cvt_pk_bf16_f32 v205, v142, v143
    v_add_f32 v5, v143, v5
    v_mfma_f32_16x16x32_bf16 v[168:171], a[196:199], a[248:251], v[168:171]
    v_exp_f32 v144, v144
    v_mfma_f32_16x16x32_bf16 v[172:175], a[192:195], a[236:239], v[172:175]
    v_exp_f32 v145, v145
    v_mfma_f32_16x16x32_bf16 v[172:175], a[196:199], a[252:255], v[172:175]
    s_waitcnt lgkmcnt(2)
    v_add_f32 v2, v144, v2
    v_cvt_pk_bf16_f32 v194, v144, v145
    v_mfma_f32_16x16x32_bf16 v[176:179], a[200:203], v[64:67], v[40:43]
    ds_read_b128 a[216:219], v6 offset:20480
    v_add_f32 v2, v145, v2
    v_mfma_f32_16x16x32_bf16 v[176:179], a[204:207], v[80:83], v[176:179]
    ds_read_b128 a[220:223], v7 offset:20480
    v_mfma_f32_16x16x32_bf16 v[180:183], a[200:203], v[68:71], v[44:47]
    ds_read_b64_tr_b16 a[192:193], v8 offset:0
    v_mfma_f32_16x16x32_bf16 v[180:183], a[204:207], v[84:87], v[180:183]
    ds_read_b64_tr_b16 a[194:195], v8 offset:6144
    v_mfma_f32_16x16x32_bf16 v[184:187], a[200:203], v[72:75], v[48:51]
    ds_read_b64_tr_b16 a[196:197], v8 offset:12288
    v_mfma_f32_16x16x32_bf16 v[184:187], a[204:207], v[88:91], v[184:187]
    ds_read_b64_tr_b16 a[198:199], v8 offset:18432
    v_mfma_f32_16x16x32_bf16 v[188:191], a[200:203], v[76:79], v[52:55]
    s_add_u32 s42, s42, 24576
    v_exp_f32 v146, v146
    v_mfma_f32_16x16x32_bf16 v[188:191], a[204:207], v[92:95], v[188:191]
    s_waitcnt lgkmcnt(6)
    v_exp_f32 v147, v147
    v_mfma_f32_16x16x32_bf16 v[176:179], a[208:211], v[96:99], v[176:179]
    ds_read_b64_tr_b16 a[200:201], v9 offset:0
    v_add_f32 v2, v146, v2
    v_mfma_f32_16x16x32_bf16 v[176:179], a[212:215], v[112:115], v[176:179]
    ds_read_b64_tr_b16 a[202:203], v9 offset:6144
    v_cvt_pk_bf16_f32 v195, v146, v147
    v_mfma_f32_16x16x32_bf16 v[180:183], a[208:211], v[100:103], v[180:183]
    ds_read_b64_tr_b16 a[204:205], v9 offset:12288
    v_add_f32 v2, v147, v2
    v_mfma_f32_16x16x32_bf16 v[180:183], a[212:215], v[116:119], v[180:183]
    ds_read_b64_tr_b16 a[206:207], v9 offset:18432
    v_mfma_f32_16x16x32_bf16 v[184:187], a[208:211], v[104:107], v[184:187]
    s_add_u32 s43, s43, 24576
    v_mfma_f32_16x16x32_bf16 v[184:187], a[212:215], v[120:123], v[184:187]
    s_mov_b32 s59, s40
    v_exp_f32 v148, v148
    v_mfma_f32_16x16x32_bf16 v[188:191], a[208:211], v[108:111], v[188:191]
    s_mov_b32 s40, s52
    v_add_f32 v3, v148, v3
    v_mfma_f32_16x16x32_bf16 v[188:191], a[212:215], v[124:127], v[188:191]
    s_waitcnt lgkmcnt(8)
    v_exp_f32 v149, v149
    v_mfma_f32_16x16x32_bf16 v[176:179], a[216:219], a[224:227], v[176:179]
    ds_read_b64_tr_b16 a[208:209], v10 offset:0
    v_cvt_pk_bf16_f32 v198, v148, v149
    v_mfma_f32_16x16x32_bf16 v[176:179], a[220:223], a[240:243], v[176:179]
    ds_read_b64_tr_b16 a[210:211], v10 offset:6144
    v_add_f32 v3, v149, v3
    v_mfma_f32_16x16x32_bf16 v[180:183], a[216:219], a[228:231], v[180:183]
    ds_read_b64_tr_b16 a[212:213], v10 offset:12288
    v_mfma_f32_16x16x32_bf16 v[180:183], a[220:223], a[244:247], v[180:183]
    ds_read_b64_tr_b16 a[214:215], v10 offset:18432
    v_mfma_f32_16x16x32_bf16 v[184:187], a[216:219], a[232:235], v[184:187]
    s_add_u32 m0, s47, 0
    v_exp_f32 v150, v150
    v_mfma_f32_16x16x32_bf16 v[184:187], a[220:223], a[248:251], v[184:187]
    buffer_load_dwordx4 v19, s[20:23], s49 offen offset:0 lds
    v_mfma_f32_16x16x32_bf16 v[188:191], a[216:219], a[236:239], v[188:191]
    s_mov_b32 s52, s53
    v_add_f32 v3, v150, v3
    v_mfma_f32_16x16x32_bf16 v[188:191], a[220:223], a[252:255], v[188:191]
    s_waitcnt lgkmcnt(8)
    v_exp_f32 v151, v151
    v_mfma_f32_16x16x32_bf16 a[0:3], a[192:195], v[224:227], a[0:3]
    ds_read_b64_tr_b16 a[216:217], v11 offset:0
    v_cvt_pk_bf16_f32 v199, v150, v151
    v_mfma_f32_16x16x32_bf16 a[0:3], a[196:199], v[240:243], a[0:3]
    ds_read_b64_tr_b16 a[218:219], v11 offset:6144
    v_add_f32 v3, v151, v3
    v_mfma_f32_16x16x32_bf16 a[4:7], a[192:195], v[228:231], a[4:7]
    ds_read_b64_tr_b16 a[220:221], v11 offset:12288
    v_mfma_f32_16x16x32_bf16 a[4:7], a[196:199], v[244:247], a[4:7]
    ds_read_b64_tr_b16 a[222:223], v11 offset:18432
    v_mfma_f32_16x16x32_bf16 a[8:11], a[192:195], v[232:235], a[8:11]
    s_mov_b32 s53, s59
    v_mfma_f32_16x16x32_bf16 a[8:11], a[196:199], v[248:251], a[8:11]
    s_add_u32 s41, s40, s48
    v_exp_f32 v152, v152
    v_mfma_f32_16x16x32_bf16 a[12:15], a[192:195], v[236:239], a[12:15]
    v_exp_f32 v153, v153
    v_mfma_f32_16x16x32_bf16 a[12:15], a[196:199], v[252:255], a[12:15]
    s_waitcnt lgkmcnt(8)
    v_add_f32 v4, v152, v4
    v_cvt_pk_bf16_f32 v202, v152, v153
    v_mfma_f32_16x16x32_bf16 a[16:19], a[200:203], v[224:227], a[16:19]
    ds_read_b64_tr_b16 a[192:193], v8 offset:1024
    v_add_f32 v4, v153, v4
    v_mfma_f32_16x16x32_bf16 a[16:19], a[204:207], v[240:243], a[16:19]
    ds_read_b64_tr_b16 a[194:195], v8 offset:7168
    v_add_u32 v6, s52, v12
    v_mfma_f32_16x16x32_bf16 a[20:23], a[200:203], v[228:231], a[20:23]
    ds_read_b64_tr_b16 a[196:197], v8 offset:13312
    v_add_u32 v7, s52, v13
    v_mfma_f32_16x16x32_bf16 a[20:23], a[204:207], v[244:247], a[20:23]
    ds_read_b64_tr_b16 a[198:199], v8 offset:19456
    v_mfma_f32_16x16x32_bf16 a[24:27], a[200:203], v[232:235], a[24:27]
    s_add_u32 m0, s47, 896
    v_exp_f32 v154, v154
    v_mfma_f32_16x16x32_bf16 a[24:27], a[204:207], v[248:251], a[24:27]
    buffer_load_dwordx4 v19, s[20:23], s49 offen offset:128 lds
    v_mfma_f32_16x16x32_bf16 a[28:31], a[200:203], v[236:239], a[28:31]
    v_exp_f32 v155, v155
    v_mfma_f32_16x16x32_bf16 a[28:31], a[204:207], v[252:255], a[28:31]
    s_waitcnt lgkmcnt(8)
    v_add_f32 v4, v154, v4
    v_cvt_pk_bf16_f32 v203, v154, v155
    v_mfma_f32_16x16x32_bf16 a[32:35], a[208:211], v[224:227], a[32:35]
    ds_read_b64_tr_b16 a[200:201], v9 offset:1024
    v_add_f32 v4, v155, v4
    v_mfma_f32_16x16x32_bf16 a[32:35], a[212:215], v[240:243], a[32:35]
    ds_read_b64_tr_b16 a[202:203], v9 offset:7168
    v_mfma_f32_16x16x32_bf16 a[36:39], a[208:211], v[228:231], a[36:39]
    ds_read_b64_tr_b16 a[204:205], v9 offset:13312
    v_mfma_f32_16x16x32_bf16 a[36:39], a[212:215], v[244:247], a[36:39]
    ds_read_b64_tr_b16 a[206:207], v9 offset:19456
    v_mfma_f32_16x16x32_bf16 a[40:43], a[208:211], v[232:235], a[40:43]
    v_exp_f32 v156, v156
    v_mfma_f32_16x16x32_bf16 a[40:43], a[212:215], v[248:251], a[40:43]
    v_add_f32 v5, v156, v5
    v_mfma_f32_16x16x32_bf16 a[44:47], a[208:211], v[236:239], a[44:47]
    v_exp_f32 v157, v157
    v_mfma_f32_16x16x32_bf16 a[44:47], a[212:215], v[252:255], a[44:47]
    s_waitcnt lgkmcnt(8)
    v_exp_f32 v158, v158
    v_mfma_f32_16x16x32_bf16 a[48:51], a[216:219], v[224:227], a[48:51]
    ds_read_b64_tr_b16 a[208:209], v10 offset:1024
    v_cvt_pk_bf16_f32 v206, v156, v157
    v_mfma_f32_16x16x32_bf16 a[48:51], a[220:223], v[240:243], a[48:51]
    ds_read_b64_tr_b16 a[210:211], v10 offset:7168
    v_add_f32 v5, v157, v5
    v_mfma_f32_16x16x32_bf16 a[52:55], a[216:219], v[228:231], a[52:55]
    ds_read_b64_tr_b16 a[212:213], v10 offset:13312
    v_add_f32 v5, v158, v5
    v_mfma_f32_16x16x32_bf16 a[52:55], a[220:223], v[244:247], a[52:55]
    ds_read_b64_tr_b16 a[214:215], v10 offset:19456
    v_mfma_f32_16x16x32_bf16 a[56:59], a[216:219], v[232:235], a[56:59]
    s_add_u32 m0, s47, 1792
    v_mfma_f32_16x16x32_bf16 a[56:59], a[220:223], v[248:251], a[56:59]
    buffer_load_dwordx4 v19, s[20:23], s49 offen offset:256 lds
    v_mfma_f32_16x16x32_bf16 a[60:63], a[216:219], v[236:239], a[60:63]
    v_exp_f32 v159, v159
    v_mfma_f32_16x16x32_bf16 a[60:63], a[220:223], v[252:255], a[60:63]
    s_waitcnt lgkmcnt(8)
    v_cvt_pk_bf16_f32 v207, v158, v159
    v_add_f32 v5, v159, v5
    v_mfma_f32_16x16x32_bf16 a[64:67], a[192:195], v[224:227], a[64:67]
    ds_read_b64_tr_b16 a[216:217], v11 offset:1024
    v_mfma_f32_16x16x32_bf16 a[64:67], a[196:199], v[240:243], a[64:67]
    ds_read_b64_tr_b16 a[218:219], v11 offset:7168
    v_mfma_f32_16x16x32_bf16 a[68:71], a[192:195], v[228:231], a[68:71]
    ds_read_b64_tr_b16 a[220:221], v11 offset:13312
    v_mfma_f32_16x16x32_bf16 a[68:71], a[196:199], v[244:247], a[68:71]
    ds_read_b64_tr_b16 a[222:223], v11 offset:19456
    v_mfma_f32_16x16x32_bf16 a[72:75], a[192:195], v[232:235], a[72:75]
    v_exp_f32 v160, v160
    v_mfma_f32_16x16x32_bf16 a[72:75], a[196:199], v[248:251], a[72:75]
    v_exp_f32 v161, v161
    v_mfma_f32_16x16x32_bf16 a[76:79], a[192:195], v[236:239], a[76:79]
    v_add_f32 v2, v160, v2
    v_cvt_pk_bf16_f32 v208, v160, v161
    v_mfma_f32_16x16x32_bf16 a[76:79], a[196:199], v[252:255], a[76:79]
    s_waitcnt lgkmcnt(8)
    v_exp_f32 v162, v162
    v_mfma_f32_16x16x32_bf16 a[80:83], a[200:203], v[224:227], a[80:83]
    ds_read_b64_tr_b16 a[192:193], v8 offset:2048
    v_add_f32 v2, v161, v2
    v_mfma_f32_16x16x32_bf16 a[80:83], a[204:207], v[240:243], a[80:83]
    ds_read_b64_tr_b16 a[194:195], v8 offset:8192
    v_add_f32 v2, v162, v2
    v_mfma_f32_16x16x32_bf16 a[84:87], a[200:203], v[228:231], a[84:87]
    ds_read_b64_tr_b16 a[196:197], v8 offset:14336
    v_mfma_f32_16x16x32_bf16 a[84:87], a[204:207], v[244:247], a[84:87]
    ds_read_b64_tr_b16 a[198:199], v8 offset:20480
    v_mfma_f32_16x16x32_bf16 a[88:91], a[200:203], v[232:235], a[88:91]
    s_add_u32 m0, s47, 12288
    v_exp_f32 v163, v163
    v_mfma_f32_16x16x32_bf16 a[88:91], a[204:207], v[248:251], a[88:91]
    buffer_load_dwordx4 v19, s[20:23], s50 offen offset:0 lds
    v_mfma_f32_16x16x32_bf16 a[92:95], a[200:203], v[236:239], a[92:95]
    v_cvt_pk_bf16_f32 v209, v162, v163
    v_add_f32 v2, v163, v2
    v_mfma_f32_16x16x32_bf16 a[92:95], a[204:207], v[252:255], a[92:95]
    s_waitcnt lgkmcnt(8)
    v_exp_f32 v164, v164
    v_mfma_f32_16x16x32_bf16 a[96:99], a[208:211], v[224:227], a[96:99]
    ds_read_b64_tr_b16 a[200:201], v9 offset:2048
    v_add_f32 v3, v164, v3
    v_mfma_f32_16x16x32_bf16 a[96:99], a[212:215], v[240:243], a[96:99]
    ds_read_b64_tr_b16 a[202:203], v9 offset:8192
    v_mfma_f32_16x16x32_bf16 a[100:103], a[208:211], v[228:231], a[100:103]
    ds_read_b64_tr_b16 a[204:205], v9 offset:14336
    v_mfma_f32_16x16x32_bf16 a[100:103], a[212:215], v[244:247], a[100:103]
    ds_read_b64_tr_b16 a[206:207], v9 offset:20480
    v_mfma_f32_16x16x32_bf16 a[104:107], a[208:211], v[232:235], a[104:107]
    s_add_u32 m0, s47, 13184
    v_mfma_f32_16x16x32_bf16 a[104:107], a[212:215], v[248:251], a[104:107]
    buffer_load_dwordx4 v19, s[20:23], s50 offen offset:128 lds
    v_mfma_f32_16x16x32_bf16 a[108:111], a[208:211], v[236:239], a[108:111]
    v_exp_f32 v165, v165
    v_mfma_f32_16x16x32_bf16 a[108:111], a[212:215], v[252:255], a[108:111]
    s_waitcnt lgkmcnt(8)
    v_exp_f32 v166, v166
    v_mfma_f32_16x16x32_bf16 a[112:115], a[216:219], v[224:227], a[112:115]
    ds_read_b64_tr_b16 a[208:209], v10 offset:2048
    v_cvt_pk_bf16_f32 v212, v164, v165
    v_mfma_f32_16x16x32_bf16 a[112:115], a[220:223], v[240:243], a[112:115]
    ds_read_b64_tr_b16 a[210:211], v10 offset:8192
    v_add_f32 v3, v165, v3
    v_mfma_f32_16x16x32_bf16 a[116:119], a[216:219], v[228:231], a[116:119]
    ds_read_b64_tr_b16 a[212:213], v10 offset:14336
    v_add_f32 v3, v166, v3
    v_mfma_f32_16x16x32_bf16 a[116:119], a[220:223], v[244:247], a[116:119]
    ds_read_b64_tr_b16 a[214:215], v10 offset:20480
    v_mfma_f32_16x16x32_bf16 a[120:123], a[216:219], v[232:235], a[120:123]
    s_add_u32 m0, s47, 14080
    v_mfma_f32_16x16x32_bf16 a[120:123], a[220:223], v[248:251], a[120:123]
    buffer_load_dwordx4 v19, s[20:23], s50 offen offset:256 lds
    v_mfma_f32_16x16x32_bf16 a[124:127], a[216:219], v[236:239], a[124:127]
    s_add_u32 s49, s49, 24576
    v_exp_f32 v167, v167
    v_mfma_f32_16x16x32_bf16 a[124:127], a[220:223], v[252:255], a[124:127]
    s_waitcnt lgkmcnt(8)
    v_cvt_pk_bf16_f32 v213, v166, v167
    v_add_f32 v3, v167, v3
    v_mfma_f32_16x16x32_bf16 a[128:131], a[192:195], v[224:227], a[128:131]
    ds_read_b64_tr_b16 a[216:217], v11 offset:2048
    v_mfma_f32_16x16x32_bf16 a[128:131], a[196:199], v[240:243], a[128:131]
    ds_read_b64_tr_b16 a[218:219], v11 offset:8192
    v_mfma_f32_16x16x32_bf16 a[132:135], a[192:195], v[228:231], a[132:135]
    ds_read_b64_tr_b16 a[220:221], v11 offset:14336
    v_mfma_f32_16x16x32_bf16 a[132:135], a[196:199], v[244:247], a[132:135]
    ds_read_b64_tr_b16 a[222:223], v11 offset:20480
    v_mfma_f32_16x16x32_bf16 a[136:139], a[192:195], v[232:235], a[136:139]
    s_add_u32 s50, s50, 24576
    v_exp_f32 v168, v168
    v_mfma_f32_16x16x32_bf16 a[136:139], a[196:199], v[248:251], a[136:139]
    s_add_u32 s47, s53, s58
    v_exp_f32 v169, v169
    v_mfma_f32_16x16x32_bf16 a[140:143], a[192:195], v[236:239], a[140:143]
    s_sub_u32 s44, s44, 1
    v_add_f32 v4, v168, v4
    v_cvt_pk_bf16_f32 v216, v168, v169
    v_mfma_f32_16x16x32_bf16 a[140:143], a[196:199], v[252:255], a[140:143]
    s_waitcnt lgkmcnt(8)
    v_exp_f32 v170, v170
    v_mfma_f32_16x16x32_bf16 a[144:147], a[200:203], v[224:227], a[144:147]
    v_exp_f32 v171, v171
    v_mfma_f32_16x16x32_bf16 a[144:147], a[204:207], v[240:243], a[144:147]
    s_waitcnt vmcnt(11) lgkmcnt(0)
    v_add_f32 v4, v169, v4
    v_add_f32 v4, v170, v4
    v_mfma_f32_16x16x32_bf16 a[148:151], a[200:203], v[228:231], a[148:151]
    s_barrier
    v_exp_f32 v172, v172
    v_mfma_f32_16x16x32_bf16 a[148:151], a[204:207], v[244:247], a[148:151]
    v_cvt_pk_bf16_f32 v217, v170, v171
    v_add_f32 v4, v171, v4
    v_mfma_f32_16x16x32_bf16 a[152:155], a[200:203], v[232:235], a[152:155]
    v_exp_f32 v173, v173
    v_mfma_f32_16x16x32_bf16 a[152:155], a[204:207], v[248:251], a[152:155]
    v_exp_f32 v174, v174
    v_mfma_f32_16x16x32_bf16 a[156:159], a[200:203], v[236:239], a[156:159]
    v_add_f32 v5, v172, v5
    v_cvt_pk_bf16_f32 v220, v172, v173
    v_mfma_f32_16x16x32_bf16 a[156:159], a[204:207], v[252:255], a[156:159]
    v_exp_f32 v175, v175
    v_mfma_f32_16x16x32_bf16 a[160:163], a[208:211], v[224:227], a[160:163]
    ds_read_b128 a[192:195], v6 offset:0
    v_add_f32 v5, v173, v5
    v_mfma_f32_16x16x32_bf16 a[160:163], a[212:215], v[240:243], a[160:163]
    ds_read_b128 a[196:199], v7 offset:0
    v_add_f32 v5, v174, v5
    v_mfma_f32_16x16x32_bf16 a[164:167], a[208:211], v[228:231], a[164:167]
    v_cvt_pk_bf16_f32 v221, v174, v175
    v_add_f32 v5, v175, v5
    v_mfma_f32_16x16x32_bf16 a[164:167], a[212:215], v[244:247], a[164:167]
    v_exp_f32 v176, v176
    v_mfma_f32_16x16x32_bf16 a[168:171], a[208:211], v[232:235], a[168:171]
    v_exp_f32 v177, v177
    v_mfma_f32_16x16x32_bf16 a[168:171], a[212:215], v[248:251], a[168:171]
    v_add_f32 v2, v176, v2
    v_cvt_pk_bf16_f32 v210, v176, v177
    v_mfma_f32_16x16x32_bf16 a[172:175], a[208:211], v[236:239], a[172:175]
    v_exp_f32 v178, v178
    v_mfma_f32_16x16x32_bf16 a[172:175], a[212:215], v[252:255], a[172:175]
    v_exp_f32 v179, v179
    v_mfma_f32_16x16x32_bf16 a[176:179], a[216:219], v[224:227], a[176:179]
    ds_read_b128 a[200:203], v6 offset:1024
    v_add_f32 v2, v177, v2
    v_mfma_f32_16x16x32_bf16 a[176:179], a[220:223], v[240:243], a[176:179]
    ds_read_b128 a[204:207], v7 offset:1024
    v_add_f32 v2, v178, v2
    v_mfma_f32_16x16x32_bf16 a[180:183], a[216:219], v[228:231], a[180:183]
    s_cmp_lg_u32 s44, 0
    v_cvt_pk_bf16_f32 v211, v178, v179
    v_add_f32 v2, v179, v2
    v_mfma_f32_16x16x32_bf16 a[180:183], a[220:223], v[244:247], a[180:183]
    v_exp_f32 v180, v180
    v_mfma_f32_16x16x32_bf16 a[184:187], a[216:219], v[232:235], a[184:187]
    v_add_f32 v3, v180, v3
    v_mfma_f32_16x16x32_bf16 a[184:187], a[220:223], v[248:251], a[184:187]
    v_exp_f32 v181, v181
    v_mfma_f32_16x16x32_bf16 a[188:191], a[216:219], v[236:239], a[188:191]
    v_exp_f32 v182, v182
    v_mfma_f32_16x16x32_bf16 a[188:191], a[220:223], v[252:255], a[188:191]
    s_waitcnt lgkmcnt(2)
    v_cvt_pk_bf16_f32 v214, v180, v181
    v_add_f32 v3, v181, v3
    s_branch L_att_loop
L_hooka:
    s_cmp_eq_u32 s44, 15
    s_cbranch_scc1 L_hL
    s_cmp_eq_u32 s44, 13
    s_cbranch_scc1 L_hC
    s_cmp_eq_u32 s44, 3
    s_cbranch_scc1 L_hF
    s_cmp_eq_u32 s44, 7
    s_cbranch_scc1 L_hT
    s_mov_b32 s39, 15
    s_cmp_lg_u32 s38, 0
    s_cbranch_scc1 L_hret
    s_lshl_b32 s45, s2, 2
    s_add_u32 s45, s45, 65536
    s_mov_b64 exec, 1
    buffer_store_dword v37, v36, s[92:95], s45 offen sc1
    s_mov_b64 exec, -1
    s_nop 1
    s_branch L_hret
L_hL:
    s_mov_b32 s39, 13
    s_mov_b32 s45, 65536
    buffer_load_dwordx4 v[20:23], v1, s[92:95], s45 offen sc1
    s_branch L_hret
L_hT:
    s_mov_b32 s39, 3
    s_memrealtime s[8:9]
    s_lshl_b32 s45, s2, 3
    s_add_u32 s45, s45, 98304
    v_mov_b32 v58, v37
    s_waitcnt lgkmcnt(0)
    v_mov_b32 v59, s8
    s_mov_b64 exec, 1
    buffer_store_dwordx2 v[58:59], v36, s[92:95], s45 offen sc1
    s_mov_b64 exec, -1
    s_nop 1
    s_branch L_hret
L_hC:
    s_mov_b32 s39, s3
    v_xor_b32 v20, v20, v37
    v_xor_b32 v21, v21, v37
    v_xor_b32 v22, v22, v37
    v_xor_b32 v23, v23, v37
    v_or3_b32 v20, v20, v21, v22
    v_or_b32 v20, v20, v23
    v_cmp_ne_u32 vcc, 0, v20
    s_cbranch_vccnz L_hret
    s_and_b32 s8, s2, 3
    s_bfe_u32 s9, s2, 0x30003
    s_lshr_b32 s10, s2, 6
    s_cmp_ge_u32 s38, 2
    s_cbranch_scc1 L_hC2
    s_bfe_u32 s45, s2, 0x10002
    s_lshl_b32 s45, s45, 3
    s_add_u32 s45, s45, s9
    s_lshl_b32 s45, s45, 2
    s_add_u32 s45, s45, s10
    s_lshl_b32 s45, s45, 1
    s_add_u32 s45, s45, s38
    s_mul_i32 s45, s45, 49152
    s_mul_i32 s46, s8, 12288
    s_add_u32 s96, s45, s46
    s_mov_b32 s101, 1024
    s_mov_b32 s32, s24
    s_mov_b32 s33, s25
    s_mov_b32 s34, 6291456
    v_mov_b32 v32, v1
    s_branch L_hret
L_hC2:
    s_mul_i32 s45, s8, 491520
    s_mul_i32 s46, s10, 10240
    s_add_u32 s45, s45, s46
    s_mul_i32 s46, s9, 1280
    s_add_u32 s45, s45, s46
    s_mul_i32 s46, s38, 640
    s_add_u32 s45, s45, s46
    s_add_u32 s96, s45, 7863040
    s_mov_b32 s101, 40960
    s_mov_b32 s32, s88
    s_mov_b32 s33, s89
    s_mov_b32 s34, 9830400
    v_min_u32 v32, 624, v1
    s_branch L_hret
L_hF:
    s_getpc_b64 s[4:5]
L_pc1:
    s_add_u32 s4, s4, L_att_tail-L_pc1
    s_addc_u32 s5, s5, 0
    s_mov_b32 s6, L_end-L_att_tail
    s_mov_b32 s7, 0x00020000
    s_bfe_u32 s45, s2, 0x30003
    s_lshl_b32 s45, s45, 2
    s_add_u32 s45, s45, s38
    s_mul_i32 s45, s45, 640
    v_min_u32 v25, 512, v63
    buffer_load_dword v24, v25, s[4:7], s45 offen
    s_mov_b32 s45, 98304
    v_and_b32 v57, 7, v0
    v_lshlrev_b32 v57, 3, v57
    buffer_load_dwordx2 v[58:59], v57, s[92:95], s45 offen sc1
    s_cmp_lg_u32 s38, 0
    s_cbranch_scc1 L_hret
    s_mov_b32 s45, 65536
    buffer_load_dwordx4 v[20:23], v1, s[92:95], s45 offen sc1
    s_branch L_hret
L_maxfirst:
    v_mfma_f32_32x32x16_bf16 a[0:15], v[48:51], v[48:51], 0
    v_mfma_f32_32x32x16_bf16 a[16:31], v[48:51], v[48:51], 0
    v_mfma_f32_32x32x16_bf16 a[32:47], v[48:51], v[48:51], 0
    v_mfma_f32_32x32x16_bf16 a[48:63], v[48:51], v[48:51], 0
    v_mfma_f32_32x32x16_bf16 a[64:79], v[48:51], v[48:51], 0
    v_mfma_f32_32x32x16_bf16 a[80:95], v[48:51], v[48:51], 0
    v_mfma_f32_32x32x16_bf16 a[96:111], v[48:51], v[48:51], 0
    v_mfma_f32_32x32x16_bf16 a[112:127], v[48:51], v[48:51], 0
    v_mfma_f32_32x32x16_bf16 a[128:143], v[48:51], v[48:51], 0
    v_mfma_f32_32x32x16_bf16 a[144:159], v[48:51], v[48:51], 0
    v_mfma_f32_32x32x16_bf16 a[160:175], v[48:51], v[48:51], 0
    v_mfma_f32_32x32x16_bf16 a[176:191], v[48:51], v[48:51], 0
    s_mov_b32 s59, 786432
L_maxnext:
    s_sub_u32 s59, s59, 24576
    s_add_u32 s45, s59, 12288
    v_mov_b32 v6, v12
    v_mov_b32 v7, v13
    s_add_u32 m0, s48, 0
    s_nop 0
    buffer_load_dwordx4 v18, s[16:19], s59 offen offset:0 lds
    s_add_u32 m0, s48, 896
    s_nop 0
    buffer_load_dwordx4 v18, s[16:19], s59 offen offset:128 lds
    s_add_u32 m0, s48, 1792
    s_nop 0
    buffer_load_dwordx4 v18, s[16:19], s59 offen offset:256 lds
    s_add_u32 m0, s48, 12288
    s_nop 0
    buffer_load_dwordx4 v18, s[16:19], s45 offen offset:0 lds
    s_add_u32 m0, s48, 13184
    s_nop 0
    buffer_load_dwordx4 v18, s[16:19], s45 offen offset:128 lds
    s_add_u32 m0, s48, 14080
    s_nop 0
    buffer_load_dwordx4 v18, s[16:19], s45 offen offset:256 lds
    s_waitcnt vmcnt(0)
    s_barrier
    ds_read_b128 a[192:195], v6 offset:0
    ds_read_b128 a[196:199], v7 offset:0
    ds_read_b128 a[200:203], v6 offset:1024
    ds_read_b128 a[204:207], v7 offset:1024
    ds_read_b128 a[208:211], v6 offset:2048
    ds_read_b128 a[212:215], v7 offset:2048
    s_waitcnt lgkmcnt(4)
    v_mfma_f32_16x16x32_bf16 v[128:131], a[192:195], v[64:67], 0
    v_mfma_f32_16x16x32_bf16 v[128:131], a[196:199], v[80:83], v[128:131]
    v_mfma_f32_16x16x32_bf16 v[132:135], a[192:195], v[68:71], 0
    v_mfma_f32_16x16x32_bf16 v[132:135], a[196:199], v[84:87], v[132:135]
    v_mfma_f32_16x16x32_bf16 v[136:139], a[192:195], v[72:75], 0
    v_mfma_f32_16x16x32_bf16 v[136:139], a[196:199], v[88:91], v[136:139]
    v_mfma_f32_16x16x32_bf16 v[140:143], a[192:195], v[76:79], 0
    v_mfma_f32_16x16x32_bf16 v[140:143], a[196:199], v[92:95], v[140:143]
    s_waitcnt lgkmcnt(2)
    v_mfma_f32_16x16x32_bf16 v[128:131], a[200:203], v[96:99], v[128:131]
    ds_read_b128 a[216:219], v6 offset:6144
    v_mfma_f32_16x16x32_bf16 v[128:131], a[204:207], v[112:115], v[128:131]
    ds_read_b128 a[220:223], v7 offset:6144
    v_mfma_f32_16x16x32_bf16 v[132:135], a[200:203], v[100:103], v[132:135]
    v_mfma_f32_16x16x32_bf16 v[132:135], a[204:207], v[116:119], v[132:135]
    v_mfma_f32_16x16x32_bf16 v[136:139], a[200:203], v[104:107], v[136:139]
    v_mfma_f32_16x16x32_bf16 v[136:139], a[204:207], v[120:123], v[136:139]
    v_mfma_f32_16x16x32_bf16 v[140:143], a[200:203], v[108:111], v[140:143]
    v_mfma_f32_16x16x32_bf16 v[140:143], a[204:207], v[124:127], v[140:143]
    s_waitcnt lgkmcnt(2)
    v_mfma_f32_16x16x32_bf16 v[128:131], a[208:211], a[224:227], v[128:131]
    ds_read_b128 a[192:195], v6 offset:7168
    v_mfma_f32_16x16x32_bf16 v[128:131], a[212:215], a[240:243], v[128:131]
    ds_read_b128 a[196:199], v7 offset:7168
    v_mfma_f32_16x16x32_bf16 v[132:135], a[208:211], a[228:231], v[132:135]
    v_mfma_f32_16x16x32_bf16 v[132:135], a[212:215], a[244:247], v[132:135]
    v_mfma_f32_16x16x32_bf16 v[136:139], a[208:211], a[232:235], v[136:139]
    v_mfma_f32_16x16x32_bf16 v[136:139], a[212:215], a[248:251], v[136:139]
    v_mfma_f32_16x16x32_bf16 v[140:143], a[208:211], a[236:239], v[140:143]
    v_mfma_f32_16x16x32_bf16 v[140:143], a[212:215], a[252:255], v[140:143]
    s_waitcnt lgkmcnt(2)
    v_mfma_f32_16x16x32_bf16 v[144:147], a[216:219], v[64:67], 0
    ds_read_b128 a[200:203], v6 offset:8192
    v_mfma_f32_16x16x32_bf16 v[144:147], a[220:223], v[80:83], v[144:147]
    ds_read_b128 a[204:207], v7 offset:8192
    v_mfma_f32_16x16x32_bf16 v[148:151], a[216:219], v[68:71], 0
    v_mfma_f32_16x16x32_bf16 v[148:151], a[220:223], v[84:87], v[148:151]
    v_mfma_f32_16x16x32_bf16 v[152:155], a[216:219], v[72:75], 0
    v_mfma_f32_16x16x32_bf16 v[152:155], a[220:223], v[88:91], v[152:155]
    v_mfma_f32_16x16x32_bf16 v[156:159], a[216:219], v[76:79], 0
    v_mfma_f32_16x16x32_bf16 v[156:159], a[220:223], v[92:95], v[156:159]
    s_waitcnt lgkmcnt(2)
    v_mfma_f32_16x16x32_bf16 v[144:147], a[192:195], v[96:99], v[144:147]
    ds_read_b128 a[208:211], v6 offset:12288
    v_max3_f32 v20, v20, v128, v129
    v_mfma_f32_16x16x32_bf16 v[144:147], a[196:199], v[112:115], v[144:147]
    ds_read_b128 a[212:215], v7 offset:12288
    v_max3_f32 v20, v20, v130, v131
    v_mfma_f32_16x16x32_bf16 v[148:151], a[192:195], v[100:103], v[148:151]
    v_max3_f32 v21, v21, v132, v133
    v_max3_f32 v21, v21, v134, v135
    v_mfma_f32_16x16x32_bf16 v[148:151], a[196:199], v[116:119], v[148:151]
    v_max3_f32 v22, v22, v136, v137
    v_max3_f32 v22, v22, v138, v139
    v_mfma_f32_16x16x32_bf16 v[152:155], a[192:195], v[104:107], v[152:155]
    v_max3_f32 v23, v23, v140, v141
    v_max3_f32 v23, v23, v142, v143
    v_mfma_f32_16x16x32_bf16 v[152:155], a[196:199], v[120:123], v[152:155]
    v_mfma_f32_16x16x32_bf16 v[156:159], a[192:195], v[108:111], v[156:159]
    v_mfma_f32_16x16x32_bf16 v[156:159], a[196:199], v[124:127], v[156:159]
    s_waitcnt lgkmcnt(2)
    v_mfma_f32_16x16x32_bf16 v[144:147], a[200:203], a[224:227], v[144:147]
    ds_read_b128 a[216:219], v6 offset:13312
    v_mfma_f32_16x16x32_bf16 v[144:147], a[204:207], a[240:243], v[144:147]
    ds_read_b128 a[220:223], v7 offset:13312
    v_mfma_f32_16x16x32_bf16 v[148:151], a[200:203], a[228:231], v[148:151]
    v_mfma_f32_16x16x32_bf16 v[148:151], a[204:207], a[244:247], v[148:151]
    v_mfma_f32_16x16x32_bf16 v[152:155], a[200:203], a[232:235], v[152:155]
    v_mfma_f32_16x16x32_bf16 v[152:155], a[204:207], a[248:251], v[152:155]
    v_mfma_f32_16x16x32_bf16 v[156:159], a[200:203], a[236:239], v[156:159]
    v_mfma_f32_16x16x32_bf16 v[156:159], a[204:207], a[252:255], v[156:159]
    s_waitcnt lgkmcnt(2)
    v_mfma_f32_16x16x32_bf16 v[160:163], a[208:211], v[64:67], 0
    ds_read_b128 a[192:195], v6 offset:14336
    v_mfma_f32_16x16x32_bf16 v[160:163], a[212:215], v[80:83], v[160:163]
    ds_read_b128 a[196:199], v7 offset:14336
    v_mfma_f32_16x16x32_bf16 v[164:167], a[208:211], v[68:71], 0
    v_mfma_f32_16x16x32_bf16 v[164:167], a[212:215], v[84:87], v[164:167]
    v_mfma_f32_16x16x32_bf16 v[168:171], a[208:211], v[72:75], 0
    v_mfma_f32_16x16x32_bf16 v[168:171], a[212:215], v[88:91], v[168:171]
    v_mfma_f32_16x16x32_bf16 v[172:175], a[208:211], v[76:79], 0
    v_mfma_f32_16x16x32_bf16 v[172:175], a[212:215], v[92:95], v[172:175]
    s_waitcnt lgkmcnt(2)
    v_mfma_f32_16x16x32_bf16 v[160:163], a[216:219], v[96:99], v[160:163]
    ds_read_b128 a[200:203], v6 offset:18432
    v_max3_f32 v20, v20, v144, v145
    v_mfma_f32_16x16x32_bf16 v[160:163], a[220:223], v[112:115], v[160:163]
    ds_read_b128 a[204:207], v7 offset:18432
    v_max3_f32 v20, v20, v146, v147
    v_mfma_f32_16x16x32_bf16 v[164:167], a[216:219], v[100:103], v[164:167]
    v_max3_f32 v21, v21, v148, v149
    v_max3_f32 v21, v21, v150, v151
    v_mfma_f32_16x16x32_bf16 v[164:167], a[220:223], v[116:119], v[164:167]
    v_max3_f32 v22, v22, v152, v153
    v_max3_f32 v22, v22, v154, v155
    v_mfma_f32_16x16x32_bf16 v[168:171], a[216:219], v[104:107], v[168:171]
    v_max3_f32 v23, v23, v156, v157
    v_max3_f32 v23, v23, v158, v159
    v_mfma_f32_16x16x32_bf16 v[168:171], a[220:223], v[120:123], v[168:171]
    v_mfma_f32_16x16x32_bf16 v[172:175], a[216:219], v[108:111], v[172:175]
    v_mfma_f32_16x16x32_bf16 v[172:175], a[220:223], v[124:127], v[172:175]
    s_waitcnt lgkmcnt(2)
    v_mfma_f32_16x16x32_bf16 v[160:163], a[192:195], a[224:227], v[160:163]
    ds_read_b128 a[208:211], v6 offset:19456
    v_mfma_f32_16x16x32_bf16 v[160:163], a[196:199], a[240:243], v[160:163]
    ds_read_b128 a[212:215], v7 offset:19456
    v_mfma_f32_16x16x32_bf16 v[164:167], a[192:195], a[228:231], v[164:167]
    v_mfma_f32_16x16x32_bf16 v[164:167], a[196:199], a[244:247], v[164:167]
    v_mfma_f32_16x16x32_bf16 v[168:171], a[192:195], a[232:235], v[168:171]
    v_mfma_f32_16x16x32_bf16 v[168:171], a[196:199], a[248:251], v[168:171]
    v_mfma_f32_16x16x32_bf16 v[172:175], a[192:195], a[236:239], v[172:175]
    v_mfma_f32_16x16x32_bf16 v[172:175], a[196:199], a[252:255], v[172:175]
    s_waitcnt lgkmcnt(2)
    v_mfma_f32_16x16x32_bf16 v[176:179], a[200:203], v[64:67], 0
    ds_read_b128 a[216:219], v6 offset:20480
    v_mfma_f32_16x16x32_bf16 v[176:179], a[204:207], v[80:83], v[176:179]
    ds_read_b128 a[220:223], v7 offset:20480
    v_mfma_f32_16x16x32_bf16 v[180:183], a[200:203], v[68:71], 0
    v_mfma_f32_16x16x32_bf16 v[180:183], a[204:207], v[84:87], v[180:183]
    v_mfma_f32_16x16x32_bf16 v[184:187], a[200:203], v[72:75], 0
    v_mfma_f32_16x16x32_bf16 v[184:187], a[204:207], v[88:91], v[184:187]
    v_mfma_f32_16x16x32_bf16 v[188:191], a[200:203], v[76:79], 0
    v_mfma_f32_16x16x32_bf16 v[188:191], a[204:207], v[92:95], v[188:191]
    s_waitcnt lgkmcnt(2)
    v_mfma_f32_16x16x32_bf16 v[176:179], a[208:211], v[96:99], v[176:179]
    v_max3_f32 v20, v20, v160, v161
    v_max3_f32 v20, v20, v162, v163
    v_mfma_f32_16x16x32_bf16 v[176:179], a[212:215], v[112:115], v[176:179]
    v_max3_f32 v21, v21, v164, v165
    v_max3_f32 v21, v21, v166, v167
    v_mfma_f32_16x16x32_bf16 v[180:183], a[208:211], v[100:103], v[180:183]
    v_max3_f32 v22, v22, v168, v169
    v_max3_f32 v22, v22, v170, v171
    v_mfma_f32_16x16x32_bf16 v[180:183], a[212:215], v[116:119], v[180:183]
    v_max3_f32 v23, v23, v172, v173
    v_max3_f32 v23, v23, v174, v175
    v_mfma_f32_16x16x32_bf16 v[184:187], a[208:211], v[104:107], v[184:187]
    v_mfma_f32_16x16x32_bf16 v[184:187], a[212:215], v[120:123], v[184:187]
    v_mfma_f32_16x16x32_bf16 v[188:191], a[208:211], v[108:111], v[188:191]
    v_mfma_f32_16x16x32_bf16 v[188:191], a[212:215], v[124:127], v[188:191]
    s_waitcnt lgkmcnt(0)
    v_mfma_f32_16x16x32_bf16 v[176:179], a[216:219], a[224:227], v[176:179]
    v_mfma_f32_16x16x32_bf16 v[176:179], a[220:223], a[240:243], v[176:179]
    v_mfma_f32_16x16x32_bf16 v[180:183], a[216:219], a[228:231], v[180:183]
    v_mfma_f32_16x16x32_bf16 v[180:183], a[220:223], a[244:247], v[180:183]
    v_mfma_f32_16x16x32_bf16 v[184:187], a[216:219], a[232:235], v[184:187]
    v_mfma_f32_16x16x32_bf16 v[184:187], a[220:223], a[248:251], v[184:187]
    v_mfma_f32_16x16x32_bf16 v[188:191], a[216:219], a[236:239], v[188:191]
    v_mfma_f32_16x16x32_bf16 v[188:191], a[220:223], a[252:255], v[188:191]
    s_waitcnt vmcnt(24)
    s_barrier
    s_cmp_lg_u32 s59, 0
    v_add_u32 v6, 24576, v12
    v_add_u32 v7, 24576, v13
    s_nop 1
    v_max3_f32 v20, v20, v176, v177
    v_max3_f32 v20, v20, v178, v179
    v_max3_f32 v21, v21, v180, v181
    v_max3_f32 v21, v21, v182, v183
    v_max3_f32 v22, v22, v184, v185
    v_max3_f32 v22, v22, v186, v187
    v_max3_f32 v23, v23, v188, v189
    v_max3_f32 v23, v23, v190, v191
    s_cbranch_scc1 L_maxnext
    s_branch L_qkdone
L_fallback:
    s_waitcnt vmcnt(0) lgkmcnt(0)
    s_barrier
    s_mov_b32 s51, 1
    s_branch L_restart
L_nonce:
    s_mov_b32 s45, 163840
    s_mov_b32 exec_hi, 0
    buffer_store_dword v37, v62, s[92:95], s45 offen sc1
    s_mov_b32 exec_hi, -1
    s_nop 1
    s_branch L_nononce
L_repoll2:
    s_mov_b32 s45, 65536
    buffer_load_dwordx4 v[20:23], v1, s[92:95], s45 offen sc1
    s_waitcnt vmcnt(0)
    s_branch L_chk2
L_rets:
    s_mov_b32 s45, 98304
    v_and_b32 v57, 7, v0
    v_lshlrev_b32 v57, 3, v57
    buffer_load_dwordx2 v[58:59], v57, s[92:95], s45 offen sc1
    s_waitcnt vmcnt(0)
    s_branch L_ok2
L_att_tail:
    v_add_u32 v8, s40, v14
    v_add_u32 v9, s40, v15
    v_add_u32 v10, s40, v16
    v_add_u32 v11, s40, v17
    ds_read_b64_tr_b16 a[192:193], v8 offset:0
    ds_read_b64_tr_b16 a[194:195], v8 offset:6144
    ds_read_b64_tr_b16 a[196:197], v8 offset:12288
    ds_read_b64_tr_b16 a[198:199], v8 offset:18432
    ds_read_b64_tr_b16 a[200:201], v9 offset:0
    ds_read_b64_tr_b16 a[202:203], v9 offset:6144
    ds_read_b64_tr_b16 a[204:205], v9 offset:12288
    ds_read_b64_tr_b16 a[206:207], v9 offset:18432
    ds_read_b64_tr_b16 a[208:209], v10 offset:0
    ds_read_b64_tr_b16 a[210:211], v10 offset:6144
    ds_read_b64_tr_b16 a[212:213], v10 offset:12288
    ds_read_b64_tr_b16 a[214:215], v10 offset:18432
    s_cmp_lg_u32 s38, 0
    s_cbranch_scc1 L_ok2
L_chk2:
    v_xor_b32 v20, v20, v37
    v_xor_b32 v21, v21, v37
    v_xor_b32 v22, v22, v37
    v_xor_b32 v23, v23, v37
    v_or3_b32 v20, v20, v21, v22
    v_or_b32 v20, v20, v23
    v_cmp_ne_u32 vcc, 0, v20
    s_cbranch_vccnz L_repoll2
L_ok2:
    v_cmp_ne_u32 vcc, v37, v58
    s_cbranch_vccnz L_rets
    v_add_f32 v3, v182, v3
    v_exp_f32 v183, v183
    s_nop 0
    v_cvt_pk_bf16_f32 v247, v182, v183
    v_add_f32 v3, v183, v3
    v_exp_f32 v184, v184
    s_nop 0
    v_exp_f32 v185, v185
    s_nop 0
    v_add_f32 v4, v184, v4
    v_cvt_pk_bf16_f32 v250, v184, v185
    v_add_f32 v4, v185, v4
    v_exp_f32 v186, v186
    s_nop 0
    v_exp_f32 v187, v187
    s_nop 0
    v_add_f32 v4, v186, v4
    v_cvt_pk_bf16_f32 v251, v186, v187
    v_exp_f32 v188, v188
    s_nop 0
    v_add_f32 v4, v187, v4
    v_add_f32 v5, v188, v5
    v_exp_f32 v189, v189
    s_nop 0
    v_exp_f32 v190, v190
    s_nop 0
    v_cvt_pk_bf16_f32 v254, v188, v189
    v_add_f32 v5, v189, v5
    v_exp_f32 v191, v191
    s_nop 0
    v_add_f32 v5, v190, v5
    v_cvt_pk_bf16_f32 v255, v190, v191
    v_add_f32 v5, v191, v5
    s_waitcnt lgkmcnt(8)
    s_nop 1
    v_mfma_f32_16x16x32_bf16 a[0:3], a[192:195], v[224:227], a[0:3]
    ds_read_b64_tr_b16 a[216:217], v11 offset:0
    v_mov_b32 v24, v2
    v_mfma_f32_16x16x32_bf16 a[0:3], a[196:199], v[240:243], a[0:3]
    ds_read_b64_tr_b16 a[218:219], v11 offset:6144
    v_mov_b32 v25, v3
    v_mfma_f32_16x16x32_bf16 a[4:7], a[192:195], v[228:231], a[4:7]
    ds_read_b64_tr_b16 a[220:221], v11 offset:12288
    v_mov_b32 v26, v4
    v_mfma_f32_16x16x32_bf16 a[4:7], a[196:199], v[244:247], a[4:7]
    ds_read_b64_tr_b16 a[222:223], v11 offset:18432
    v_mov_b32 v27, v5
    v_mfma_f32_16x16x32_bf16 a[8:11], a[192:195], v[232:235], a[8:11]
    s_waitcnt vmcnt(0)
    v_mfma_f32_16x16x32_bf16 a[8:11], a[196:199], v[248:251], a[8:11]
    s_barrier
    v_mfma_f32_16x16x32_bf16 a[12:15], a[192:195], v[236:239], a[12:15]
    s_or_b32 s45, s2, s38
    s_cmp_eq_u32 s45, 0
    s_cbranch_scc1 L_nonce
L_nononce:
    v_mfma_f32_16x16x32_bf16 a[12:15], a[196:199], v[252:255], a[12:15]
    s_waitcnt lgkmcnt(8)
    s_and_b32 s40, s2, 3
    s_bfe_u32 s45, s2, 0x10002
    s_lshl_b32 s45, s45, 3
    v_mfma_f32_16x16x32_bf16 a[16:19], a[200:203], v[224:227], a[16:19]
    ds_read_b64_tr_b16 a[192:193], v8 offset:1024
    v_permlane32_swap_b32 v2, v24
    v_mfma_f32_16x16x32_bf16 a[16:19], a[204:207], v[240:243], a[16:19]
    ds_read_b64_tr_b16 a[194:195], v8 offset:7168
    v_permlane32_swap_b32 v3, v25
    v_mfma_f32_16x16x32_bf16 a[20:23], a[200:203], v[228:231], a[20:23]
    ds_read_b64_tr_b16 a[196:197], v8 offset:13312
    v_permlane32_swap_b32 v4, v26
    v_mfma_f32_16x16x32_bf16 a[20:23], a[204:207], v[244:247], a[20:23]
    ds_read_b64_tr_b16 a[198:199], v8 offset:19456
    v_permlane32_swap_b32 v5, v27
    v_mfma_f32_16x16x32_bf16 a[24:27], a[200:203], v[232:235], a[24:27]
    s_bfe_u32 s41, s2, 0x30003
    s_add_u32 s41, s41, s45
    s_lshr_b32 s42, s2, 6
    v_mfma_f32_16x16x32_bf16 a[24:27], a[204:207], v[248:251], a[24:27]
    s_lshl_b32 s55, s41, 2
    s_add_u32 s55, s55, s42
    s_lshl_b32 s45, s41, 3
    v_mfma_f32_16x16x32_bf16 a[28:31], a[200:203], v[236:239], a[28:31]
    s_lshl_b32 s46, s38, 1
    s_add_u32 s45, s45, s46
    s_xor_b32 s45, s45, s40
    v_mfma_f32_16x16x32_bf16 a[28:31], a[204:207], v[252:255], a[28:31]
    s_waitcnt lgkmcnt(8)
    s_mul_i32 s46, s45, 196608
    v_add_u32 v14, s46, v1
    s_mul_i32 s46, s45, 49152
    v_mfma_f32_16x16x32_bf16 a[32:35], a[208:211], v[224:227], a[32:35]
    ds_read_b64_tr_b16 a[200:201], v9 offset:1024
    v_add_f32 v2, v2, v24
    v_mfma_f32_16x16x32_bf16 a[32:35], a[212:215], v[240:243], a[32:35]
    ds_read_b64_tr_b16 a[202:203], v9 offset:7168
    v_add_f32 v3, v3, v25
    v_mfma_f32_16x16x32_bf16 a[36:39], a[208:211], v[228:231], a[36:39]
    ds_read_b64_tr_b16 a[204:205], v9 offset:13312
    v_add_f32 v4, v4, v26
    v_mfma_f32_16x16x32_bf16 a[36:39], a[212:215], v[244:247], a[36:39]
    ds_read_b64_tr_b16 a[206:207], v9 offset:19456
    v_add_f32 v5, v5, v27
    v_mfma_f32_16x16x32_bf16 a[40:43], a[208:211], v[232:235], a[40:43]
    v_add_u32 v12, s46, v1
    s_xor_b32 s45, s45, 1
    v_mfma_f32_16x16x32_bf16 a[40:43], a[212:215], v[248:251], a[40:43]
    s_mul_i32 s46, s45, 196608
    v_add_u32 v15, s46, v1
    s_mul_i32 s46, s45, 49152
    v_mfma_f32_16x16x32_bf16 a[44:47], a[208:211], v[236:239], a[44:47]
    v_add_u32 v13, s46, v1
    s_mul_i32 s43, s40, 12288
    v_mfma_f32_16x16x32_bf16 a[44:47], a[212:215], v[252:255], a[44:47]
    s_waitcnt lgkmcnt(8)
    s_lshr_b32 s45, s38, 1
    s_mul_i32 s56, s45, 40960
    s_mul_i32 s54, s45, 10240
    v_mfma_f32_16x16x32_bf16 a[48:51], a[216:219], v[224:227], a[48:51]
    ds_read_b64_tr_b16 a[208:209], v10 offset:1024
    v_mov_b32 v24, v2
    v_mfma_f32_16x16x32_bf16 a[48:51], a[220:223], v[240:243], a[48:51]
    ds_read_b64_tr_b16 a[210:211], v10 offset:7168
    v_mov_b32 v25, v3
    v_mfma_f32_16x16x32_bf16 a[52:55], a[216:219], v[228:231], a[52:55]
    ds_read_b64_tr_b16 a[212:213], v10 offset:13312
    v_mov_b32 v26, v4
    v_mfma_f32_16x16x32_bf16 a[52:55], a[220:223], v[244:247], a[52:55]
    ds_read_b64_tr_b16 a[214:215], v10 offset:19456
    v_mov_b32 v27, v5
    v_mfma_f32_16x16x32_bf16 a[56:59], a[216:219], v[232:235], a[56:59]
    s_lshl_b32 s45, s45, 13
    v_add_u32 v16, s45, v1
    s_and_b32 s45, s38, 1
    v_mfma_f32_16x16x32_bf16 a[56:59], a[220:223], v[248:251], a[56:59]
    s_mul_i32 s45, s45, 5120
    s_add_u32 s56, s56, s45
    s_add_u32 s45, s45, 16384
    v_mfma_f32_16x16x32_bf16 a[60:63], a[216:219], v[236:239], a[60:63]
    s_add_u32 s54, s54, s45
    v_add_u32 v17, s45, v1
    s_mul_i32 s45, s42, 10240
    v_mfma_f32_16x16x32_bf16 a[60:63], a[220:223], v[252:255], a[60:63]
    s_waitcnt lgkmcnt(8)
    s_add_u32 s56, s56, s45
    s_mul_i32 s45, s40, 491520
    s_add_u32 s47, s56, s45
    v_mfma_f32_16x16x32_bf16 a[64:67], a[192:195], v[224:227], a[64:67]
    ds_read_b64_tr_b16 a[216:217], v11 offset:1024
    v_permlane16_swap_b32 v2, v24
    v_mfma_f32_16x16x32_bf16 a[64:67], a[196:199], v[240:243], a[64:67]
    ds_read_b64_tr_b16 a[218:219], v11 offset:7168
    v_permlane16_swap_b32 v3, v25
    v_mfma_f32_16x16x32_bf16 a[68:71], a[192:195], v[228:231], a[68:71]
    ds_read_b64_tr_b16 a[220:221], v11 offset:13312
    v_permlane16_swap_b32 v4, v26
    v_mfma_f32_16x16x32_bf16 a[68:71], a[196:199], v[244:247], a[68:71]
    ds_read_b64_tr_b16 a[222:223], v11 offset:19456
    v_permlane16_swap_b32 v5, v27
    v_mfma_f32_16x16x32_bf16 a[72:75], a[192:195], v[232:235], a[72:75]
    s_add_u32 s47, s47, 7864320
    s_add_u32 s48, s47, 4096
    s_lshl_b32 s53, s38, 12
    v_mfma_f32_16x16x32_bf16 a[72:75], a[196:199], v[248:251], a[72:75]
    v_mov_b32 v6, v16
    v_mov_b32 v7, v17
    v_mfma_f32_16x16x32_bf16 a[76:79], a[192:195], v[236:239], a[76:79]
    s_mov_b32 s90, 9830400
    v_mfma_f32_16x16x32_bf16 a[76:79], a[196:199], v[252:255], a[76:79]
    s_waitcnt lgkmcnt(8)
    s_add_u32 s50, s53, 0
    s_add_u32 s52, s54, 0
    s_add_u32 m0, s50, 0
    v_mfma_f32_16x16x32_bf16 a[80:83], a[200:203], v[224:227], a[80:83]
    ds_read_b64_tr_b16 a[192:193], v8 offset:2048
    v_add_f32 v2, v2, v24
    v_mfma_f32_16x16x32_bf16 a[80:83], a[204:207], v[240:243], a[80:83]
    ds_read_b64_tr_b16 a[194:195], v8 offset:8192
    v_add_f32 v3, v3, v25
    v_mfma_f32_16x16x32_bf16 a[84:87], a[200:203], v[228:231], a[84:87]
    ds_read_b64_tr_b16 a[196:197], v8 offset:14336
    v_add_f32 v4, v4, v26
    v_mfma_f32_16x16x32_bf16 a[84:87], a[204:207], v[244:247], a[84:87]
    ds_read_b64_tr_b16 a[198:199], v8 offset:20480
    v_add_f32 v5, v5, v27
    v_mfma_f32_16x16x32_bf16 a[88:91], a[200:203], v[232:235], a[88:91]
    buffer_load_dwordx4 v12, s[24:27], s43 offen offset:0 sc1 lds
    v_mfma_f32_16x16x32_bf16 a[88:91], a[204:207], v[248:251], a[88:91]
    buffer_load_dwordx4 v12, s[24:27], s43 offen offset:1024 sc1 lds
    v_mfma_f32_16x16x32_bf16 a[92:95], a[200:203], v[236:239], a[92:95]
    s_add_u32 m0, s50, 2048
    v_mfma_f32_16x16x32_bf16 a[92:95], a[204:207], v[252:255], a[92:95]
    s_waitcnt lgkmcnt(8)
    buffer_load_dwordx4 v13, s[24:27], s43 offen offset:0 sc1 lds
    v_mfma_f32_16x16x32_bf16 a[96:99], a[208:211], v[224:227], a[96:99]
    ds_read_b64_tr_b16 a[200:201], v9 offset:2048
    v_rcp_f32 v20, v2
    v_mfma_f32_16x16x32_bf16 a[96:99], a[212:215], v[240:243], a[96:99]
    ds_read_b64_tr_b16 a[202:203], v9 offset:8192
    v_rcp_f32 v22, v3
    v_mfma_f32_16x16x32_bf16 a[100:103], a[208:211], v[228:231], a[100:103]
    ds_read_b64_tr_b16 a[204:205], v9 offset:14336
    v_rcp_f32 v24, v4
    v_mfma_f32_16x16x32_bf16 a[100:103], a[212:215], v[244:247], a[100:103]
    ds_read_b64_tr_b16 a[206:207], v9 offset:20480
    v_rcp_f32 v26, v5
    v_mfma_f32_16x16x32_bf16 a[104:107], a[208:211], v[232:235], a[104:107]
    buffer_load_dwordx4 v13, s[24:27], s43 offen offset:1024 sc1 lds
    v_mfma_f32_16x16x32_bf16 a[104:107], a[212:215], v[248:251], a[104:107]
    s_mov_b32 m0, s52
    v_mfma_f32_16x16x32_bf16 a[108:111], a[208:211], v[236:239], a[108:111]
    buffer_load_dwordx4 v1, s[88:91], s47 offen offset:0 sc1 lds
    v_mfma_f32_16x16x32_bf16 a[108:111], a[212:215], v[252:255], a[108:111]
    s_waitcnt lgkmcnt(8)
    buffer_load_dwordx4 v1, s[88:91], s47 offen offset:1024 sc1 lds
    v_mfma_f32_16x16x32_bf16 a[112:115], a[216:219], v[224:227], a[112:115]
    ds_read_b64_tr_b16 a[208:209], v10 offset:2048
    v_mfma_f32_16x16x32_bf16 a[112:115], a[220:223], v[240:243], a[112:115]
    ds_read_b64_tr_b16 a[210:211], v10 offset:8192
    v_mfma_f32_16x16x32_bf16 a[116:119], a[216:219], v[228:231], a[116:119]
    ds_read_b64_tr_b16 a[212:213], v10 offset:14336
    v_mfma_f32_16x16x32_bf16 a[116:119], a[220:223], v[244:247], a[116:119]
    ds_read_b64_tr_b16 a[214:215], v10 offset:20480
    v_mfma_f32_16x16x32_bf16 a[120:123], a[216:219], v[232:235], a[120:123]
    buffer_load_dwordx4 v1, s[88:91], s47 offen offset:2048 sc1 lds
    v_mfma_f32_16x16x32_bf16 a[120:123], a[220:223], v[248:251], a[120:123]
    buffer_load_dwordx4 v1, s[88:91], s47 offen offset:3072 sc1 lds
    v_mfma_f32_16x16x32_bf16 a[124:127], a[216:219], v[236:239], a[124:127]
    s_add_u32 m0, s52, 4096
    v_mfma_f32_16x16x32_bf16 a[124:127], a[220:223], v[252:255], a[124:127]
    s_waitcnt lgkmcnt(8)
    buffer_load_dwordx4 v1, s[88:91], s48 offen sc1 lds
    v_mfma_f32_16x16x32_bf16 a[128:131], a[192:195], v[224:227], a[128:131]
    ds_read_b64_tr_b16 a[216:217], v11 offset:2048
    v_mfma_f32_16x16x32_bf16 a[128:131], a[196:199], v[240:243], a[128:131]
    ds_read_b64_tr_b16 a[218:219], v11 offset:8192
    v_mfma_f32_16x16x32_bf16 a[132:135], a[192:195], v[228:231], a[132:135]
    ds_read_b64_tr_b16 a[220:221], v11 offset:14336
    v_mfma_f32_16x16x32_bf16 a[132:135], a[196:199], v[244:247], a[132:135]
    ds_read_b64_tr_b16 a[222:223], v11 offset:20480
    v_mfma_f32_16x16x32_bf16 a[136:139], a[192:195], v[232:235], a[136:139]
    s_add_u32 s43, s43, 2048
    s_add_u32 s47, s47, 81920
    s_add_u32 s48, s48, 81920
    v_mfma_f32_16x16x32_bf16 a[136:139], a[196:199], v[248:251], a[136:139]
    s_add_u32 s50, s53, 36864
    s_add_u32 s52, s54, 36864
    s_add_u32 m0, s50, 0
    v_mfma_f32_16x16x32_bf16 a[140:143], a[192:195], v[236:239], a[140:143]
    buffer_load_dwordx4 v12, s[24:27], s43 offen offset:0 sc1 lds
    v_mfma_f32_16x16x32_bf16 a[140:143], a[196:199], v[252:255], a[140:143]
    s_waitcnt lgkmcnt(8)
    buffer_load_dwordx4 v12, s[24:27], s43 offen offset:1024 sc1 lds
    v_mfma_f32_16x16x32_bf16 a[144:147], a[200:203], v[224:227], a[144:147]
    s_add_u32 m0, s50, 2048
    v_mfma_f32_16x16x32_bf16 a[144:147], a[204:207], v[240:243], a[144:147]
    buffer_load_dwordx4 v13, s[24:27], s43 offen offset:0 sc1 lds
    v_mfma_f32_16x16x32_bf16 a[148:151], a[200:203], v[228:231], a[148:151]
    buffer_load_dwordx4 v13, s[24:27], s43 offen offset:1024 sc1 lds
    v_mfma_f32_16x16x32_bf16 a[148:151], a[204:207], v[244:247], a[148:151]
    s_mov_b32 m0, s52
    v_mfma_f32_16x16x32_bf16 a[152:155], a[200:203], v[232:235], a[152:155]
    buffer_load_dwordx4 v1, s[88:91], s47 offen offset:0 sc1 lds
    v_mfma_f32_16x16x32_bf16 a[152:155], a[204:207], v[248:251], a[152:155]
    buffer_load_dwordx4 v1, s[88:91], s47 offen offset:1024 sc1 lds
    v_mfma_f32_16x16x32_bf16 a[156:159], a[200:203], v[236:239], a[156:159]
    buffer_load_dwordx4 v1, s[88:91], s47 offen offset:2048 sc1 lds
    v_mfma_f32_16x16x32_bf16 a[156:159], a[204:207], v[252:255], a[156:159]
    s_waitcnt lgkmcnt(4)
    buffer_load_dwordx4 v1, s[88:91], s47 offen offset:3072 sc1 lds
    v_mfma_f32_16x16x32_bf16 a[160:163], a[208:211], v[224:227], a[160:163]
    s_add_u32 m0, s52, 4096
    v_mfma_f32_16x16x32_bf16 a[160:163], a[212:215], v[240:243], a[160:163]
    buffer_load_dwordx4 v1, s[88:91], s48 offen sc1 lds
    v_mfma_f32_16x16x32_bf16 a[164:167], a[208:211], v[228:231], a[164:167]
    v_mfma_f32_16x16x32_bf16 a[164:167], a[212:215], v[244:247], a[164:167]
    v_mfma_f32_16x16x32_bf16 a[168:171], a[208:211], v[232:235], a[168:171]
    v_mfma_f32_16x16x32_bf16 a[168:171], a[212:215], v[248:251], a[168:171]
    v_mfma_f32_16x16x32_bf16 a[172:175], a[208:211], v[236:239], a[172:175]
    v_mfma_f32_16x16x32_bf16 a[172:175], a[212:215], v[252:255], a[172:175]
    s_waitcnt lgkmcnt(0)
    v_mfma_f32_16x16x32_bf16 a[176:179], a[216:219], v[224:227], a[176:179]
    v_mfma_f32_16x16x32_bf16 a[176:179], a[220:223], v[240:243], a[176:179]
    v_mfma_f32_16x16x32_bf16 a[180:183], a[216:219], v[228:231], a[180:183]
    v_mfma_f32_16x16x32_bf16 a[180:183], a[220:223], v[244:247], a[180:183]
    v_mfma_f32_16x16x32_bf16 a[184:187], a[216:219], v[232:235], a[184:187]
    v_mfma_f32_16x16x32_bf16 a[184:187], a[220:223], v[248:251], a[184:187]
    v_mfma_f32_16x16x32_bf16 a[188:191], a[216:219], v[236:239], a[188:191]
    v_mfma_f32_16x16x32_bf16 a[188:191], a[220:223], v[252:255], a[188:191]
    s_lshl_b32 s45, s37, 4
    s_lshl_b32 s46, s38, 2
    s_add_u32 s45, s45, s46
    s_mul_i32 s45, s45, 196608
    s_mul_i32 s46, s36, 6144
    s_add_u32 s45, s45, s46
    v_add_u32 v28, s45, v1
    v_add_u32 v29, 196608, v28
    v_add_u32 v30, 393216, v28
    v_add_u32 v31, 589824, v28
    s_mov_b32 s58, 4096
    v_mov_b32 v168, 0
    v_mov_b32 v169, 0
    v_mov_b32 v170, 0
    v_mov_b32 v171, 0
    v_accvgpr_read_b32 v40, a0
    v_accvgpr_read_b32 v41, a1
    v_accvgpr_read_b32 v42, a2
    v_accvgpr_read_b32 v43, a3
    v_accvgpr_read_b32 v44, a16
    v_accvgpr_read_b32 v45, a17
    v_accvgpr_read_b32 v46, a18
    v_accvgpr_read_b32 v47, a19
    v_pk_mul_f32 v[40:41], v[40:41], v[20:21] op_sel_hi:[1,0]
    v_pk_mul_f32 v[42:43], v[42:43], v[20:21] op_sel_hi:[1,0]
    v_pk_mul_f32 v[44:45], v[44:45], v[20:21] op_sel_hi:[1,0]
    v_pk_mul_f32 v[46:47], v[46:47], v[20:21] op_sel_hi:[1,0]
    v_cvt_pk_bf16_f32 v64, v40, v41
    v_cvt_pk_bf16_f32 v65, v42, v43
    v_cvt_pk_bf16_f32 v66, v44, v45
    v_cvt_pk_bf16_f32 v67, v46, v47
    buffer_store_dwordx4 v[64:67], v28, s[28:31], 0 offen offset:0 sc1
    v_accvgpr_read_b32 v48, a4
    v_accvgpr_read_b32 v49, a5
    v_accvgpr_read_b32 v50, a6
    v_accvgpr_read_b32 v51, a7
    v_accvgpr_read_b32 v52, a20
    v_accvgpr_read_b32 v53, a21
    v_accvgpr_read_b32 v54, a22
    v_accvgpr_read_b32 v55, a23
    v_pk_mul_f32 v[48:49], v[48:49], v[22:23] op_sel_hi:[1,0]
    v_pk_mul_f32 v[50:51], v[50:51], v[22:23] op_sel_hi:[1,0]
    v_pk_mul_f32 v[52:53], v[52:53], v[22:23] op_sel_hi:[1,0]
    v_pk_mul_f32 v[54:55], v[54:55], v[22:23] op_sel_hi:[1,0]
    v_cvt_pk_bf16_f32 v68, v48, v49
    v_cvt_pk_bf16_f32 v69, v50, v51
    v_cvt_pk_bf16_f32 v70, v52, v53
    v_cvt_pk_bf16_f32 v71, v54, v55
    buffer_store_dwordx4 v[68:71], v29, s[28:31], 0 offen offset:0 sc1
    v_accvgpr_read_b32 v40, a8
    v_accvgpr_read_b32 v41, a9
    v_accvgpr_read_b32 v42, a10
    v_accvgpr_read_b32 v43, a11
    v_accvgpr_read_b32 v44, a24
    v_accvgpr_read_b32 v45, a25
    v_accvgpr_read_b32 v46, a26
    v_accvgpr_read_b32 v47, a27
    v_mfma_f32_32x32x16_bf16 v[176:191], v[168:171], v[168:171], 0
    v_pk_mul_f32 v[40:41], v[40:41], v[24:25] op_sel_hi:[1,0]
    v_pk_mul_f32 v[42:43], v[42:43], v[24:25] op_sel_hi:[1,0]
    v_pk_mul_f32 v[44:45], v[44:45], v[24:25] op_sel_hi:[1,0]
    v_pk_mul_f32 v[46:47], v[46:47], v[24:25] op_sel_hi:[1,0]
    v_cvt_pk_bf16_f32 v72, v40, v41
    v_cvt_pk_bf16_f32 v73, v42, v43
    v_cvt_pk_bf16_f32 v74, v44, v45
    v_cvt_pk_bf16_f32 v75, v46, v47
    buffer_store_dwordx4 v[72:75], v30, s[28:31], 0 offen offset:0 sc1
    v_accvgpr_read_b32 v48, a12
    v_accvgpr_read_b32 v49, a13
    v_accvgpr_read_b32 v50, a14
    v_accvgpr_read_b32 v51, a15
    v_accvgpr_read_b32 v52, a28
    v_accvgpr_read_b32 v53, a29
    v_accvgpr_read_b32 v54, a30
    v_accvgpr_read_b32 v55, a31
    v_mfma_f32_32x32x16_bf16 v[192:207], v[168:171], v[168:171], 0
    v_pk_mul_f32 v[48:49], v[48:49], v[26:27] op_sel_hi:[1,0]
    v_pk_mul_f32 v[50:51], v[50:51], v[26:27] op_sel_hi:[1,0]
    v_pk_mul_f32 v[52:53], v[52:53], v[26:27] op_sel_hi:[1,0]
    v_pk_mul_f32 v[54:55], v[54:55], v[26:27] op_sel_hi:[1,0]
    v_cvt_pk_bf16_f32 v76, v48, v49
    v_cvt_pk_bf16_f32 v77, v50, v51
    v_cvt_pk_bf16_f32 v78, v52, v53
    v_cvt_pk_bf16_f32 v79, v54, v55
    buffer_store_dwordx4 v[76:79], v31, s[28:31], 0 offen offset:0 sc1
    v_accvgpr_read_b32 v40, a32
    v_accvgpr_read_b32 v41, a33
    v_accvgpr_read_b32 v42, a34
    v_accvgpr_read_b32 v43, a35
    v_accvgpr_read_b32 v44, a48
    v_accvgpr_read_b32 v45, a49
    v_accvgpr_read_b32 v46, a50
    v_accvgpr_read_b32 v47, a51
    v_mfma_f32_32x32x16_bf16 v[208:223], v[168:171], v[168:171], 0
    v_pk_mul_f32 v[40:41], v[40:41], v[20:21] op_sel_hi:[1,0]
    v_pk_mul_f32 v[42:43], v[42:43], v[20:21] op_sel_hi:[1,0]
    v_pk_mul_f32 v[44:45], v[44:45], v[20:21] op_sel_hi:[1,0]
    v_pk_mul_f32 v[46:47], v[46:47], v[20:21] op_sel_hi:[1,0]
    v_cvt_pk_bf16_f32 v80, v40, v41
    v_cvt_pk_bf16_f32 v81, v42, v43
    v_cvt_pk_bf16_f32 v82, v44, v45
    v_cvt_pk_bf16_f32 v83, v46, v47
    buffer_store_dwordx4 v[80:83], v28, s[28:31], 0 offen offset:1024 sc1
    v_accvgpr_read_b32 v48, a36
    v_accvgpr_read_b32 v49, a37
    v_accvgpr_read_b32 v50, a38
    v_accvgpr_read_b32 v51, a39
    v_accvgpr_read_b32 v52, a52
    v_accvgpr_read_b32 v53, a53
    v_accvgpr_read_b32 v54, a54
    v_accvgpr_read_b32 v55, a55
    v_mfma_f32_32x32x16_bf16 v[224:239], v[168:171], v[168:171], 0
    v_pk_mul_f32 v[48:49], v[48:49], v[22:23] op_sel_hi:[1,0]
    v_pk_mul_f32 v[50:51], v[50:51], v[22:23] op_sel_hi:[1,0]
    v_pk_mul_f32 v[52:53], v[52:53], v[22:23] op_sel_hi:[1,0]
    v_pk_mul_f32 v[54:55], v[54:55], v[22:23] op_sel_hi:[1,0]
    v_cvt_pk_bf16_f32 v84, v48, v49
    v_cvt_pk_bf16_f32 v85, v50, v51
    v_cvt_pk_bf16_f32 v86, v52, v53
    v_cvt_pk_bf16_f32 v87, v54, v55
    buffer_store_dwordx4 v[84:87], v29, s[28:31], 0 offen offset:1024 sc1
    v_accvgpr_read_b32 v40, a40
    v_accvgpr_read_b32 v41, a41
    v_accvgpr_read_b32 v42, a42
    v_accvgpr_read_b32 v43, a43
    v_accvgpr_read_b32 v44, a56
    v_accvgpr_read_b32 v45, a57
    v_accvgpr_read_b32 v46, a58
    v_accvgpr_read_b32 v47, a59
    v_mfma_f32_32x32x16_bf16 v[240:255], v[168:171], v[168:171], 0
    v_pk_mul_f32 v[40:41], v[40:41], v[24:25] op_sel_hi:[1,0]
    v_pk_mul_f32 v[42:43], v[42:43], v[24:25] op_sel_hi:[1,0]
    v_pk_mul_f32 v[44:45], v[44:45], v[24:25] op_sel_hi:[1,0]
    v_pk_mul_f32 v[46:47], v[46:47], v[24:25] op_sel_hi:[1,0]
    v_cvt_pk_bf16_f32 v88, v40, v41
    v_cvt_pk_bf16_f32 v89, v42, v43
    v_cvt_pk_bf16_f32 v90, v44, v45
    v_cvt_pk_bf16_f32 v91, v46, v47
    buffer_store_dwordx4 v[88:91], v30, s[28:31], 0 offen offset:1024 sc1
    v_accvgpr_read_b32 v48, a44
    v_accvgpr_read_b32 v49, a45
    v_accvgpr_read_b32 v50, a46
    v_accvgpr_read_b32 v51, a47
    v_accvgpr_read_b32 v52, a60
    v_accvgpr_read_b32 v53, a61
    v_accvgpr_read_b32 v54, a62
    v_accvgpr_read_b32 v55, a63
    v_pk_mul_f32 v[48:49], v[48:49], v[26:27] op_sel_hi:[1,0]
    v_pk_mul_f32 v[50:51], v[50:51], v[26:27] op_sel_hi:[1,0]
    v_pk_mul_f32 v[52:53], v[52:53], v[26:27] op_sel_hi:[1,0]
    v_pk_mul_f32 v[54:55], v[54:55], v[26:27] op_sel_hi:[1,0]
    v_cvt_pk_bf16_f32 v92, v48, v49
    v_cvt_pk_bf16_f32 v93, v50, v51
    v_cvt_pk_bf16_f32 v94, v52, v53
    v_cvt_pk_bf16_f32 v95, v54, v55
    buffer_store_dwordx4 v[92:95], v31, s[28:31], 0 offen offset:1024 sc1
    v_accvgpr_read_b32 v40, a64
    v_accvgpr_read_b32 v41, a65
    v_accvgpr_read_b32 v42, a66
    v_accvgpr_read_b32 v43, a67
    v_accvgpr_read_b32 v44, a80
    v_accvgpr_read_b32 v45, a81
    v_accvgpr_read_b32 v46, a82
    v_accvgpr_read_b32 v47, a83
    v_pk_mul_f32 v[40:41], v[40:41], v[20:21] op_sel_hi:[1,0]
    v_pk_mul_f32 v[42:43], v[42:43], v[20:21] op_sel_hi:[1,0]
    v_pk_mul_f32 v[44:45], v[44:45], v[20:21] op_sel_hi:[1,0]
    v_pk_mul_f32 v[46:47], v[46:47], v[20:21] op_sel_hi:[1,0]
    v_cvt_pk_bf16_f32 v96, v40, v41
    v_cvt_pk_bf16_f32 v97, v42, v43
    v_cvt_pk_bf16_f32 v98, v44, v45
    v_cvt_pk_bf16_f32 v99, v46, v47
    buffer_store_dwordx4 v[96:99], v28, s[28:31], 0 offen offset:2048 sc1
    v_accvgpr_read_b32 v48, a68
    v_accvgpr_read_b32 v49, a69
    v_accvgpr_read_b32 v50, a70
    v_accvgpr_read_b32 v51, a71
    v_accvgpr_read_b32 v52, a84
    v_accvgpr_read_b32 v53, a85
    v_accvgpr_read_b32 v54, a86
    v_accvgpr_read_b32 v55, a87
    v_pk_mul_f32 v[48:49], v[48:49], v[22:23] op_sel_hi:[1,0]
    v_pk_mul_f32 v[50:51], v[50:51], v[22:23] op_sel_hi:[1,0]
    v_pk_mul_f32 v[52:53], v[52:53], v[22:23] op_sel_hi:[1,0]
    v_pk_mul_f32 v[54:55], v[54:55], v[22:23] op_sel_hi:[1,0]
    v_cvt_pk_bf16_f32 v100, v48, v49
    v_cvt_pk_bf16_f32 v101, v50, v51
    v_cvt_pk_bf16_f32 v102, v52, v53
    v_cvt_pk_bf16_f32 v103, v54, v55
    buffer_store_dwordx4 v[100:103], v29, s[28:31], 0 offen offset:2048 sc1
    v_accvgpr_read_b32 v40, a72
    v_accvgpr_read_b32 v41, a73
    v_accvgpr_read_b32 v42, a74
    v_accvgpr_read_b32 v43, a75
    v_accvgpr_read_b32 v44, a88
    v_accvgpr_read_b32 v45, a89
    v_accvgpr_read_b32 v46, a90
    v_accvgpr_read_b32 v47, a91
    v_pk_mul_f32 v[40:41], v[40:41], v[24:25] op_sel_hi:[1,0]
    v_pk_mul_f32 v[42:43], v[42:43], v[24:25] op_sel_hi:[1,0]
    v_pk_mul_f32 v[44:45], v[44:45], v[24:25] op_sel_hi:[1,0]
    v_pk_mul_f32 v[46:47], v[46:47], v[24:25] op_sel_hi:[1,0]
    v_cvt_pk_bf16_f32 v104, v40, v41
    v_cvt_pk_bf16_f32 v105, v42, v43
    v_cvt_pk_bf16_f32 v106, v44, v45
    v_cvt_pk_bf16_f32 v107, v46, v47
    buffer_store_dwordx4 v[104:107], v30, s[28:31], 0 offen offset:2048 sc1
    v_accvgpr_read_b32 v48, a76
    v_accvgpr_read_b32 v49, a77
    v_accvgpr_read_b32 v50, a78
    v_accvgpr_read_b32 v51, a79
    v_accvgpr_read_b32 v52, a92
    v_accvgpr_read_b32 v53, a93
    v_accvgpr_read_b32 v54, a94
    v_accvgpr_read_b32 v55, a95
    v_pk_mul_f32 v[48:49], v[48:49], v[26:27] op_sel_hi:[1,0]
    v_pk_mul_f32 v[50:51], v[50:51], v[26:27] op_sel_hi:[1,0]
    v_pk_mul_f32 v[52:53], v[52:53], v[26:27] op_sel_hi:[1,0]
    v_pk_mul_f32 v[54:55], v[54:55], v[26:27] op_sel_hi:[1,0]
    v_cvt_pk_bf16_f32 v108, v48, v49
    v_cvt_pk_bf16_f32 v109, v50, v51
    v_cvt_pk_bf16_f32 v110, v52, v53
    v_cvt_pk_bf16_f32 v111, v54, v55
    buffer_store_dwordx4 v[108:111], v31, s[28:31], 0 offen offset:2048 sc1
    v_accvgpr_read_b32 v40, a96
    v_accvgpr_read_b32 v41, a97
    v_accvgpr_read_b32 v42, a98
    v_accvgpr_read_b32 v43, a99
    v_accvgpr_read_b32 v44, a112
    v_accvgpr_read_b32 v45, a113
    v_accvgpr_read_b32 v46, a114
    v_accvgpr_read_b32 v47, a115
    v_pk_mul_f32 v[40:41], v[40:41], v[20:21] op_sel_hi:[1,0]
    v_pk_mul_f32 v[42:43], v[42:43], v[20:21] op_sel_hi:[1,0]
    v_pk_mul_f32 v[44:45], v[44:45], v[20:21] op_sel_hi:[1,0]
    v_pk_mul_f32 v[46:47], v[46:47], v[20:21] op_sel_hi:[1,0]
    v_cvt_pk_bf16_f32 v112, v40, v41
    v_cvt_pk_bf16_f32 v113, v42, v43
    v_cvt_pk_bf16_f32 v114, v44, v45
    v_cvt_pk_bf16_f32 v115, v46, v47
    buffer_store_dwordx4 v[112:115], v28, s[28:31], 0 offen offset:3072 sc1
    v_accvgpr_read_b32 v48, a100
    v_accvgpr_read_b32 v49, a101
    v_accvgpr_read_b32 v50, a102
    v_accvgpr_read_b32 v51, a103
    v_accvgpr_read_b32 v52, a116
    v_accvgpr_read_b32 v53, a117
    v_accvgpr_read_b32 v54, a118
    v_accvgpr_read_b32 v55, a119
    v_pk_mul_f32 v[48:49], v[48:49], v[22:23] op_sel_hi:[1,0]
    v_pk_mul_f32 v[50:51], v[50:51], v[22:23] op_sel_hi:[1,0]
    v_pk_mul_f32 v[52:53], v[52:53], v[22:23] op_sel_hi:[1,0]
    v_pk_mul_f32 v[54:55], v[54:55], v[22:23] op_sel_hi:[1,0]
    v_cvt_pk_bf16_f32 v116, v48, v49
    v_cvt_pk_bf16_f32 v117, v50, v51
    v_cvt_pk_bf16_f32 v118, v52, v53
    v_cvt_pk_bf16_f32 v119, v54, v55
    buffer_store_dwordx4 v[116:119], v29, s[28:31], 0 offen offset:3072 sc1
    v_max3_f32 v160, |v64|, |v65|, |v66|
    v_max3_f32 v160, |v67|, |v80|, v160
    v_max3_f32 v160, |v81|, |v82|, v160
    v_max3_f32 v160, |v83|, |v96|, v160
    v_max3_f32 v160, |v97|, |v98|, v160
    v_max_f32 v160, |v99|, v160
    v_max3_f32 v161, |v68|, |v69|, |v70|
    v_max3_f32 v161, |v71|, |v84|, v161
    v_max3_f32 v161, |v85|, |v86|, v161
    v_max3_f32 v161, |v87|, |v100|, v161
    v_max3_f32 v161, |v101|, |v102|, v161
    v_max_f32 v161, |v103|, v161
    v_max3_f32 v162, |v72|, |v73|, |v74|
    v_max3_f32 v162, |v75|, |v88|, v162
    v_max3_f32 v162, |v89|, |v90|, v162
    v_max3_f32 v162, |v91|, |v104|, v162
    v_max3_f32 v162, |v105|, |v106|, v162
    v_max_f32 v162, |v107|, v162
    v_max3_f32 v163, |v76|, |v77|, |v78|
    v_max3_f32 v163, |v79|, |v92|, v163
    v_max3_f32 v163, |v93|, |v94|, v163
    v_max3_f32 v163, |v95|, |v108|, v163
    v_max3_f32 v163, |v109|, |v110|, v163
    v_max_f32 v163, |v111|, v163
    v_mov_b32 v164, v160
    v_mov_b32 v165, v161
    s_nop 0
    v_mov_b32 v166, v162
    v_mov_b32 v167, v163
    s_nop 0
    v_permlane32_swap_b32 v160, v164
    v_permlane32_swap_b32 v161, v165
    s_nop 0
    v_permlane32_swap_b32 v162, v166
    v_permlane32_swap_b32 v163, v167
    s_nop 0
    v_max_f32 v160, v160, v164
    v_max_f32 v161, v161, v165
    s_nop 0
    v_max_f32 v162, v162, v166
    v_max_f32 v163, v163, v167
    s_nop 0
    v_mov_b32 v164, v160
    v_mov_b32 v165, v161
    s_nop 0
    v_mov_b32 v166, v162
    v_mov_b32 v167, v163
    s_nop 0
    v_permlane16_swap_b32 v160, v164
    v_permlane16_swap_b32 v161, v165
    s_nop 0
    v_permlane16_swap_b32 v162, v166
    v_permlane16_swap_b32 v163, v167
    s_nop 0
    v_max_f32 v160, v160, v164
    v_max_f32 v161, v161, v165
    s_nop 0
    v_max_f32 v162, v162, v166
    v_max_f32 v163, v163, v167
    s_nop 0
    v_mul_f32 v160, v160, v2
    v_mul_f32 v161, v161, v3
    v_mul_f32 v162, v162, v4
    v_mul_f32 v163, v163, v5
    v_min3_f32 v160, v160, v161, v162
    v_min_f32 v160, v160, v163
    v_add_f32 v161, v2, v3
    v_add_f32 v162, v4, v5
    v_add_f32 v161, v161, v162
    v_mov_b32 v162, 0x08800000
    v_cmp_nle_f32 vcc, v162, v160
    v_cmp_ngt_f32 s[96:97], 1.0, v161
    v_mov_b32 v172, 159744
    v_mov_b32 v173, 1
    s_add_u32 s4, s80, 83886080
    s_addc_u32 s5, s81, 0
    s_mov_b32 s6, 20971520
    s_mov_b32 s7, 0x00020000
    s_or_b64 vcc, vcc, s[96:97]
    s_cbranch_vccz L_good
    ds_write_b32 v172, v173
L_good:
    v_accvgpr_read_b32 v40, a104
    v_accvgpr_read_b32 v41, a105
    v_accvgpr_read_b32 v42, a106
    v_accvgpr_read_b32 v43, a107
    v_accvgpr_read_b32 v44, a120
    v_accvgpr_read_b32 v45, a121
    v_accvgpr_read_b32 v46, a122
    v_accvgpr_read_b32 v47, a123
    v_pk_mul_f32 v[40:41], v[40:41], v[24:25] op_sel_hi:[1,0]
    v_pk_mul_f32 v[42:43], v[42:43], v[24:25] op_sel_hi:[1,0]
    v_pk_mul_f32 v[44:45], v[44:45], v[24:25] op_sel_hi:[1,0]
    v_pk_mul_f32 v[46:47], v[46:47], v[24:25] op_sel_hi:[1,0]
    v_cvt_pk_bf16_f32 v120, v40, v41
    v_cvt_pk_bf16_f32 v121, v42, v43
    v_cvt_pk_bf16_f32 v122, v44, v45
    v_cvt_pk_bf16_f32 v123, v46, v47
    buffer_store_dwordx4 v[120:123], v30, s[28:31], 0 offen offset:3072 sc1
    v_accvgpr_read_b32 v48, a108
    v_accvgpr_read_b32 v49, a109
    v_accvgpr_read_b32 v50, a110
    v_accvgpr_read_b32 v51, a111
    v_accvgpr_read_b32 v52, a124
    v_accvgpr_read_b32 v53, a125
    v_accvgpr_read_b32 v54, a126
    v_accvgpr_read_b32 v55, a127
    v_pk_mul_f32 v[48:49], v[48:49], v[26:27] op_sel_hi:[1,0]
    v_pk_mul_f32 v[50:51], v[50:51], v[26:27] op_sel_hi:[1,0]
    v_pk_mul_f32 v[52:53], v[52:53], v[26:27] op_sel_hi:[1,0]
    v_pk_mul_f32 v[54:55], v[54:55], v[26:27] op_sel_hi:[1,0]
    v_cvt_pk_bf16_f32 v124, v48, v49
    v_cvt_pk_bf16_f32 v125, v50, v51
    v_cvt_pk_bf16_f32 v126, v52, v53
    v_cvt_pk_bf16_f32 v127, v54, v55
    buffer_store_dwordx4 v[124:127], v31, s[28:31], 0 offen offset:3072 sc1
    v_accvgpr_read_b32 v40, a128
    v_accvgpr_read_b32 v41, a129
    v_accvgpr_read_b32 v42, a130
    v_accvgpr_read_b32 v43, a131
    v_accvgpr_read_b32 v44, a144
    v_accvgpr_read_b32 v45, a145
    v_accvgpr_read_b32 v46, a146
    v_accvgpr_read_b32 v47, a147
    v_pk_mul_f32 v[40:41], v[40:41], v[20:21] op_sel_hi:[1,0]
    v_pk_mul_f32 v[42:43], v[42:43], v[20:21] op_sel_hi:[1,0]
    v_pk_mul_f32 v[44:45], v[44:45], v[20:21] op_sel_hi:[1,0]
    v_pk_mul_f32 v[46:47], v[46:47], v[20:21] op_sel_hi:[1,0]
    v_cvt_pk_bf16_f32 v128, v40, v41
    v_cvt_pk_bf16_f32 v129, v42, v43
    v_cvt_pk_bf16_f32 v130, v44, v45
    v_cvt_pk_bf16_f32 v131, v46, v47
    buffer_store_dwordx4 v[128:131], v28, s[28:31], s58 offen offset:0 sc1
    s_and_b32 s8, s2, 4
    s_add_u32 s9, s8, 1
    s_add_u32 s10, s8, 2
    s_add_u32 s11, s8, 3
    v_readlane_b32 s8, v59, s8
    v_readlane_b32 s9, v59, s9
    v_readlane_b32 s10, v59, s10
    v_readlane_b32 s11, v59, s11
    s_nop 3
    s_sub_u32 s9, s9, s8
    s_sub_u32 s10, s10, s8
    s_sub_u32 s11, s11, s8
    s_add_u32 s14, s9, s10
    s_add_u32 s14, s14, s11
    s_mov_b32 s8, 0
    s_lshl_b32 s8, s8, 2
    s_sub_u32 s8, s8, s14
    s_max_i32 s8, s8, -4000
    s_min_i32 s8, s8, 4000
    s_mul_i32 s8, s8, 180
    s_add_u32 s8, s8, 32768
    s_ashr_i32 s8, s8, 16
    s_max_i32 s8, s8, -6
    s_min_i32 s8, s8, 6
    s_lshl_b32 s8, s8, 1
    s_sub_u32 s8, 24, s8
    s_min_u32 s8, s8, 60
    s_lshl_b32 s9, s9, 2
    s_sub_u32 s9, s9, s14
    s_max_i32 s9, s9, -4000
    s_min_i32 s9, s9, 4000
    s_mul_i32 s9, s9, 180
    s_add_u32 s9, s9, 32768
    s_ashr_i32 s9, s9, 16
    s_max_i32 s9, s9, -6
    s_min_i32 s9, s9, 6
    s_lshl_b32 s9, s9, 1
    s_sub_u32 s9, 24, s9
    s_add_u32 s9, s9, s8
    s_min_u32 s9, s9, 72
    s_lshl_b32 s10, s10, 2
    s_sub_u32 s10, s10, s14
    s_max_i32 s10, s10, -4000
    s_min_i32 s10, s10, 4000
    s_mul_i32 s10, s10, 180
    s_add_u32 s10, s10, 32768
    s_ashr_i32 s10, s10, 16
    s_max_i32 s10, s10, -6
    s_min_i32 s10, s10, 6
    s_lshl_b32 s10, s10, 1
    s_sub_u32 s10, 24, s10
    s_add_u32 s10, s10, s9
    s_min_u32 s10, s10, 84
    s_mov_b32 s14, 0
    s_mov_b32 s15, s8
    s_cmp_eq_u32 s40, 1
    s_cselect_b32 s14, s8, s14
    s_cselect_b32 s15, s9, s15
    s_cmp_eq_u32 s40, 2
    s_cselect_b32 s14, s9, s14
    s_cselect_b32 s15, s10, s15
    s_cmp_eq_u32 s40, 3
    s_cselect_b32 s14, s10, s14
    s_cselect_b32 s15, 96, s15
    s_sub_u32 s19, s15, s14
    s_sub_u32 s19, s19, 3
    s_sub_u32 s15, s15, 1
    s_mov_b32 s11, 0x55555556
    s_mul_hi_u32 s8, s14, s11
    s_mul_hi_u32 s9, s15, s11
    s_sub_u32 s10, s9, s8
    s_add_u32 s10, s10, 1
    s_bfm_b32 s22, s10, s8
    s_add_u32 s8, s14, 7
    s_sub_u32 s9, s15, 7
    s_mov_b32 s10, 0x15555556
    s_mul_hi_u32 s12, s14, s10
    s_mul_hi_u32 s13, s8, s10
    s_mul_hi_u32 s16, s9, s10
    s_mul_hi_u32 s17, s15, s10
    v_readlane_b32 s12, v59, s12
    v_readlane_b32 s13, v59, s13
    v_readlane_b32 s16, v59, s16
    v_readlane_b32 s17, v59, s17
    s_nop 3
    s_sub_u32 s13, s13, s12
    s_sub_u32 s16, s16, s12
    s_sub_u32 s17, s17, s12
    s_max_i32 s13, s13, 0
    s_max_i32 s16, s16, s17
    s_sub_u32 s12, s13, s16
    s_cmp_gt_i32 s12, 0
    s_cselect_b32 s12, s15, s14
    s_cselect_b32 s14, s9, s14
    s_cselect_b32 s15, s15, s8
    s_cselect_b32 s13, -1, 1
    s_mul_hi_u32 s8, s14, s11
    s_mul_hi_u32 s9, s15, s11
    s_sub_u32 s10, s9, s8
    s_add_u32 s10, s10, 1
    s_bfm_b32 s20, s10, s8
    s_mov_b32 s21, 0
    s_mov_b32 s23, 0
    s_lshl_b32 s18, s12, 11
    s_mul_i32 s12, s12, 81920
    s_add_u32 s56, s56, s12
    s_lshl_b32 s16, s13, 11
    s_mul_i32 s17, s13, 81920
    v_accvgpr_read_b32 v48, a132
    v_accvgpr_read_b32 v49, a133
    v_accvgpr_read_b32 v50, a134
    v_accvgpr_read_b32 v51, a135
    v_accvgpr_read_b32 v52, a148
    v_accvgpr_read_b32 v53, a149
    v_accvgpr_read_b32 v54, a150
    v_accvgpr_read_b32 v55, a151
    v_pk_mul_f32 v[48:49], v[48:49], v[22:23] op_sel_hi:[1,0]
    v_pk_mul_f32 v[50:51], v[50:51], v[22:23] op_sel_hi:[1,0]
    v_pk_mul_f32 v[52:53], v[52:53], v[22:23] op_sel_hi:[1,0]
    v_pk_mul_f32 v[54:55], v[54:55], v[22:23] op_sel_hi:[1,0]
    v_cvt_pk_bf16_f32 v132, v48, v49
    v_cvt_pk_bf16_f32 v133, v50, v51
    v_cvt_pk_bf16_f32 v134, v52, v53
    v_cvt_pk_bf16_f32 v135, v54, v55
    buffer_store_dwordx4 v[132:135], v29, s[28:31], s58 offen offset:0 sc1
    v_accvgpr_read_b32 v40, a136
    v_accvgpr_read_b32 v41, a137
    v_accvgpr_read_b32 v42, a138
    v_accvgpr_read_b32 v43, a139
    v_accvgpr_read_b32 v44, a152
    v_accvgpr_read_b32 v45, a153
    v_accvgpr_read_b32 v46, a154
    v_accvgpr_read_b32 v47, a155
    v_pk_mul_f32 v[40:41], v[40:41], v[24:25] op_sel_hi:[1,0]
    v_pk_mul_f32 v[42:43], v[42:43], v[24:25] op_sel_hi:[1,0]
    v_pk_mul_f32 v[44:45], v[44:45], v[24:25] op_sel_hi:[1,0]
    v_pk_mul_f32 v[46:47], v[46:47], v[24:25] op_sel_hi:[1,0]
    v_cvt_pk_bf16_f32 v136, v40, v41
    v_cvt_pk_bf16_f32 v137, v42, v43
    v_cvt_pk_bf16_f32 v138, v44, v45
    v_cvt_pk_bf16_f32 v139, v46, v47
    buffer_store_dwordx4 v[136:139], v30, s[28:31], s58 offen offset:0 sc1
    v_accvgpr_read_b32 v48, a140
    v_accvgpr_read_b32 v49, a141
    v_accvgpr_read_b32 v50, a142
    v_accvgpr_read_b32 v51, a143
    v_accvgpr_read_b32 v52, a156
    v_accvgpr_read_b32 v53, a157
    v_accvgpr_read_b32 v54, a158
    v_accvgpr_read_b32 v55, a159
    v_pk_mul_f32 v[48:49], v[48:49], v[26:27] op_sel_hi:[1,0]
    v_pk_mul_f32 v[50:51], v[50:51], v[26:27] op_sel_hi:[1,0]
    v_pk_mul_f32 v[52:53], v[52:53], v[26:27] op_sel_hi:[1,0]
    v_pk_mul_f32 v[54:55], v[54:55], v[26:27] op_sel_hi:[1,0]
    v_cvt_pk_bf16_f32 v140, v48, v49
    v_cvt_pk_bf16_f32 v141, v50, v51
    v_cvt_pk_bf16_f32 v142, v52, v53
    v_cvt_pk_bf16_f32 v143, v54, v55
    buffer_store_dwordx4 v[140:143], v31, s[28:31], s58 offen offset:0 sc1
    s_mov_b32 s8, s76
    s_mov_b32 s9, s77
    s_mov_b32 s10, 2621440
    s_mov_b32 s11, 0x00020000
    s_mov_b32 s12, s74
    s_mov_b32 s13, s75
    s_mov_b32 s14, 1280
    s_mov_b32 s15, 0x00020000
    s_lshl_b32 s45, s41, 3
    s_lshr_b32 s46, s38, 1
    s_lshl_b32 s46, s46, 2
    s_add_u32 s45, s45, s46
    s_add_u32 s45, s45, s40
    s_lshl_b32 s45, s45, 4
    v_and_b32 v174, 15, v0
    v_add_u32 v174, s45, v174
    v_mul_u32_u24 v174, 1280, v174
    s_mul_i32 s45, s42, 320
    s_and_b32 s46, s38, 1
    s_mul_i32 s46, s46, 160
    s_add_u32 s45, s45, s46
    v_lshrrev_b32 v175, 4, v0
    v_lshlrev_b32 v175, 3, v175
    v_add_u32 v19, s45, v175
    v_add_u32 v18, v174, v19
    v_lshlrev_b32 v32, 3, v0
    v_and_b32 v33, 384, v63
    v_accvgpr_read_b32 v40, a160
    v_accvgpr_read_b32 v41, a161
    v_accvgpr_read_b32 v42, a162
    v_accvgpr_read_b32 v43, a163
    v_accvgpr_read_b32 v44, a176
    v_accvgpr_read_b32 v45, a177
    v_accvgpr_read_b32 v46, a178
    v_accvgpr_read_b32 v47, a179
    v_pk_mul_f32 v[40:41], v[40:41], v[20:21] op_sel_hi:[1,0]
    v_pk_mul_f32 v[42:43], v[42:43], v[20:21] op_sel_hi:[1,0]
    v_pk_mul_f32 v[44:45], v[44:45], v[20:21] op_sel_hi:[1,0]
    v_pk_mul_f32 v[46:47], v[46:47], v[20:21] op_sel_hi:[1,0]
    v_cvt_pk_bf16_f32 v144, v40, v41
    v_cvt_pk_bf16_f32 v145, v42, v43
    v_cvt_pk_bf16_f32 v146, v44, v45
    v_cvt_pk_bf16_f32 v147, v46, v47
    buffer_store_dwordx4 v[144:147], v28, s[28:31], s58 offen offset:1024 sc1
    v_accvgpr_read_b32 v48, a164
    v_accvgpr_read_b32 v49, a165
    v_accvgpr_read_b32 v50, a166
    v_accvgpr_read_b32 v51, a167
    v_accvgpr_read_b32 v52, a180
    v_accvgpr_read_b32 v53, a181
    v_accvgpr_read_b32 v54, a182
    v_accvgpr_read_b32 v55, a183
    v_pk_mul_f32 v[48:49], v[48:49], v[22:23] op_sel_hi:[1,0]
    v_pk_mul_f32 v[50:51], v[50:51], v[22:23] op_sel_hi:[1,0]
    v_pk_mul_f32 v[52:53], v[52:53], v[22:23] op_sel_hi:[1,0]
    v_pk_mul_f32 v[54:55], v[54:55], v[22:23] op_sel_hi:[1,0]
    v_cvt_pk_bf16_f32 v148, v48, v49
    v_cvt_pk_bf16_f32 v149, v50, v51
    v_cvt_pk_bf16_f32 v150, v52, v53
    v_cvt_pk_bf16_f32 v151, v54, v55
    buffer_store_dwordx4 v[148:151], v29, s[28:31], s58 offen offset:1024 sc1
    v_accvgpr_read_b32 v40, a168
    v_accvgpr_read_b32 v41, a169
    v_accvgpr_read_b32 v42, a170
    v_accvgpr_read_b32 v43, a171
    v_accvgpr_read_b32 v44, a184
    v_accvgpr_read_b32 v45, a185
    v_accvgpr_read_b32 v46, a186
    v_accvgpr_read_b32 v47, a187
    v_pk_mul_f32 v[40:41], v[40:41], v[24:25] op_sel_hi:[1,0]
    v_pk_mul_f32 v[42:43], v[42:43], v[24:25] op_sel_hi:[1,0]
    v_pk_mul_f32 v[44:45], v[44:45], v[24:25] op_sel_hi:[1,0]
    v_pk_mul_f32 v[46:47], v[46:47], v[24:25] op_sel_hi:[1,0]
    v_cvt_pk_bf16_f32 v152, v40, v41
    v_cvt_pk_bf16_f32 v153, v42, v43
    v_cvt_pk_bf16_f32 v154, v44, v45
    v_cvt_pk_bf16_f32 v155, v46, v47
    buffer_store_dwordx4 v[152:155], v30, s[28:31], s58 offen offset:1024 sc1
    v_accvgpr_read_b32 v48, a172
    v_accvgpr_read_b32 v49, a173
    v_accvgpr_read_b32 v50, a174
    v_accvgpr_read_b32 v51, a175
    v_accvgpr_read_b32 v52, a188
    v_accvgpr_read_b32 v53, a189
    v_accvgpr_read_b32 v54, a190
    v_accvgpr_read_b32 v55, a191
    v_pk_mul_f32 v[48:49], v[48:49], v[26:27] op_sel_hi:[1,0]
    v_pk_mul_f32 v[50:51], v[50:51], v[26:27] op_sel_hi:[1,0]
    v_pk_mul_f32 v[52:53], v[52:53], v[26:27] op_sel_hi:[1,0]
    v_pk_mul_f32 v[54:55], v[54:55], v[26:27] op_sel_hi:[1,0]
    v_cvt_pk_bf16_f32 v156, v48, v49
    v_cvt_pk_bf16_f32 v157, v50, v51
    v_cvt_pk_bf16_f32 v158, v52, v53
    v_cvt_pk_bf16_f32 v159, v54, v55
    buffer_store_dwordx4 v[156:159], v31, s[28:31], s58 offen offset:1024 sc1
    s_lshr_b32 s45, s41, 1
    s_lshl_b32 s45, s45, 12
    s_add_u32 s58, s45, 32768
    v_mov_b32 v48, 0
    v_mov_b32 v49, 0
    v_mov_b32 v50, 0
    v_mov_b32 v51, 0
    s_waitcnt vmcnt(24) lgkmcnt(0)
    s_barrier
    ds_read_b32 v41, v172
    ds_read_b128 a[0:3], v6 offset:0
    ds_read_b128 a[36:39], v6 offset:1024
    ds_read_b128 a[16:19], v7 offset:0
    ds_read_b128 a[52:55], v7 offset:10240
    ds_read_b128 a[4:7], v6 offset:2048
    ds_read_b128 a[40:43], v6 offset:3072
    ds_read_b128 a[8:11], v6 offset:4096
    ds_read_b128 a[44:47], v6 offset:5120
    ds_read_b128 a[12:15], v6 offset:6144
    ds_read_b128 a[48:51], v6 offset:7168
    ds_read_b128 a[20:23], v7 offset:1024
    ds_read_b128 a[56:59], v7 offset:11264
    ds_read_b128 a[24:27], v7 offset:2048
    ds_read_b128 a[60:63], v7 offset:12288
    s_waitcnt lgkmcnt(14)
    v_readfirstlane_b32 s45, v41
    ds_read_b128 a[28:31], v7 offset:3072
    ds_read_b128 a[64:67], v7 offset:13312
    ds_read_b128 a[32:35], v7 offset:4096
    ds_read_b128 a[68:71], v7 offset:14336
    s_cmp_gt_u32 s45, s51
    s_cbranch_scc1 L_fallback
    v_mfma_f32_32x32x16_bf16 v[96:111], v[48:51], v[48:51], 0
    v_mfma_f32_32x32x16_bf16 v[112:127], v[48:51], v[48:51], 0
    v_mfma_f32_32x32x16_bf16 v[128:143], v[48:51], v[48:51], 0
    v_mfma_f32_32x32x16_bf16 v[144:159], v[48:51], v[48:51], 0
    v_mfma_f32_32x32x16_bf16 v[160:175], v[48:51], v[48:51], 0
    s_waitcnt lgkmcnt(0)
    v_mfma_f32_16x16x32_bf16 v[176:179], a[16:19], a[0:3], v[176:179]
    s_add_u32 s43, s43, 2048
    s_add_u32 s47, s47, 81920
    s_add_u32 s48, s48, 81920
    s_add_u32 s50, s53, 73728
    s_add_u32 s52, s54, 73728
    s_add_u32 m0, s50, 0
    s_nop 0
    buffer_load_dwordx4 v12, s[24:27], s43 offen offset:0 sc1 lds
    v_mfma_f32_16x16x32_bf16 v[176:179], a[52:55], a[36:39], v[176:179]
    buffer_load_dwordx4 v12, s[24:27], s43 offen offset:1024 sc1 lds
    v_mfma_f32_16x16x32_bf16 v[196:199], a[16:19], a[4:7], v[196:199]
    s_add_u32 m0, s50, 2048
    s_nop 0
    buffer_load_dwordx4 v13, s[24:27], s43 offen offset:0 sc1 lds
    v_mfma_f32_16x16x32_bf16 v[196:199], a[52:55], a[40:43], v[196:199]
    buffer_load_dwordx4 v13, s[24:27], s43 offen offset:1024 sc1 lds
    v_mfma_f32_16x16x32_bf16 v[216:219], a[16:19], a[8:11], v[216:219]
    s_mov_b32 m0, s52
    s_nop 0
    buffer_load_dwordx4 v1, s[88:91], s47 offen offset:0 sc1 lds
    v_mfma_f32_16x16x32_bf16 v[216:219], a[52:55], a[44:47], v[216:219]
    buffer_load_dwordx4 v1, s[88:91], s47 offen offset:1024 sc1 lds
    v_mfma_f32_16x16x32_bf16 v[236:239], a[16:19], a[12:15], v[236:239]
    buffer_load_dwordx4 v1, s[88:91], s47 offen offset:2048 sc1 lds
    v_mfma_f32_16x16x32_bf16 v[236:239], a[52:55], a[48:51], v[236:239]
    s_waitcnt lgkmcnt(0)
    s_barrier
    v_mfma_f32_16x16x32_bf16 v[180:183], a[20:23], a[0:3], v[180:183]
    v_add_u32 v6, 36864, v16
    v_add_u32 v7, 36864, v17
    v_mfma_f32_16x16x32_bf16 v[180:183], a[56:59], a[36:39], v[180:183]
    ds_read_b128 a[72:75], v6 offset:0
    v_mfma_f32_16x16x32_bf16 v[200:203], a[20:23], a[4:7], v[200:203]
    ds_read_b128 a[108:111], v6 offset:1024
    v_mfma_f32_16x16x32_bf16 v[200:203], a[56:59], a[40:43], v[200:203]
    buffer_load_dwordx4 v1, s[88:91], s47 offen offset:3072 sc1 lds
    v_mfma_f32_16x16x32_bf16 v[220:223], a[20:23], a[8:11], v[220:223]
    ds_read_b128 a[88:91], v7 offset:0
    v_mfma_f32_16x16x32_bf16 v[220:223], a[56:59], a[44:47], v[220:223]
    ds_read_b128 a[124:127], v7 offset:10240
    s_add_u32 m0, s52, 4096
    v_mfma_f32_16x16x32_bf16 v[240:243], a[20:23], a[12:15], v[240:243]
    buffer_load_dwordx4 v1, s[88:91], s48 offen sc1 lds
    v_mfma_f32_16x16x32_bf16 v[240:243], a[56:59], a[48:51], v[240:243]
    ds_read_b128 a[76:79], v6 offset:2048
    v_mfma_f32_16x16x32_bf16 v[184:187], a[24:27], a[0:3], v[184:187]
    ds_read_b128 a[112:115], v6 offset:3072
    s_add_u32 s43, s43, 2048
    s_add_u32 s47, s47, 81920
    s_add_u32 s48, s48, 81920
    s_add_u32 s50, s53, 110592
    s_add_u32 s52, s54, 110592
    s_add_u32 m0, s50, 0
    v_mfma_f32_16x16x32_bf16 v[184:187], a[60:63], a[36:39], v[184:187]
    buffer_load_dwordx4 v12, s[24:27], s43 offen offset:0 sc1 lds
    v_mfma_f32_16x16x32_bf16 v[204:207], a[24:27], a[4:7], v[204:207]
    ds_read_b128 a[80:83], v6 offset:4096
    v_mfma_f32_16x16x32_bf16 v[204:207], a[60:63], a[40:43], v[204:207]
    ds_read_b128 a[116:119], v6 offset:5120
    v_mfma_f32_16x16x32_bf16 v[224:227], a[24:27], a[8:11], v[224:227]
    buffer_load_dwordx4 v12, s[24:27], s43 offen offset:1024 sc1 lds
    v_mfma_f32_16x16x32_bf16 v[224:227], a[60:63], a[44:47], v[224:227]
    ds_read_b128 a[84:87], v6 offset:6144
    s_add_u32 m0, s50, 2048
    v_mfma_f32_16x16x32_bf16 v[244:247], a[24:27], a[12:15], v[244:247]
    buffer_load_dwordx4 v13, s[24:27], s43 offen offset:0 sc1 lds
    v_mfma_f32_16x16x32_bf16 v[244:247], a[60:63], a[48:51], v[244:247]
    ds_read_b128 a[120:123], v6 offset:7168
    v_mfma_f32_16x16x32_bf16 v[188:191], a[28:31], a[0:3], v[188:191]
    buffer_load_dwordx4 v13, s[24:27], s43 offen offset:1024 sc1 lds
    v_mfma_f32_16x16x32_bf16 v[188:191], a[64:67], a[36:39], v[188:191]
    ds_read_b128 a[92:95], v7 offset:1024
    s_mov_b32 m0, s52
    v_mfma_f32_16x16x32_bf16 v[208:211], a[28:31], a[4:7], v[208:211]
    buffer_load_dwordx4 v1, s[88:91], s47 offen offset:0 sc1 lds
    v_mfma_f32_16x16x32_bf16 v[208:211], a[64:67], a[40:43], v[208:211]
    ds_read_b128 a[128:131], v7 offset:11264
    v_mfma_f32_16x16x32_bf16 v[228:231], a[28:31], a[8:11], v[228:231]
    buffer_load_dwordx4 v1, s[88:91], s47 offen offset:1024 sc1 lds
    v_mfma_f32_16x16x32_bf16 v[228:231], a[64:67], a[44:47], v[228:231]
    ds_read_b128 a[96:99], v7 offset:2048
    v_mfma_f32_16x16x32_bf16 v[248:251], a[28:31], a[12:15], v[248:251]
    buffer_load_dwordx4 v1, s[88:91], s47 offen offset:2048 sc1 lds
    v_mfma_f32_16x16x32_bf16 v[248:251], a[64:67], a[48:51], v[248:251]
    ds_read_b128 a[132:135], v7 offset:12288
    v_mfma_f32_16x16x32_bf16 v[192:195], a[32:35], a[0:3], v[192:195]
    buffer_load_dwordx4 v1, s[88:91], s47 offen offset:3072 sc1 lds
    v_mfma_f32_16x16x32_bf16 v[192:195], a[68:71], a[36:39], v[192:195]
    ds_read_b128 a[100:103], v7 offset:3072
    s_add_u32 m0, s52, 4096
    v_mfma_f32_16x16x32_bf16 v[212:215], a[32:35], a[4:7], v[212:215]
    buffer_load_dwordx4 v1, s[88:91], s48 offen sc1 lds
    v_mfma_f32_16x16x32_bf16 v[212:215], a[68:71], a[40:43], v[212:215]
    ds_read_b128 a[136:139], v7 offset:13312
    v_mfma_f32_16x16x32_bf16 v[232:235], a[32:35], a[8:11], v[232:235]
    ds_read_b128 a[104:107], v7 offset:4096
    v_mfma_f32_16x16x32_bf16 v[232:235], a[68:71], a[44:47], v[232:235]
    ds_read_b128 a[140:143], v7 offset:14336
    v_mfma_f32_16x16x32_bf16 v[252:255], a[32:35], a[12:15], v[252:255]
    v_mfma_f32_16x16x32_bf16 v[252:255], a[68:71], a[48:51], v[252:255]
    s_waitcnt lgkmcnt(6)
    v_mfma_f32_16x16x32_bf16 v[176:179], a[88:91], a[72:75], v[176:179]
    s_add_u32 s43, s43, 2048
    s_add_u32 s47, s47, 81920
    s_add_u32 s48, s48, 81920
    s_add_u32 s50, s53, 0
    s_add_u32 s52, s54, 0
    s_add_u32 m0, s50, 0
    s_nop 0
    buffer_load_dwordx4 v12, s[24:27], s43 offen offset:0 sc1 lds
    v_mfma_f32_16x16x32_bf16 v[176:179], a[124:127], a[108:111], v[176:179]
    buffer_load_dwordx4 v12, s[24:27], s43 offen offset:1024 sc1 lds
    v_mfma_f32_16x16x32_bf16 v[196:199], a[88:91], a[76:79], v[196:199]
    s_add_u32 m0, s50, 2048
    s_nop 0
    buffer_load_dwordx4 v13, s[24:27], s43 offen offset:0 sc1 lds
    v_mfma_f32_16x16x32_bf16 v[196:199], a[124:127], a[112:115], v[196:199]
    buffer_load_dwordx4 v13, s[24:27], s43 offen offset:1024 sc1 lds
    v_mfma_f32_16x16x32_bf16 v[216:219], a[88:91], a[80:83], v[216:219]
    s_mov_b32 m0, s52
    s_nop 0
    buffer_load_dwordx4 v1, s[88:91], s47 offen offset:0 sc1 lds
    v_mfma_f32_16x16x32_bf16 v[216:219], a[124:127], a[116:119], v[216:219]
    buffer_load_dwordx4 v1, s[88:91], s47 offen offset:1024 sc1 lds
    v_mfma_f32_16x16x32_bf16 v[236:239], a[88:91], a[84:87], v[236:239]
    buffer_load_dwordx4 v1, s[88:91], s47 offen offset:2048 sc1 lds
    v_mfma_f32_16x16x32_bf16 v[236:239], a[124:127], a[120:123], v[236:239]
    s_waitcnt vmcnt(16)
    s_waitcnt lgkmcnt(0)
    s_barrier
    v_mfma_f32_16x16x32_bf16 v[180:183], a[92:95], a[72:75], v[180:183]
    s_cmp_eq_u32 s38, 0
    s_cbranch_scc1 L_g_h1
L_g_r1:
    v_add_u32 v6, 73728, v16
    v_add_u32 v7, 73728, v17
    v_mfma_f32_16x16x32_bf16 v[180:183], a[128:131], a[108:111], v[180:183]
    ds_read_b128 a[0:3], v6 offset:0
    v_mfma_f32_16x16x32_bf16 v[200:203], a[92:95], a[76:79], v[200:203]
    ds_read_b128 a[36:39], v6 offset:1024
    v_mfma_f32_16x16x32_bf16 v[200:203], a[128:131], a[112:115], v[200:203]
    buffer_load_dwordx4 v1, s[88:91], s47 offen offset:3072 sc1 lds
    v_mfma_f32_16x16x32_bf16 v[220:223], a[92:95], a[80:83], v[220:223]
    ds_read_b128 a[16:19], v7 offset:0
    v_mfma_f32_16x16x32_bf16 v[220:223], a[128:131], a[116:119], v[220:223]
    ds_read_b128 a[52:55], v7 offset:10240
    s_add_u32 m0, s52, 4096
    v_mfma_f32_16x16x32_bf16 v[240:243], a[92:95], a[84:87], v[240:243]
    buffer_load_dwordx4 v1, s[88:91], s48 offen sc1 lds
    v_mfma_f32_16x16x32_bf16 v[240:243], a[128:131], a[120:123], v[240:243]
    ds_read_b128 a[4:7], v6 offset:2048
    v_mfma_f32_16x16x32_bf16 v[184:187], a[96:99], a[72:75], v[184:187]
    ds_read_b128 a[40:43], v6 offset:3072
    s_add_u32 s43, s43, 2048
    s_add_u32 s47, s47, 81920
    s_add_u32 s48, s48, 81920
    s_add_u32 s50, s53, 36864
    s_add_u32 s52, s54, 36864
    s_add_u32 m0, s50, 0
    v_mfma_f32_16x16x32_bf16 v[184:187], a[132:135], a[108:111], v[184:187]
    buffer_load_dwordx4 v12, s[24:27], s43 offen offset:0 sc1 lds
    v_mfma_f32_16x16x32_bf16 v[204:207], a[96:99], a[76:79], v[204:207]
    ds_read_b128 a[8:11], v6 offset:4096
    v_mfma_f32_16x16x32_bf16 v[204:207], a[132:135], a[112:115], v[204:207]
    ds_read_b128 a[44:47], v6 offset:5120
    v_mfma_f32_16x16x32_bf16 v[224:227], a[96:99], a[80:83], v[224:227]
    buffer_load_dwordx4 v12, s[24:27], s43 offen offset:1024 sc1 lds
    v_mfma_f32_16x16x32_bf16 v[224:227], a[132:135], a[116:119], v[224:227]
    ds_read_b128 a[12:15], v6 offset:6144
    s_add_u32 m0, s50, 2048
    v_mfma_f32_16x16x32_bf16 v[244:247], a[96:99], a[84:87], v[244:247]
    buffer_load_dwordx4 v13, s[24:27], s43 offen offset:0 sc1 lds
    v_mfma_f32_16x16x32_bf16 v[244:247], a[132:135], a[120:123], v[244:247]
    ds_read_b128 a[48:51], v6 offset:7168
    v_mfma_f32_16x16x32_bf16 v[188:191], a[100:103], a[72:75], v[188:191]
    buffer_load_dwordx4 v13, s[24:27], s43 offen offset:1024 sc1 lds
    v_mfma_f32_16x16x32_bf16 v[188:191], a[136:139], a[108:111], v[188:191]
    ds_read_b128 a[20:23], v7 offset:1024
    s_mov_b32 m0, s52
    v_mfma_f32_16x16x32_bf16 v[208:211], a[100:103], a[76:79], v[208:211]
    buffer_load_dwordx4 v1, s[88:91], s47 offen offset:0 sc1 lds
    v_mfma_f32_16x16x32_bf16 v[208:211], a[136:139], a[112:115], v[208:211]
    ds_read_b128 a[56:59], v7 offset:11264
    v_mfma_f32_16x16x32_bf16 v[228:231], a[100:103], a[80:83], v[228:231]
    buffer_load_dwordx4 v1, s[88:91], s47 offen offset:1024 sc1 lds
    v_mfma_f32_16x16x32_bf16 v[228:231], a[136:139], a[116:119], v[228:231]
    ds_read_b128 a[24:27], v7 offset:2048
    v_mfma_f32_16x16x32_bf16 v[248:251], a[100:103], a[84:87], v[248:251]
    buffer_load_dwordx4 v1, s[88:91], s47 offen offset:2048 sc1 lds
    v_mfma_f32_16x16x32_bf16 v[248:251], a[136:139], a[120:123], v[248:251]
    ds_read_b128 a[60:63], v7 offset:12288
    v_mfma_f32_16x16x32_bf16 v[192:195], a[104:107], a[72:75], v[192:195]
    buffer_load_dwordx4 v1, s[88:91], s47 offen offset:3072 sc1 lds
    v_mfma_f32_16x16x32_bf16 v[192:195], a[140:143], a[108:111], v[192:195]
    ds_read_b128 a[28:31], v7 offset:3072
    s_add_u32 m0, s52, 4096
    v_mfma_f32_16x16x32_bf16 v[212:215], a[104:107], a[76:79], v[212:215]
    buffer_load_dwordx4 v1, s[88:91], s48 offen sc1 lds
    v_mfma_f32_16x16x32_bf16 v[212:215], a[140:143], a[112:115], v[212:215]
    ds_read_b128 a[64:67], v7 offset:13312
    v_mfma_f32_16x16x32_bf16 v[232:235], a[104:107], a[80:83], v[232:235]
    ds_read_b128 a[32:35], v7 offset:4096
    v_mfma_f32_16x16x32_bf16 v[232:235], a[140:143], a[116:119], v[232:235]
    ds_read_b128 a[68:71], v7 offset:14336
    v_mfma_f32_16x16x32_bf16 v[252:255], a[104:107], a[84:87], v[252:255]
    v_mfma_f32_16x16x32_bf16 v[252:255], a[140:143], a[120:123], v[252:255]
    s_waitcnt lgkmcnt(6)
    s_mov_b32 s49, 73728
    s_mov_b32 s26, 0
    s_mov_b32 s47, s56
    s_add_u32 s48, s56, 4096
    s_mov_b32 s44, 4
L_g_loop:
    v_mfma_f32_16x16x32_bf16 v[176:179], a[16:19], a[0:3], v[176:179]
    v_mfma_f32_16x16x32_bf16 v[176:179], a[52:55], a[36:39], v[176:179]
    v_mfma_f32_16x16x32_bf16 v[196:199], a[16:19], a[4:7], v[196:199]
    v_mfma_f32_16x16x32_bf16 v[196:199], a[52:55], a[40:43], v[196:199]
    s_add_u32 s50, s49, s53
    s_add_u32 s52, s49, s54
    s_add_u32 s49, s49, 36864
    v_mfma_f32_16x16x32_bf16 v[216:219], a[16:19], a[8:11], v[216:219]
    s_cmp_eq_u32 s49, 147456
    s_cselect_b32 s49, 0, s49
    v_mfma_f32_16x16x32_bf16 v[216:219], a[52:55], a[44:47], v[216:219]
    v_add_u32 v6, s49, v16
    v_add_u32 v7, s49, v17
    v_mfma_f32_16x16x32_bf16 v[236:239], a[16:19], a[12:15], v[236:239]
    s_waitcnt vmcnt(18)
    v_mfma_f32_16x16x32_bf16 v[236:239], a[52:55], a[48:51], v[236:239]
    s_waitcnt lgkmcnt(0)
    s_barrier
    v_mfma_f32_16x16x32_bf16 v[180:183], a[20:23], a[0:3], v[180:183]
    s_cmp_eq_u32 s44, 2
    s_cbranch_scc1 L_g_h0
L_g_r0:
    v_mfma_f32_16x16x32_bf16 v[180:183], a[56:59], a[36:39], v[180:183]
    ds_read_b128 a[72:75], v6 offset:0
    v_mfma_f32_16x16x32_bf16 v[200:203], a[20:23], a[4:7], v[200:203]
    ds_read_b128 a[108:111], v6 offset:1024
    s_add_u32 m0, s50, 0
    v_mfma_f32_16x16x32_bf16 v[200:203], a[56:59], a[40:43], v[200:203]
    buffer_load_dwordx4 v12, s[24:27], s43 offen offset:0 sc1 lds
    v_mfma_f32_16x16x32_bf16 v[220:223], a[20:23], a[8:11], v[220:223]
    ds_read_b128 a[88:91], v7 offset:0
    v_mfma_f32_16x16x32_bf16 v[220:223], a[56:59], a[44:47], v[220:223]
    ds_read_b128 a[124:127], v7 offset:10240
    v_mfma_f32_16x16x32_bf16 v[240:243], a[20:23], a[12:15], v[240:243]
    buffer_load_dwordx4 v12, s[24:27], s43 offen offset:1024 sc1 lds
    v_mfma_f32_16x16x32_bf16 v[240:243], a[56:59], a[48:51], v[240:243]
    ds_read_b128 a[76:79], v6 offset:2048
    v_mfma_f32_16x16x32_bf16 v[184:187], a[24:27], a[0:3], v[184:187]
    ds_read_b128 a[112:115], v6 offset:3072
    s_add_u32 m0, s50, 2048
    v_mfma_f32_16x16x32_bf16 v[184:187], a[60:63], a[36:39], v[184:187]
    buffer_load_dwordx4 v13, s[24:27], s43 offen offset:0 sc1 lds
    v_mfma_f32_16x16x32_bf16 v[204:207], a[24:27], a[4:7], v[204:207]
    ds_read_b128 a[80:83], v6 offset:4096
    v_mfma_f32_16x16x32_bf16 v[204:207], a[60:63], a[40:43], v[204:207]
    ds_read_b128 a[116:119], v6 offset:5120
    v_mfma_f32_16x16x32_bf16 v[224:227], a[24:27], a[8:11], v[224:227]
    buffer_load_dwordx4 v13, s[24:27], s43 offen offset:1024 sc1 lds
    v_mfma_f32_16x16x32_bf16 v[224:227], a[60:63], a[44:47], v[224:227]
    ds_read_b128 a[84:87], v6 offset:6144
    v_mfma_f32_16x16x32_bf16 v[244:247], a[24:27], a[12:15], v[244:247]
    ds_read_b128 a[120:123], v6 offset:7168
    s_mov_b32 m0, s52
    v_mfma_f32_16x16x32_bf16 v[244:247], a[60:63], a[48:51], v[244:247]
    buffer_load_dwordx4 v1, s[88:91], s47 offen offset:0 sc1 lds
    v_mfma_f32_16x16x32_bf16 v[188:191], a[28:31], a[0:3], v[188:191]
    ds_read_b128 a[92:95], v7 offset:1024
    v_mfma_f32_16x16x32_bf16 v[188:191], a[64:67], a[36:39], v[188:191]
    ds_read_b128 a[128:131], v7 offset:11264
    v_mfma_f32_16x16x32_bf16 v[208:211], a[28:31], a[4:7], v[208:211]
    buffer_load_dwordx4 v1, s[88:91], s47 offen offset:1024 sc1 lds
    v_mfma_f32_16x16x32_bf16 v[208:211], a[64:67], a[40:43], v[208:211]
    ds_read_b128 a[96:99], v7 offset:2048
    v_mfma_f32_16x16x32_bf16 v[228:231], a[28:31], a[8:11], v[228:231]
    ds_read_b128 a[132:135], v7 offset:12288
    v_mfma_f32_16x16x32_bf16 v[228:231], a[64:67], a[44:47], v[228:231]
    buffer_load_dwordx4 v1, s[88:91], s47 offen offset:2048 sc1 lds
    v_mfma_f32_16x16x32_bf16 v[248:251], a[28:31], a[12:15], v[248:251]
    ds_read_b128 a[100:103], v7 offset:3072
    v_mfma_f32_16x16x32_bf16 v[248:251], a[64:67], a[48:51], v[248:251]
    ds_read_b128 a[136:139], v7 offset:13312
    v_mfma_f32_16x16x32_bf16 v[192:195], a[32:35], a[0:3], v[192:195]
    buffer_load_dwordx4 v1, s[88:91], s47 offen offset:3072 sc1 lds
    v_mfma_f32_16x16x32_bf16 v[192:195], a[68:71], a[36:39], v[192:195]
    ds_read_b128 a[104:107], v7 offset:4096
    v_mfma_f32_16x16x32_bf16 v[212:215], a[32:35], a[4:7], v[212:215]
    ds_read_b128 a[140:143], v7 offset:14336
    s_add_u32 m0, s52, 4096
    v_mfma_f32_16x16x32_bf16 v[212:215], a[68:71], a[40:43], v[212:215]
    buffer_load_dwordx4 v1, s[88:91], s48 offen sc1 lds
    v_mfma_f32_16x16x32_bf16 v[232:235], a[32:35], a[8:11], v[232:235]
    s_add_u32 s43, s43, s16
    s_add_u32 s47, s47, s17
    s_add_u32 s48, s48, s17
    v_mfma_f32_16x16x32_bf16 v[232:235], a[68:71], a[44:47], v[232:235]
    s_sub_u32 s44, s44, 1
    v_mfma_f32_16x16x32_bf16 v[252:255], a[32:35], a[12:15], v[252:255]
    v_mfma_f32_16x16x32_bf16 v[252:255], a[68:71], a[48:51], v[252:255]
    s_waitcnt lgkmcnt(6)
    v_mfma_f32_16x16x32_bf16 v[176:179], a[88:91], a[72:75], v[176:179]
    v_mfma_f32_16x16x32_bf16 v[176:179], a[124:127], a[108:111], v[176:179]
    v_mfma_f32_16x16x32_bf16 v[196:199], a[88:91], a[76:79], v[196:199]
    v_mfma_f32_16x16x32_bf16 v[196:199], a[124:127], a[112:115], v[196:199]
    s_add_u32 s50, s49, s53
    s_add_u32 s52, s49, s54
    s_add_u32 s49, s49, 36864
    v_mfma_f32_16x16x32_bf16 v[216:219], a[88:91], a[80:83], v[216:219]
    s_cmp_eq_u32 s49, 147456
    s_cselect_b32 s49, 0, s49
    v_mfma_f32_16x16x32_bf16 v[216:219], a[124:127], a[116:119], v[216:219]
    v_add_u32 v6, s49, v16
    v_add_u32 v7, s49, v17
    v_mfma_f32_16x16x32_bf16 v[236:239], a[88:91], a[84:87], v[236:239]
    s_waitcnt vmcnt(18)
    v_mfma_f32_16x16x32_bf16 v[236:239], a[124:127], a[120:123], v[236:239]
    s_waitcnt lgkmcnt(0)
    s_barrier
    v_mfma_f32_16x16x32_bf16 v[180:183], a[92:95], a[72:75], v[180:183]
    v_mfma_f32_16x16x32_bf16 v[180:183], a[128:131], a[108:111], v[180:183]
    ds_read_b128 a[0:3], v6 offset:0
    v_mfma_f32_16x16x32_bf16 v[200:203], a[92:95], a[76:79], v[200:203]
    ds_read_b128 a[36:39], v6 offset:1024
    s_add_u32 m0, s50, 0
    v_mfma_f32_16x16x32_bf16 v[200:203], a[128:131], a[112:115], v[200:203]
    buffer_load_dwordx4 v12, s[24:27], s43 offen offset:0 sc1 lds
    v_mfma_f32_16x16x32_bf16 v[220:223], a[92:95], a[80:83], v[220:223]
    ds_read_b128 a[16:19], v7 offset:0
    v_mfma_f32_16x16x32_bf16 v[220:223], a[128:131], a[116:119], v[220:223]
    ds_read_b128 a[52:55], v7 offset:10240
    v_mfma_f32_16x16x32_bf16 v[240:243], a[92:95], a[84:87], v[240:243]
    buffer_load_dwordx4 v12, s[24:27], s43 offen offset:1024 sc1 lds
    v_mfma_f32_16x16x32_bf16 v[240:243], a[128:131], a[120:123], v[240:243]
    ds_read_b128 a[4:7], v6 offset:2048
    v_mfma_f32_16x16x32_bf16 v[184:187], a[96:99], a[72:75], v[184:187]
    ds_read_b128 a[40:43], v6 offset:3072
    s_add_u32 m0, s50, 2048
    v_mfma_f32_16x16x32_bf16 v[184:187], a[132:135], a[108:111], v[184:187]
    buffer_load_dwordx4 v13, s[24:27], s43 offen offset:0 sc1 lds
    v_mfma_f32_16x16x32_bf16 v[204:207], a[96:99], a[76:79], v[204:207]
    ds_read_b128 a[8:11], v6 offset:4096
    v_mfma_f32_16x16x32_bf16 v[204:207], a[132:135], a[112:115], v[204:207]
    ds_read_b128 a[44:47], v6 offset:5120
    v_mfma_f32_16x16x32_bf16 v[224:227], a[96:99], a[80:83], v[224:227]
    buffer_load_dwordx4 v13, s[24:27], s43 offen offset:1024 sc1 lds
    v_mfma_f32_16x16x32_bf16 v[224:227], a[132:135], a[116:119], v[224:227]
    ds_read_b128 a[12:15], v6 offset:6144
    v_mfma_f32_16x16x32_bf16 v[244:247], a[96:99], a[84:87], v[244:247]
    ds_read_b128 a[48:51], v6 offset:7168
    s_mov_b32 m0, s52
    v_mfma_f32_16x16x32_bf16 v[244:247], a[132:135], a[120:123], v[244:247]
    buffer_load_dwordx4 v1, s[88:91], s47 offen offset:0 sc1 lds
    v_mfma_f32_16x16x32_bf16 v[188:191], a[100:103], a[72:75], v[188:191]
    ds_read_b128 a[20:23], v7 offset:1024
    v_mfma_f32_16x16x32_bf16 v[188:191], a[136:139], a[108:111], v[188:191]
    ds_read_b128 a[56:59], v7 offset:11264
    v_mfma_f32_16x16x32_bf16 v[208:211], a[100:103], a[76:79], v[208:211]
    buffer_load_dwordx4 v1, s[88:91], s47 offen offset:1024 sc1 lds
    v_mfma_f32_16x16x32_bf16 v[208:211], a[136:139], a[112:115], v[208:211]
    ds_read_b128 a[24:27], v7 offset:2048
    v_mfma_f32_16x16x32_bf16 v[228:231], a[100:103], a[80:83], v[228:231]
    ds_read_b128 a[60:63], v7 offset:12288
    v_mfma_f32_16x16x32_bf16 v[228:231], a[136:139], a[116:119], v[228:231]
    buffer_load_dwordx4 v1, s[88:91], s47 offen offset:2048 sc1 lds
    v_mfma_f32_16x16x32_bf16 v[248:251], a[100:103], a[84:87], v[248:251]
    ds_read_b128 a[28:31], v7 offset:3072
    v_mfma_f32_16x16x32_bf16 v[248:251], a[136:139], a[120:123], v[248:251]
    ds_read_b128 a[64:67], v7 offset:13312
    v_mfma_f32_16x16x32_bf16 v[192:195], a[104:107], a[72:75], v[192:195]
    buffer_load_dwordx4 v1, s[88:91], s47 offen offset:3072 sc1 lds
    v_mfma_f32_16x16x32_bf16 v[192:195], a[140:143], a[108:111], v[192:195]
    ds_read_b128 a[32:35], v7 offset:4096
    v_mfma_f32_16x16x32_bf16 v[212:215], a[104:107], a[76:79], v[212:215]
    ds_read_b128 a[68:71], v7 offset:14336
    s_add_u32 m0, s52, 4096
    v_mfma_f32_16x16x32_bf16 v[212:215], a[140:143], a[112:115], v[212:215]
    buffer_load_dwordx4 v1, s[88:91], s48 offen sc1 lds
    v_mfma_f32_16x16x32_bf16 v[232:235], a[104:107], a[80:83], v[232:235]
    s_add_u32 s43, s43, s16
    s_add_u32 s47, s47, s17
    s_add_u32 s48, s48, s17
    v_mfma_f32_16x16x32_bf16 v[232:235], a[140:143], a[116:119], v[232:235]
    s_sub_u32 s44, s44, 1
    v_mfma_f32_16x16x32_bf16 v[252:255], a[104:107], a[84:87], v[252:255]
    v_mfma_f32_16x16x32_bf16 v[252:255], a[140:143], a[120:123], v[252:255]
    s_waitcnt lgkmcnt(6)
    s_cmp_lg_u32 s44, 0
    s_cbranch_scc1 L_g_loop
    s_branch L_g_done
L_g_h0:
    s_mov_b64 exec, s[20:21]
    buffer_load_dword v60, v63, s[92:95], s58 offen sc1
    s_mov_b64 exec, -1
    s_branch L_g_r0
L_g_h1:
    s_lshl_b32 s45, s37, 12
    s_lshl_b32 s46, s36, 7
    s_add_u32 s45, s45, s46
    s_add_u32 s45, s45, 32768
    s_mov_b32 exec_hi, 0
    buffer_store_dword v37, v62, s[92:95], s45 offen sc1
    s_mov_b32 exec_hi, -1
    s_branch L_g_r1
L_g_done:
    s_waitcnt vmcnt(18) lgkmcnt(0)
    s_barrier
    v_cmp_ne_u32 vcc, v37, v60
    s_nop 3
    s_and_b64 vcc, vcc, s[20:21]
    s_mov_b32 s59, 0
    s_cbranch_vccnz L_late
    s_mov_b32 s59, 1
    s_mov_b32 s43, s18
    s_add_u32 s50, s53, 73728
    s_add_u32 m0, s50, 0
    s_nop 0
    buffer_load_dwordx4 v14, s[28:31], s43 offen offset:0 sc1 lds
    buffer_load_dwordx4 v14, s[28:31], s43 offen offset:1024 sc1 lds
    s_add_u32 m0, s50, 2048
    s_nop 0
    buffer_load_dwordx4 v15, s[28:31], s43 offen offset:0 sc1 lds
    buffer_load_dwordx4 v15, s[28:31], s43 offen offset:1024 sc1 lds
    s_add_u32 s43, s43, s16
    s_add_u32 s50, s53, 110592
    s_add_u32 m0, s50, 0
    s_nop 0
    buffer_load_dwordx4 v14, s[28:31], s43 offen offset:0 sc1 lds
    buffer_load_dwordx4 v14, s[28:31], s43 offen offset:1024 sc1 lds
    s_add_u32 m0, s50, 2048
    s_nop 0
    buffer_load_dwordx4 v15, s[28:31], s43 offen offset:0 sc1 lds
    buffer_load_dwordx4 v15, s[28:31], s43 offen offset:1024 sc1 lds
    s_add_u32 s43, s43, s16
    s_add_u32 s50, s53, 0
    s_add_u32 m0, s50, 0
    s_nop 0
    buffer_load_dwordx4 v14, s[28:31], s43 offen offset:0 sc1 lds
    buffer_load_dwordx4 v14, s[28:31], s43 offen offset:1024 sc1 lds
    s_add_u32 m0, s50, 2048
    s_nop 0
    buffer_load_dwordx4 v15, s[28:31], s43 offen offset:0 sc1 lds
    buffer_load_dwordx4 v15, s[28:31], s43 offen offset:1024 sc1 lds
    s_add_u32 s43, s43, s16
    s_add_u32 s50, s53, 36864
    s_add_u32 m0, s50, 0
    s_nop 0
    buffer_load_dwordx4 v14, s[28:31], s43 offen offset:0 sc1 lds
    buffer_load_dwordx4 v14, s[28:31], s43 offen offset:1024 sc1 lds
    s_add_u32 m0, s50, 2048
    s_nop 0
    buffer_load_dwordx4 v15, s[28:31], s43 offen offset:0 sc1 lds
    buffer_load_dwordx4 v15, s[28:31], s43 offen offset:1024 sc1 lds
    s_add_u32 s43, s43, s16
L_late:
    s_lshl_b32 s57, s55, 2
    s_mul_i32 s46, s38, 2560
    s_xor_b32 s45, s40, 1
    s_add_u32 s45, s45, s57
    s_mul_i32 s45, s45, 40960
    s_add_u32 s45, s45, s46
    s_add_u32 s45, s45, 10496000
    v_cvt_pk_bf16_f32 v20, v196, v197
    v_cvt_pk_bf16_f32 v21, v198, v199
    v_cvt_pk_bf16_f32 v22, v200, v201
    v_cvt_pk_bf16_f32 v23, v202, v203
    v_cvt_pk_bf16_f32 v24, v204, v205
    v_cvt_pk_bf16_f32 v25, v206, v207
    v_cvt_pk_bf16_f32 v26, v208, v209
    v_cvt_pk_bf16_f32 v27, v210, v211
    v_cvt_pk_bf16_f32 v28, v212, v213
    v_cvt_pk_bf16_f32 v29, v214, v215
    buffer_store_dwordx4 v[20:23], v1, s[4:7], s45 offen sc1
    buffer_store_dwordx4 v[24:27], v1, s[4:7], s45 offen offset:1024 sc1
    buffer_store_dwordx2 v[28:29], v32, s[4:7], s45 offen offset:2048 sc1
    s_xor_b32 s45, s40, 2
    s_add_u32 s45, s45, s57
    s_mul_i32 s45, s45, 40960
    s_add_u32 s45, s45, s46
    s_add_u32 s45, s45, 10506240
    v_cvt_pk_bf16_f32 v40, v216, v217
    v_cvt_pk_bf16_f32 v41, v218, v219
    v_cvt_pk_bf16_f32 v42, v220, v221
    v_cvt_pk_bf16_f32 v43, v222, v223
    v_cvt_pk_bf16_f32 v44, v224, v225
    v_cvt_pk_bf16_f32 v45, v226, v227
    v_cvt_pk_bf16_f32 v46, v228, v229
    v_cvt_pk_bf16_f32 v47, v230, v231
    v_cvt_pk_bf16_f32 v48, v232, v233
    v_cvt_pk_bf16_f32 v49, v234, v235
    buffer_store_dwordx4 v[40:43], v1, s[4:7], s45 offen sc1
    buffer_store_dwordx4 v[44:47], v1, s[4:7], s45 offen offset:1024 sc1
    buffer_store_dwordx2 v[48:49], v32, s[4:7], s45 offen offset:2048 sc1
    s_xor_b32 s45, s40, 3
    s_add_u32 s45, s45, s57
    s_mul_i32 s45, s45, 40960
    s_add_u32 s45, s45, s46
    s_add_u32 s45, s45, 10516480
    v_cvt_pk_bf16_f32 v50, v236, v237
    v_cvt_pk_bf16_f32 v51, v238, v239
    v_cvt_pk_bf16_f32 v52, v240, v241
    v_cvt_pk_bf16_f32 v53, v242, v243
    v_cvt_pk_bf16_f32 v54, v244, v245
    v_cvt_pk_bf16_f32 v55, v246, v247
    v_cvt_pk_bf16_f32 v56, v248, v249
    v_cvt_pk_bf16_f32 v57, v250, v251
    v_cvt_pk_bf16_f32 v58, v252, v253
    v_cvt_pk_bf16_f32 v59, v254, v255
    buffer_store_dwordx4 v[50:53], v1, s[4:7], s45 offen sc1
    buffer_store_dwordx4 v[54:57], v1, s[4:7], s45 offen offset:1024 sc1
    buffer_store_dwordx2 v[58:59], v32, s[4:7], s45 offen offset:2048 sc1
    s_cmp_eq_u32 s59, 1
    s_cbranch_scc1 L_p3go
L_poll3:
    s_mov_b64 exec, s[20:21]
    buffer_load_dword v60, v63, s[92:95], s58 offen sc1
    s_mov_b64 exec, -1
    s_waitcnt vmcnt(0)
    v_cmp_ne_u32 vcc, v37, v60
    s_nop 3
    s_and_b64 vcc, vcc, s[20:21]
    s_cbranch_vccnz L_poll3
    s_mov_b32 s43, s18
    s_add_u32 s50, s53, 73728
    s_add_u32 m0, s50, 0
    s_nop 0
    buffer_load_dwordx4 v14, s[28:31], s43 offen offset:0 sc1 lds
    buffer_load_dwordx4 v14, s[28:31], s43 offen offset:1024 sc1 lds
    s_add_u32 m0, s50, 2048
    s_nop 0
    buffer_load_dwordx4 v15, s[28:31], s43 offen offset:0 sc1 lds
    buffer_load_dwordx4 v15, s[28:31], s43 offen offset:1024 sc1 lds
    s_add_u32 s43, s43, s16
    s_add_u32 s50, s53, 110592
    s_add_u32 m0, s50, 0
    s_nop 0
    buffer_load_dwordx4 v14, s[28:31], s43 offen offset:0 sc1 lds
    buffer_load_dwordx4 v14, s[28:31], s43 offen offset:1024 sc1 lds
    s_add_u32 m0, s50, 2048
    s_nop 0
    buffer_load_dwordx4 v15, s[28:31], s43 offen offset:0 sc1 lds
    buffer_load_dwordx4 v15, s[28:31], s43 offen offset:1024 sc1 lds
    s_add_u32 s43, s43, s16
    s_add_u32 s50, s53, 0
    s_add_u32 m0, s50, 0
    s_nop 0
    buffer_load_dwordx4 v14, s[28:31], s43 offen offset:0 sc1 lds
    buffer_load_dwordx4 v14, s[28:31], s43 offen offset:1024 sc1 lds
    s_add_u32 m0, s50, 2048
    s_nop 0
    buffer_load_dwordx4 v15, s[28:31], s43 offen offset:0 sc1 lds
    buffer_load_dwordx4 v15, s[28:31], s43 offen offset:1024 sc1 lds
    s_add_u32 s43, s43, s16
    s_add_u32 s50, s53, 36864
    s_add_u32 m0, s50, 0
    s_nop 0
    buffer_load_dwordx4 v14, s[28:31], s43 offen offset:0 sc1 lds
    buffer_load_dwordx4 v14, s[28:31], s43 offen offset:1024 sc1 lds
    s_add_u32 m0, s50, 2048
    s_nop 0
    buffer_load_dwordx4 v15, s[28:31], s43 offen offset:0 sc1 lds
    buffer_load_dwordx4 v15, s[28:31], s43 offen offset:1024 sc1 lds
    s_add_u32 s43, s43, s16
    buffer_load_dword v61, v1, s[24:27], 0 offen
    buffer_load_dword v61, v1, s[24:27], 0 offen
    buffer_load_dword v61, v1, s[24:27], 0 offen
    buffer_load_dword v61, v1, s[24:27], 0 offen
    buffer_load_dword v61, v1, s[24:27], 0 offen
    buffer_load_dword v61, v1, s[24:27], 0 offen
    buffer_load_dword v61, v1, s[24:27], 0 offen
    buffer_load_dword v61, v1, s[24:27], 0 offen
    buffer_load_dword v61, v1, s[24:27], 0 offen
L_p3go:
    s_sub_u32 s39, s19, -1
    s_add_u32 s44, s19, 3
    s_mov_b32 s59, 0
    s_waitcnt vmcnt(17)
    s_barrier
    ds_read_b128 a[0:3], v6 offset:0
    ds_read_b128 a[36:39], v6 offset:1024
    ds_read_b128 a[16:19], v7 offset:0
    ds_read_b128 a[52:55], v7 offset:10240
    ds_read_b128 a[4:7], v6 offset:2048
    ds_read_b128 a[40:43], v6 offset:3072
    ds_read_b128 a[8:11], v6 offset:4096
    ds_read_b128 a[44:47], v6 offset:5120
    ds_read_b128 a[12:15], v6 offset:6144
    ds_read_b128 a[48:51], v6 offset:7168
    ds_read_b128 a[20:23], v7 offset:1024
    ds_read_b128 a[56:59], v7 offset:11264
    ds_read_b128 a[24:27], v7 offset:2048
    ds_read_b128 a[60:63], v7 offset:12288
    ds_read_b128 a[28:31], v7 offset:3072
    ds_read_b128 a[64:67], v7 offset:13312
    ds_read_b128 a[32:35], v7 offset:4096
    ds_read_b128 a[68:71], v7 offset:14336
    s_waitcnt lgkmcnt(0)
.p2align 6
L_s_loop:
    v_mfma_f32_16x16x32_bf16 v[96:99], a[16:19], a[0:3], v[96:99]
    v_mfma_f32_16x16x32_bf16 v[96:99], a[52:55], a[36:39], v[96:99]
    v_mfma_f32_16x16x32_bf16 v[116:119], a[16:19], a[4:7], v[116:119]
    v_mfma_f32_16x16x32_bf16 v[116:119], a[52:55], a[40:43], v[116:119]
    s_add_u32 s50, s49, s53
    s_add_u32 s52, s49, s54
    s_add_u32 s49, s49, 36864
    v_mfma_f32_16x16x32_bf16 v[136:139], a[16:19], a[8:11], v[136:139]
    s_cmp_eq_u32 s49, 147456
    s_cselect_b32 s49, 0, s49
    v_mfma_f32_16x16x32_bf16 v[136:139], a[52:55], a[44:47], v[136:139]
    v_add_u32 v6, s49, v16
    v_add_u32 v7, s49, v17
    v_mfma_f32_16x16x32_bf16 v[156:159], a[16:19], a[12:15], v[156:159]
    s_waitcnt vmcnt(27)
    s_cmp_gt_u32 s44, s19
    s_cbranch_scc1 L_s_n0
    s_waitcnt vmcnt(18)
L_s_n0:
    v_mfma_f32_16x16x32_bf16 v[156:159], a[52:55], a[48:51], v[156:159]
    s_waitcnt lgkmcnt(0)
    s_barrier
    v_mfma_f32_16x16x32_bf16 v[100:103], a[20:23], a[0:3], v[100:103]
    s_cmp_eq_u32 s44, s39
    s_cbranch_scc1 L_s_h
L_s_r:
    v_mfma_f32_16x16x32_bf16 v[100:103], a[56:59], a[36:39], v[100:103]
    ds_read_b128 a[72:75], v6 offset:0
    v_mfma_f32_16x16x32_bf16 v[120:123], a[20:23], a[4:7], v[120:123]
    ds_read_b128 a[108:111], v6 offset:1024
    s_add_u32 m0, s50, 0
    v_mfma_f32_16x16x32_bf16 v[120:123], a[56:59], a[40:43], v[120:123]
    buffer_load_dwordx4 v14, s[28:31], s43 offen offset:0 sc1 lds
    v_mfma_f32_16x16x32_bf16 v[140:143], a[20:23], a[8:11], v[140:143]
    ds_read_b128 a[88:91], v7 offset:0
    v_mfma_f32_16x16x32_bf16 v[140:143], a[56:59], a[44:47], v[140:143]
    ds_read_b128 a[124:127], v7 offset:10240
    v_mfma_f32_16x16x32_bf16 v[160:163], a[20:23], a[12:15], v[160:163]
    buffer_load_dwordx4 v14, s[28:31], s43 offen offset:1024 sc1 lds
    v_mfma_f32_16x16x32_bf16 v[160:163], a[56:59], a[48:51], v[160:163]
    ds_read_b128 a[76:79], v6 offset:2048
    v_mfma_f32_16x16x32_bf16 v[104:107], a[24:27], a[0:3], v[104:107]
    ds_read_b128 a[112:115], v6 offset:3072
    s_add_u32 m0, s50, 2048
    v_mfma_f32_16x16x32_bf16 v[104:107], a[60:63], a[36:39], v[104:107]
    buffer_load_dwordx4 v15, s[28:31], s43 offen offset:0 sc1 lds
    v_mfma_f32_16x16x32_bf16 v[124:127], a[24:27], a[4:7], v[124:127]
    ds_read_b128 a[80:83], v6 offset:4096
    v_mfma_f32_16x16x32_bf16 v[124:127], a[60:63], a[40:43], v[124:127]
    ds_read_b128 a[116:119], v6 offset:5120
    v_mfma_f32_16x16x32_bf16 v[144:147], a[24:27], a[8:11], v[144:147]
    buffer_load_dwordx4 v15, s[28:31], s43 offen offset:1024 sc1 lds
    v_mfma_f32_16x16x32_bf16 v[144:147], a[60:63], a[44:47], v[144:147]
    ds_read_b128 a[84:87], v6 offset:6144
    v_mfma_f32_16x16x32_bf16 v[164:167], a[24:27], a[12:15], v[164:167]
    ds_read_b128 a[120:123], v6 offset:7168
    s_mov_b32 m0, s52
    v_mfma_f32_16x16x32_bf16 v[164:167], a[60:63], a[48:51], v[164:167]
    buffer_load_dwordx4 v1, s[88:91], s47 offen offset:0 sc1 lds
    v_mfma_f32_16x16x32_bf16 v[108:111], a[28:31], a[0:3], v[108:111]
    ds_read_b128 a[92:95], v7 offset:1024
    v_mfma_f32_16x16x32_bf16 v[108:111], a[64:67], a[36:39], v[108:111]
    ds_read_b128 a[128:131], v7 offset:11264
    v_mfma_f32_16x16x32_bf16 v[128:131], a[28:31], a[4:7], v[128:131]
    buffer_load_dwordx4 v1, s[88:91], s47 offen offset:1024 sc1 lds
    v_mfma_f32_16x16x32_bf16 v[128:131], a[64:67], a[40:43], v[128:131]
    ds_read_b128 a[96:99], v7 offset:2048
    v_mfma_f32_16x16x32_bf16 v[148:151], a[28:31], a[8:11], v[148:151]
    ds_read_b128 a[132:135], v7 offset:12288
    v_mfma_f32_16x16x32_bf16 v[148:151], a[64:67], a[44:47], v[148:151]
    buffer_load_dwordx4 v1, s[88:91], s47 offen offset:2048 sc1 lds
    v_mfma_f32_16x16x32_bf16 v[168:171], a[28:31], a[12:15], v[168:171]
    ds_read_b128 a[100:103], v7 offset:3072
    v_mfma_f32_16x16x32_bf16 v[168:171], a[64:67], a[48:51], v[168:171]
    ds_read_b128 a[136:139], v7 offset:13312
    v_mfma_f32_16x16x32_bf16 v[112:115], a[32:35], a[0:3], v[112:115]
    buffer_load_dwordx4 v1, s[88:91], s47 offen offset:3072 sc1 lds
    v_mfma_f32_16x16x32_bf16 v[112:115], a[68:71], a[36:39], v[112:115]
    ds_read_b128 a[104:107], v7 offset:4096
    v_mfma_f32_16x16x32_bf16 v[132:135], a[32:35], a[4:7], v[132:135]
    ds_read_b128 a[140:143], v7 offset:14336
    s_add_u32 m0, s52, 4096
    v_mfma_f32_16x16x32_bf16 v[132:135], a[68:71], a[40:43], v[132:135]
    buffer_load_dwordx4 v1, s[88:91], s48 offen sc1 lds
    v_mfma_f32_16x16x32_bf16 v[152:155], a[32:35], a[8:11], v[152:155]
    s_add_u32 s43, s43, s16
    s_add_u32 s47, s47, s17
    s_add_u32 s48, s48, s17
    v_mfma_f32_16x16x32_bf16 v[152:155], a[68:71], a[44:47], v[152:155]
    s_sub_u32 s44, s44, 1
    v_mfma_f32_16x16x32_bf16 v[172:175], a[32:35], a[12:15], v[172:175]
    v_mfma_f32_16x16x32_bf16 v[172:175], a[68:71], a[48:51], v[172:175]
    s_waitcnt lgkmcnt(6)
    v_mfma_f32_16x16x32_bf16 v[96:99], a[88:91], a[72:75], v[96:99]
    v_mfma_f32_16x16x32_bf16 v[96:99], a[124:127], a[108:111], v[96:99]
    v_mfma_f32_16x16x32_bf16 v[116:119], a[88:91], a[76:79], v[116:119]
    v_mfma_f32_16x16x32_bf16 v[116:119], a[124:127], a[112:115], v[116:119]
    s_add_u32 s50, s49, s53
    s_add_u32 s52, s49, s54
    s_add_u32 s49, s49, 36864
    v_mfma_f32_16x16x32_bf16 v[136:139], a[88:91], a[80:83], v[136:139]
    s_cmp_eq_u32 s49, 147456
    s_cselect_b32 s49, 0, s49
    v_mfma_f32_16x16x32_bf16 v[136:139], a[124:127], a[116:119], v[136:139]
    v_add_u32 v6, s49, v16
    v_add_u32 v7, s49, v17
    v_mfma_f32_16x16x32_bf16 v[156:159], a[88:91], a[84:87], v[156:159]
    s_waitcnt vmcnt(22)
    s_cmp_gt_u32 s44, s19
    s_cbranch_scc1 L_s_n1
    s_waitcnt vmcnt(18)
L_s_n1:
    v_mfma_f32_16x16x32_bf16 v[156:159], a[124:127], a[120:123], v[156:159]
    s_waitcnt lgkmcnt(0)
    s_barrier
    v_mfma_f32_16x16x32_bf16 v[100:103], a[92:95], a[72:75], v[100:103]
    v_mfma_f32_16x16x32_bf16 v[100:103], a[128:131], a[108:111], v[100:103]
    ds_read_b128 a[0:3], v6 offset:0
    v_mfma_f32_16x16x32_bf16 v[120:123], a[92:95], a[76:79], v[120:123]
    ds_read_b128 a[36:39], v6 offset:1024
    s_add_u32 m0, s50, 0
    v_mfma_f32_16x16x32_bf16 v[120:123], a[128:131], a[112:115], v[120:123]
    buffer_load_dwordx4 v14, s[28:31], s43 offen offset:0 sc1 lds
    v_mfma_f32_16x16x32_bf16 v[140:143], a[92:95], a[80:83], v[140:143]
    ds_read_b128 a[16:19], v7 offset:0
    v_mfma_f32_16x16x32_bf16 v[140:143], a[128:131], a[116:119], v[140:143]
    ds_read_b128 a[52:55], v7 offset:10240
    v_mfma_f32_16x16x32_bf16 v[160:163], a[92:95], a[84:87], v[160:163]
    buffer_load_dwordx4 v14, s[28:31], s43 offen offset:1024 sc1 lds
    v_mfma_f32_16x16x32_bf16 v[160:163], a[128:131], a[120:123], v[160:163]
    ds_read_b128 a[4:7], v6 offset:2048
    v_mfma_f32_16x16x32_bf16 v[104:107], a[96:99], a[72:75], v[104:107]
    ds_read_b128 a[40:43], v6 offset:3072
    s_add_u32 m0, s50, 2048
    v_mfma_f32_16x16x32_bf16 v[104:107], a[132:135], a[108:111], v[104:107]
    buffer_load_dwordx4 v15, s[28:31], s43 offen offset:0 sc1 lds
    v_mfma_f32_16x16x32_bf16 v[124:127], a[96:99], a[76:79], v[124:127]
    ds_read_b128 a[8:11], v6 offset:4096
    v_mfma_f32_16x16x32_bf16 v[124:127], a[132:135], a[112:115], v[124:127]
    ds_read_b128 a[44:47], v6 offset:5120
    v_mfma_f32_16x16x32_bf16 v[144:147], a[96:99], a[80:83], v[144:147]
    buffer_load_dwordx4 v15, s[28:31], s43 offen offset:1024 sc1 lds
    v_mfma_f32_16x16x32_bf16 v[144:147], a[132:135], a[116:119], v[144:147]
    ds_read_b128 a[12:15], v6 offset:6144
    v_mfma_f32_16x16x32_bf16 v[164:167], a[96:99], a[84:87], v[164:167]
    ds_read_b128 a[48:51], v6 offset:7168
    s_mov_b32 m0, s52
    v_mfma_f32_16x16x32_bf16 v[164:167], a[132:135], a[120:123], v[164:167]
    buffer_load_dwordx4 v1, s[88:91], s47 offen offset:0 sc1 lds
    v_mfma_f32_16x16x32_bf16 v[108:111], a[100:103], a[72:75], v[108:111]
    ds_read_b128 a[20:23], v7 offset:1024
    v_mfma_f32_16x16x32_bf16 v[108:111], a[136:139], a[108:111], v[108:111]
    ds_read_b128 a[56:59], v7 offset:11264
    v_mfma_f32_16x16x32_bf16 v[128:131], a[100:103], a[76:79], v[128:131]
    buffer_load_dwordx4 v1, s[88:91], s47 offen offset:1024 sc1 lds
    v_mfma_f32_16x16x32_bf16 v[128:131], a[136:139], a[112:115], v[128:131]
    ds_read_b128 a[24:27], v7 offset:2048
    v_mfma_f32_16x16x32_bf16 v[148:151], a[100:103], a[80:83], v[148:151]
    ds_read_b128 a[60:63], v7 offset:12288
    v_mfma_f32_16x16x32_bf16 v[148:151], a[136:139], a[116:119], v[148:151]
    buffer_load_dwordx4 v1, s[88:91], s47 offen offset:2048 sc1 lds
    v_mfma_f32_16x16x32_bf16 v[168:171], a[100:103], a[84:87], v[168:171]
    ds_read_b128 a[28:31], v7 offset:3072
    v_mfma_f32_16x16x32_bf16 v[168:171], a[136:139], a[120:123], v[168:171]
    ds_read_b128 a[64:67], v7 offset:13312
    v_mfma_f32_16x16x32_bf16 v[112:115], a[104:107], a[72:75], v[112:115]
    buffer_load_dwordx4 v1, s[88:91], s47 offen offset:3072 sc1 lds
    v_mfma_f32_16x16x32_bf16 v[112:115], a[140:143], a[108:111], v[112:115]
    ds_read_b128 a[32:35], v7 offset:4096
    v_mfma_f32_16x16x32_bf16 v[132:135], a[104:107], a[76:79], v[132:135]
    ds_read_b128 a[68:71], v7 offset:14336
    s_add_u32 m0, s52, 4096
    v_mfma_f32_16x16x32_bf16 v[132:135], a[140:143], a[112:115], v[132:135]
    buffer_load_dwordx4 v1, s[88:91], s48 offen sc1 lds
    v_mfma_f32_16x16x32_bf16 v[152:155], a[104:107], a[80:83], v[152:155]
    s_add_u32 s43, s43, s16
    s_add_u32 s47, s47, s17
    s_add_u32 s48, s48, s17
    v_mfma_f32_16x16x32_bf16 v[152:155], a[140:143], a[116:119], v[152:155]
    s_sub_u32 s44, s44, 1
    v_mfma_f32_16x16x32_bf16 v[172:175], a[104:107], a[84:87], v[172:175]
    v_mfma_f32_16x16x32_bf16 v[172:175], a[140:143], a[120:123], v[172:175]
    s_waitcnt lgkmcnt(6)
    s_cmp_lg_u32 s44, 2
    s_cbranch_scc1 L_s_loop
    s_lshl_b32 s45, s55, 2
    s_add_u32 s45, s45, s40
    s_mul_i32 s45, s45, 40960
    s_mul_i32 s46, s38, 2560
    s_add_u32 s45, s45, s46
    s_add_u32 s45, s45, 10485760
    v_mfma_f32_16x16x32_bf16 v[96:99], a[16:19], a[0:3], v[96:99]
    v_mfma_f32_16x16x32_bf16 v[96:99], a[52:55], a[36:39], v[96:99]
    v_mfma_f32_16x16x32_bf16 v[116:119], a[16:19], a[4:7], v[116:119]
    v_mfma_f32_16x16x32_bf16 v[116:119], a[52:55], a[40:43], v[116:119]
    s_add_u32 s49, s49, 36864
    v_mfma_f32_16x16x32_bf16 v[136:139], a[16:19], a[8:11], v[136:139]
    s_cmp_eq_u32 s49, 147456
    s_cselect_b32 s49, 0, s49
    v_mfma_f32_16x16x32_bf16 v[136:139], a[52:55], a[44:47], v[136:139]
    v_add_u32 v6, s49, v16
    v_add_u32 v7, s49, v17
    v_mfma_f32_16x16x32_bf16 v[156:159], a[16:19], a[12:15], v[156:159]
    s_waitcnt vmcnt(18)
    v_mfma_f32_16x16x32_bf16 v[156:159], a[52:55], a[48:51], v[156:159]
    s_waitcnt lgkmcnt(0)
    s_barrier
    v_mfma_f32_16x16x32_bf16 v[100:103], a[20:23], a[0:3], v[100:103]
    v_cmp_ne_u32 vcc, v37, v60
    s_cbranch_vccnz L_repoll5
L_f5ok:
    v_mfma_f32_16x16x32_bf16 v[100:103], a[56:59], a[36:39], v[100:103]
    ds_read_b128 a[72:75], v6 offset:0
    v_mfma_f32_16x16x32_bf16 v[120:123], a[20:23], a[4:7], v[120:123]
    ds_read_b128 a[108:111], v6 offset:1024
    s_add_u32 s45, s45, 10240
    v_mfma_f32_16x16x32_bf16 v[120:123], a[56:59], a[40:43], v[120:123]
    buffer_load_dwordx4 v[196:199], v1, s[4:7], s45 offen sc1
    v_mfma_f32_16x16x32_bf16 v[140:143], a[20:23], a[8:11], v[140:143]
    ds_read_b128 a[88:91], v7 offset:0
    v_mfma_f32_16x16x32_bf16 v[140:143], a[56:59], a[44:47], v[140:143]
    ds_read_b128 a[124:127], v7 offset:10240
    v_mfma_f32_16x16x32_bf16 v[160:163], a[20:23], a[12:15], v[160:163]
    buffer_load_dwordx4 v[200:203], v1, s[4:7], s45 offen offset:1024 sc1
    v_mfma_f32_16x16x32_bf16 v[160:163], a[56:59], a[48:51], v[160:163]
    ds_read_b128 a[76:79], v6 offset:2048
    v_mfma_f32_16x16x32_bf16 v[104:107], a[24:27], a[0:3], v[104:107]
    ds_read_b128 a[112:115], v6 offset:3072
    v_mfma_f32_16x16x32_bf16 v[104:107], a[60:63], a[36:39], v[104:107]
    buffer_load_dwordx2 v[204:205], v32, s[4:7], s45 offen offset:2048 sc1
    v_mfma_f32_16x16x32_bf16 v[124:127], a[24:27], a[4:7], v[124:127]
    ds_read_b128 a[80:83], v6 offset:4096
    v_mfma_f32_16x16x32_bf16 v[124:127], a[60:63], a[40:43], v[124:127]
    ds_read_b128 a[116:119], v6 offset:5120
    s_add_u32 s45, s45, 10240
    v_mfma_f32_16x16x32_bf16 v[144:147], a[24:27], a[8:11], v[144:147]
    buffer_load_dwordx4 v[208:211], v1, s[4:7], s45 offen sc1
    v_mfma_f32_16x16x32_bf16 v[144:147], a[60:63], a[44:47], v[144:147]
    ds_read_b128 a[84:87], v6 offset:6144
    v_mfma_f32_16x16x32_bf16 v[164:167], a[24:27], a[12:15], v[164:167]
    ds_read_b128 a[120:123], v6 offset:7168
    v_mfma_f32_16x16x32_bf16 v[164:167], a[60:63], a[48:51], v[164:167]
    buffer_load_dwordx4 v[212:215], v1, s[4:7], s45 offen offset:1024 sc1
    v_mfma_f32_16x16x32_bf16 v[108:111], a[28:31], a[0:3], v[108:111]
    ds_read_b128 a[92:95], v7 offset:1024
    v_mfma_f32_16x16x32_bf16 v[108:111], a[64:67], a[36:39], v[108:111]
    ds_read_b128 a[128:131], v7 offset:11264
    v_mfma_f32_16x16x32_bf16 v[128:131], a[28:31], a[4:7], v[128:131]
    buffer_load_dwordx2 v[216:217], v32, s[4:7], s45 offen offset:2048 sc1
    v_mfma_f32_16x16x32_bf16 v[128:131], a[64:67], a[40:43], v[128:131]
    ds_read_b128 a[96:99], v7 offset:2048
    v_mfma_f32_16x16x32_bf16 v[148:151], a[28:31], a[8:11], v[148:151]
    ds_read_b128 a[132:135], v7 offset:12288
    s_add_u32 s45, s45, 10240
    v_mfma_f32_16x16x32_bf16 v[148:151], a[64:67], a[44:47], v[148:151]
    buffer_load_dwordx4 v[220:223], v1, s[4:7], s45 offen sc1
    v_mfma_f32_16x16x32_bf16 v[168:171], a[28:31], a[12:15], v[168:171]
    ds_read_b128 a[100:103], v7 offset:3072
    v_mfma_f32_16x16x32_bf16 v[168:171], a[64:67], a[48:51], v[168:171]
    ds_read_b128 a[136:139], v7 offset:13312
    v_mfma_f32_16x16x32_bf16 v[112:115], a[32:35], a[0:3], v[112:115]
    buffer_load_dwordx4 v[224:227], v1, s[4:7], s45 offen offset:1024 sc1
    v_mfma_f32_16x16x32_bf16 v[112:115], a[68:71], a[36:39], v[112:115]
    ds_read_b128 a[104:107], v7 offset:4096
    v_mfma_f32_16x16x32_bf16 v[132:135], a[32:35], a[4:7], v[132:135]
    ds_read_b128 a[140:143], v7 offset:14336
    v_mfma_f32_16x16x32_bf16 v[132:135], a[68:71], a[40:43], v[132:135]
    buffer_load_dwordx2 v[228:229], v32, s[4:7], s45 offen offset:2048 sc1
    v_mfma_f32_16x16x32_bf16 v[152:155], a[32:35], a[8:11], v[152:155]
    v_mfma_f32_16x16x32_bf16 v[152:155], a[68:71], a[44:47], v[152:155]
    v_mfma_f32_16x16x32_bf16 v[172:175], a[32:35], a[12:15], v[172:175]
    v_mfma_f32_16x16x32_bf16 v[172:175], a[68:71], a[48:51], v[172:175]
    s_waitcnt lgkmcnt(6)
    v_mfma_f32_16x16x32_bf16 v[96:99], a[88:91], a[72:75], v[96:99]
    v_mfma_f32_16x16x32_bf16 v[96:99], a[124:127], a[108:111], v[96:99]
    v_mfma_f32_16x16x32_bf16 v[116:119], a[88:91], a[76:79], v[116:119]
    v_mfma_f32_16x16x32_bf16 v[116:119], a[124:127], a[112:115], v[116:119]
    v_mfma_f32_16x16x32_bf16 v[136:139], a[88:91], a[80:83], v[136:139]
    v_mfma_f32_16x16x32_bf16 v[136:139], a[124:127], a[116:119], v[136:139]
    v_mfma_f32_16x16x32_bf16 v[156:159], a[88:91], a[84:87], v[156:159]
    v_mfma_f32_16x16x32_bf16 v[156:159], a[124:127], a[120:123], v[156:159]
    s_waitcnt lgkmcnt(0)
    v_mfma_f32_16x16x32_bf16 v[100:103], a[92:95], a[72:75], v[100:103]
    v_mfma_f32_16x16x32_bf16 v[100:103], a[128:131], a[108:111], v[100:103]
    v_mfma_f32_16x16x32_bf16 v[120:123], a[92:95], a[76:79], v[120:123]
    buffer_load_dwordx2 v[74:75], v19, s[12:15], 0 offen offset:0
    v_mfma_f32_16x16x32_bf16 v[120:123], a[128:131], a[112:115], v[120:123]
    v_mfma_f32_16x16x32_bf16 v[140:143], a[92:95], a[80:83], v[140:143]
    buffer_load_dwordx2 v[76:77], v19, s[12:15], 0 offen offset:32
    v_mfma_f32_16x16x32_bf16 v[140:143], a[128:131], a[116:119], v[140:143]
    v_mfma_f32_16x16x32_bf16 v[160:163], a[92:95], a[84:87], v[160:163]
    buffer_load_dwordx2 v[78:79], v19, s[12:15], 0 offen offset:64
    v_mfma_f32_16x16x32_bf16 v[160:163], a[128:131], a[120:123], v[160:163]
    v_mfma_f32_16x16x32_bf16 v[104:107], a[96:99], a[72:75], v[104:107]
    buffer_load_dwordx2 v[80:81], v19, s[12:15], 0 offen offset:96
    v_mfma_f32_16x16x32_bf16 v[104:107], a[132:135], a[108:111], v[104:107]
    v_mfma_f32_16x16x32_bf16 v[124:127], a[96:99], a[76:79], v[124:127]
    buffer_load_dwordx2 v[82:83], v19, s[12:15], 0 offen offset:128
    v_mfma_f32_16x16x32_bf16 v[124:127], a[132:135], a[112:115], v[124:127]
    v_mfma_f32_16x16x32_bf16 v[144:147], a[96:99], a[80:83], v[144:147]
    v_mfma_f32_16x16x32_bf16 v[144:147], a[132:135], a[116:119], v[144:147]
    v_mfma_f32_16x16x32_bf16 v[164:167], a[96:99], a[84:87], v[164:167]
    v_mfma_f32_16x16x32_bf16 v[164:167], a[132:135], a[120:123], v[164:167]
    v_mfma_f32_16x16x32_bf16 v[108:111], a[100:103], a[72:75], v[108:111]
    v_mfma_f32_16x16x32_bf16 v[108:111], a[136:139], a[108:111], v[108:111]
    v_mfma_f32_16x16x32_bf16 v[128:131], a[100:103], a[76:79], v[128:131]
    v_mfma_f32_16x16x32_bf16 v[128:131], a[136:139], a[112:115], v[128:131]
    v_mfma_f32_16x16x32_bf16 v[148:151], a[100:103], a[80:83], v[148:151]
    v_mfma_f32_16x16x32_bf16 v[148:151], a[136:139], a[116:119], v[148:151]
    v_mfma_f32_16x16x32_bf16 v[168:171], a[100:103], a[84:87], v[168:171]
    v_mfma_f32_16x16x32_bf16 v[168:171], a[136:139], a[120:123], v[168:171]
    v_mfma_f32_16x16x32_bf16 v[112:115], a[104:107], a[72:75], v[112:115]
    v_mfma_f32_16x16x32_bf16 v[112:115], a[140:143], a[108:111], v[112:115]
    v_mfma_f32_16x16x32_bf16 v[132:135], a[104:107], a[76:79], v[132:135]
    v_mfma_f32_16x16x32_bf16 v[132:135], a[140:143], a[112:115], v[132:135]
    v_mfma_f32_16x16x32_bf16 v[152:155], a[104:107], a[80:83], v[152:155]
    v_mfma_f32_16x16x32_bf16 v[152:155], a[140:143], a[116:119], v[152:155]
    v_mfma_f32_16x16x32_bf16 v[172:175], a[104:107], a[84:87], v[172:175]
    v_mfma_f32_16x16x32_bf16 v[172:175], a[140:143], a[120:123], v[172:175]
    s_branch L_s_done
L_s_h:
    s_lshl_b32 s57, s55, 9
    s_add_u32 s57, s57, 131072
    s_cmp_eq_u32 s44, 4
    s_cbranch_scc1 L_s_h2
    s_cmp_eq_u32 s59, 1
    s_cbranch_scc1 L_s_h4
    s_mov_b32 s59, 1
    s_sub_u32 s39, s39, 2
    s_mov_b64 exec, s[22:23]
    buffer_load_dword v60, v63, s[92:95], s58 offen sc1
    s_mov_b64 exec, -1
    s_branch L_s_r
L_s_h5:
    s_mov_b64 exec, s[22:23]
    buffer_load_dword v60, v63, s[92:95], s58 offen sc1
    s_mov_b64 exec, -1
    s_waitcnt vmcnt(0)
L_s_h4:
    v_cmp_ne_u32 vcc, v37, v60
    s_mov_b32 s39, 4
    s_lshl_b32 s46, s40, 7
    s_add_u32 s45, s57, s46
    s_nop 0
    s_and_b64 vcc, vcc, s[22:23]
    s_cbranch_vccnz L_s_h5
    s_cmp_lg_u32 s38, 0
    s_cbranch_scc1 L_s_r
    s_mov_b32 exec_hi, 0
    buffer_store_dword v37, v62, s[92:95], s45 offen sc1
    s_mov_b32 exec_hi, -1
    s_branch L_s_r
L_s_h2:
    s_mov_b32 s30, 0
    s_mov_b32 s90, 0
    buffer_load_dword v60, v33, s[92:95], s57 offen sc1
    s_branch L_s_r
L_repoll5:
    buffer_load_dword v60, v33, s[92:95], s57 offen sc1
    s_waitcnt vmcnt(0)
    v_cmp_ne_u32 vcc, v37, v60
    s_cbranch_vccnz L_repoll5
    s_branch L_f5ok
L_s_done:
    s_nop 5
    s_lshl_b32 s57, s55, 2
    s_mul_i32 s46, s38, 2560
    s_xor_b32 s45, s40, 1
    s_add_u32 s45, s45, s57
    s_mul_i32 s45, s45, 40960
    s_add_u32 s45, s45, s46
    s_add_u32 s45, s45, 10240
    v_cvt_pk_bf16_f32 v20, v116, v117
    v_cvt_pk_bf16_f32 v21, v118, v119
    v_cvt_pk_bf16_f32 v22, v120, v121
    v_cvt_pk_bf16_f32 v23, v122, v123
    v_cvt_pk_bf16_f32 v24, v124, v125
    v_cvt_pk_bf16_f32 v25, v126, v127
    v_cvt_pk_bf16_f32 v26, v128, v129
    v_cvt_pk_bf16_f32 v27, v130, v131
    v_cvt_pk_bf16_f32 v28, v132, v133
    v_cvt_pk_bf16_f32 v29, v134, v135
    buffer_store_dwordx4 v[20:23], v1, s[4:7], s45 offen sc1
    buffer_store_dwordx4 v[24:27], v1, s[4:7], s45 offen offset:1024 sc1
    buffer_store_dwordx2 v[28:29], v32, s[4:7], s45 offen offset:2048 sc1
    s_xor_b32 s45, s40, 2
    s_add_u32 s45, s45, s57
    s_mul_i32 s45, s45, 40960
    s_add_u32 s45, s45, s46
    s_add_u32 s45, s45, 20480
    v_cvt_pk_bf16_f32 v40, v136, v137
    v_cvt_pk_bf16_f32 v41, v138, v139
    v_cvt_pk_bf16_f32 v42, v140, v141
    v_cvt_pk_bf16_f32 v43, v142, v143
    v_cvt_pk_bf16_f32 v44, v144, v145
    v_cvt_pk_bf16_f32 v45, v146, v147
    v_cvt_pk_bf16_f32 v46, v148, v149
    v_cvt_pk_bf16_f32 v47, v150, v151
    v_cvt_pk_bf16_f32 v48, v152, v153
    v_cvt_pk_bf16_f32 v49, v154, v155
    buffer_store_dwordx4 v[40:43], v1, s[4:7], s45 offen sc1
    buffer_store_dwordx4 v[44:47], v1, s[4:7], s45 offen offset:1024 sc1
    buffer_store_dwordx2 v[48:49], v32, s[4:7], s45 offen offset:2048 sc1
    s_xor_b32 s45, s40, 3
    s_add_u32 s45, s45, s57
    s_mul_i32 s45, s45, 40960
    s_add_u32 s45, s45, s46
    s_add_u32 s45, s45, 30720
    v_cvt_pk_bf16_f32 v50, v156, v157
    v_cvt_pk_bf16_f32 v51, v158, v159
    v_cvt_pk_bf16_f32 v52, v160, v161
    v_cvt_pk_bf16_f32 v53, v162, v163
    v_cvt_pk_bf16_f32 v54, v164, v165
    v_cvt_pk_bf16_f32 v55, v166, v167
    v_cvt_pk_bf16_f32 v56, v168, v169
    v_cvt_pk_bf16_f32 v57, v170, v171
    v_cvt_pk_bf16_f32 v58, v172, v173
    v_cvt_pk_bf16_f32 v59, v174, v175
    buffer_store_dwordx4 v[50:53], v1, s[4:7], s45 offen sc1
    buffer_store_dwordx4 v[54:57], v1, s[4:7], s45 offen offset:1024 sc1
    buffer_store_dwordx2 v[58:59], v32, s[4:7], s45 offen offset:2048 sc1
    s_lshl_b32 s57, s55, 11
    s_lshl_b32 s45, s38, 7
    s_add_u32 s57, s57, s45
    s_add_u32 s57, s57, 163968
    s_lshl_b32 s46, s40, 9
    s_add_u32 s45, s57, s46
    v_lshlrev_b32 v33, 2, v33
    s_waitcnt vmcnt(9)
    v_lshlrev_b32 v84, 16, v196
    v_and_b32 v85, 0xffff0000, v196
    v_pk_add_f32 v[176:177], v[176:177], v[84:85]
    v_lshlrev_b32 v86, 16, v197
    v_and_b32 v87, 0xffff0000, v197
    v_pk_add_f32 v[178:179], v[178:179], v[86:87]
    v_lshlrev_b32 v84, 16, v198
    v_and_b32 v85, 0xffff0000, v198
    v_pk_add_f32 v[180:181], v[180:181], v[84:85]
    v_lshlrev_b32 v86, 16, v199
    v_and_b32 v87, 0xffff0000, v199
    v_pk_add_f32 v[182:183], v[182:183], v[86:87]
    v_lshlrev_b32 v84, 16, v200
    v_and_b32 v85, 0xffff0000, v200
    v_pk_add_f32 v[184:185], v[184:185], v[84:85]
    v_lshlrev_b32 v86, 16, v201
    v_and_b32 v87, 0xffff0000, v201
    v_pk_add_f32 v[186:187], v[186:187], v[86:87]
    v_lshlrev_b32 v84, 16, v202
    v_and_b32 v85, 0xffff0000, v202
    v_pk_add_f32 v[188:189], v[188:189], v[84:85]
    v_lshlrev_b32 v86, 16, v203
    v_and_b32 v87, 0xffff0000, v203
    v_pk_add_f32 v[190:191], v[190:191], v[86:87]
    v_lshlrev_b32 v84, 16, v204
    v_and_b32 v85, 0xffff0000, v204
    v_pk_add_f32 v[192:193], v[192:193], v[84:85]
    v_lshlrev_b32 v86, 16, v205
    v_and_b32 v87, 0xffff0000, v205
    v_pk_add_f32 v[194:195], v[194:195], v[86:87]
    v_lshlrev_b32 v84, 16, v208
    v_and_b32 v85, 0xffff0000, v208
    v_pk_add_f32 v[176:177], v[176:177], v[84:85]
    v_lshlrev_b32 v86, 16, v209
    v_and_b32 v87, 0xffff0000, v209
    v_pk_add_f32 v[178:179], v[178:179], v[86:87]
    v_lshlrev_b32 v84, 16, v210
    v_and_b32 v85, 0xffff0000, v210
    v_pk_add_f32 v[180:181], v[180:181], v[84:85]
    v_lshlrev_b32 v86, 16, v211
    v_and_b32 v87, 0xffff0000, v211
    v_pk_add_f32 v[182:183], v[182:183], v[86:87]
    v_lshlrev_b32 v84, 16, v212
    v_and_b32 v85, 0xffff0000, v212
    v_pk_add_f32 v[184:185], v[184:185], v[84:85]
    v_lshlrev_b32 v86, 16, v213
    v_and_b32 v87, 0xffff0000, v213
    v_pk_add_f32 v[186:187], v[186:187], v[86:87]
    v_lshlrev_b32 v84, 16, v214
    v_and_b32 v85, 0xffff0000, v214
    v_pk_add_f32 v[188:189], v[188:189], v[84:85]
    v_lshlrev_b32 v86, 16, v215
    v_and_b32 v87, 0xffff0000, v215
    v_pk_add_f32 v[190:191], v[190:191], v[86:87]
    v_lshlrev_b32 v84, 16, v216
    v_and_b32 v85, 0xffff0000, v216
    v_pk_add_f32 v[192:193], v[192:193], v[84:85]
    v_lshlrev_b32 v86, 16, v217
    v_and_b32 v87, 0xffff0000, v217
    v_pk_add_f32 v[194:195], v[194:195], v[86:87]
    v_lshlrev_b32 v84, 16, v220
    v_and_b32 v85, 0xffff0000, v220
    v_pk_add_f32 v[176:177], v[176:177], v[84:85]
    v_lshlrev_b32 v86, 16, v221
    v_and_b32 v87, 0xffff0000, v221
    v_pk_add_f32 v[178:179], v[178:179], v[86:87]
    v_lshlrev_b32 v84, 16, v222
    v_and_b32 v85, 0xffff0000, v222
    v_pk_add_f32 v[180:181], v[180:181], v[84:85]
    v_lshlrev_b32 v86, 16, v223
    v_and_b32 v87, 0xffff0000, v223
    v_pk_add_f32 v[182:183], v[182:183], v[86:87]
    v_lshlrev_b32 v84, 16, v224
    v_and_b32 v85, 0xffff0000, v224
    v_pk_add_f32 v[184:185], v[184:185], v[84:85]
    v_lshlrev_b32 v86, 16, v225
    v_and_b32 v87, 0xffff0000, v225
    v_pk_add_f32 v[186:187], v[186:187], v[86:87]
    v_lshlrev_b32 v84, 16, v226
    v_and_b32 v85, 0xffff0000, v226
    v_pk_add_f32 v[188:189], v[188:189], v[84:85]
    v_lshlrev_b32 v86, 16, v227
    v_and_b32 v87, 0xffff0000, v227
    v_pk_add_f32 v[190:191], v[190:191], v[86:87]
    v_lshlrev_b32 v84, 16, v228
    v_and_b32 v85, 0xffff0000, v228
    v_pk_add_f32 v[192:193], v[192:193], v[84:85]
    v_lshlrev_b32 v86, 16, v229
    v_and_b32 v87, 0xffff0000, v229
    v_pk_add_f32 v[194:195], v[194:195], v[86:87]
    v_lshlrev_b32 v232, 16, v74
    v_and_b32 v233, 0xffff0000, v74
    v_lshlrev_b32 v234, 16, v75
    v_and_b32 v235, 0xffff0000, v75
    v_lshlrev_b32 v236, 16, v76
    v_and_b32 v237, 0xffff0000, v76
    v_lshlrev_b32 v238, 16, v77
    v_and_b32 v239, 0xffff0000, v77
    v_lshlrev_b32 v240, 16, v78
    v_and_b32 v241, 0xffff0000, v78
    v_lshlrev_b32 v242, 16, v79
    v_and_b32 v243, 0xffff0000, v79
    v_lshlrev_b32 v244, 16, v80
    v_and_b32 v245, 0xffff0000, v80
    v_lshlrev_b32 v246, 16, v81
    v_and_b32 v247, 0xffff0000, v81
    v_lshlrev_b32 v248, 16, v82
    v_and_b32 v249, 0xffff0000, v82
    v_lshlrev_b32 v250, 16, v83
    v_and_b32 v251, 0xffff0000, v83
    v_add_f32 v176, v232, v176
    v_add_f32 v177, v233, v177
    v_add_f32 v178, v234, v178
    v_add_f32 v179, v235, v179
    v_add_f32 v180, v236, v180
    v_add_f32 v181, v237, v181
    v_add_f32 v182, v238, v182
    v_add_f32 v183, v239, v183
    v_add_f32 v184, v240, v184
    v_add_f32 v185, v241, v185
    v_add_f32 v186, v242, v186
    v_add_f32 v187, v243, v187
    v_add_f32 v188, v244, v188
    v_add_f32 v189, v245, v189
    v_add_f32 v190, v246, v190
    v_add_f32 v191, v247, v191
    v_add_f32 v192, v248, v192
    v_add_f32 v193, v249, v193
    v_add_f32 v194, v250, v194
    v_add_f32 v195, v251, v195
    v_mul_f32 v232, 0xbfb8aa3b, v176
    v_mul_f32 v233, 0xbfb8aa3b, v177
    v_mul_f32 v234, 0xbfb8aa3b, v178
    v_mul_f32 v235, 0xbfb8aa3b, v179
    v_mul_f32 v236, 0xbfb8aa3b, v180
    v_mul_f32 v237, 0xbfb8aa3b, v181
    v_mul_f32 v238, 0xbfb8aa3b, v182
    v_mul_f32 v239, 0xbfb8aa3b, v183
    v_mul_f32 v240, 0xbfb8aa3b, v184
    v_mul_f32 v241, 0xbfb8aa3b, v185
    v_mul_f32 v242, 0xbfb8aa3b, v186
    v_mul_f32 v243, 0xbfb8aa3b, v187
    v_mul_f32 v244, 0xbfb8aa3b, v188
    v_mul_f32 v245, 0xbfb8aa3b, v189
    v_mul_f32 v246, 0xbfb8aa3b, v190
    v_mul_f32 v247, 0xbfb8aa3b, v191
    v_mul_f32 v248, 0xbfb8aa3b, v192
    v_mul_f32 v249, 0xbfb8aa3b, v193
    v_mul_f32 v250, 0xbfb8aa3b, v194
    v_mul_f32 v251, 0xbfb8aa3b, v195
    s_waitcnt vmcnt(0) lgkmcnt(0)
    s_mov_b32 exec_hi, 0
    buffer_store_dword v37, v62, s[92:95], s45 offen sc1
    s_mov_b32 exec_hi, -1
    buffer_load_dwordx2 v[64:65], v18, s[84:87], 0 offen offset:0
    buffer_load_dwordx2 v[66:67], v18, s[84:87], 0 offen offset:32
    buffer_load_dwordx2 v[68:69], v18, s[84:87], 0 offen offset:64
    buffer_load_dwordx2 v[70:71], v18, s[84:87], 0 offen offset:96
    buffer_load_dwordx2 v[72:73], v18, s[84:87], 0 offen offset:128
    v_exp_f32 v232, v232
    v_exp_f32 v233, v233
    v_exp_f32 v234, v234
    v_exp_f32 v235, v235
    v_exp_f32 v236, v236
    v_exp_f32 v237, v237
    v_exp_f32 v238, v238
    v_exp_f32 v239, v239
    v_exp_f32 v240, v240
    v_exp_f32 v241, v241
    v_exp_f32 v242, v242
    v_exp_f32 v243, v243
    v_exp_f32 v244, v244
    v_exp_f32 v245, v245
    v_exp_f32 v246, v246
    v_exp_f32 v247, v247
    v_exp_f32 v248, v248
    v_exp_f32 v249, v249
    v_exp_f32 v250, v250
    v_exp_f32 v251, v251
    v_add_f32 v232, 1.0, v232
    v_add_f32 v233, 1.0, v233
    v_add_f32 v234, 1.0, v234
    v_add_f32 v235, 1.0, v235
    v_add_f32 v236, 1.0, v236
    v_add_f32 v237, 1.0, v237
    v_add_f32 v238, 1.0, v238
    v_add_f32 v239, 1.0, v239
    v_add_f32 v240, 1.0, v240
    v_add_f32 v241, 1.0, v241
    v_add_f32 v242, 1.0, v242
    v_add_f32 v243, 1.0, v243
    v_add_f32 v244, 1.0, v244
    v_add_f32 v245, 1.0, v245
    v_add_f32 v246, 1.0, v246
    v_add_f32 v247, 1.0, v247
    v_add_f32 v248, 1.0, v248
    v_add_f32 v249, 1.0, v249
    v_add_f32 v250, 1.0, v250
    v_add_f32 v251, 1.0, v251
    v_rcp_f32 v232, v232
    v_rcp_f32 v233, v233
    v_rcp_f32 v234, v234
    v_rcp_f32 v235, v235
    v_rcp_f32 v236, v236
    v_rcp_f32 v237, v237
    v_rcp_f32 v238, v238
    v_rcp_f32 v239, v239
    v_rcp_f32 v240, v240
    v_rcp_f32 v241, v241
    v_rcp_f32 v242, v242
    v_rcp_f32 v243, v243
    v_rcp_f32 v244, v244
    v_rcp_f32 v245, v245
    v_rcp_f32 v246, v246
    v_rcp_f32 v247, v247
    v_rcp_f32 v248, v248
    v_rcp_f32 v249, v249
    v_rcp_f32 v250, v250
    v_rcp_f32 v251, v251
    v_mul_f32 v176, v176, v232
    v_mul_f32 v177, v177, v233
    v_mul_f32 v178, v178, v234
    v_mul_f32 v179, v179, v235
    v_mul_f32 v180, v180, v236
    v_mul_f32 v181, v181, v237
    v_mul_f32 v182, v182, v238
    v_mul_f32 v183, v183, v239
    v_mul_f32 v184, v184, v240
    v_mul_f32 v185, v185, v241
    v_mul_f32 v186, v186, v242
    v_mul_f32 v187, v187, v243
    v_mul_f32 v188, v188, v244
    v_mul_f32 v189, v189, v245
    v_mul_f32 v190, v190, v246
    v_mul_f32 v191, v191, v247
    v_mul_f32 v192, v192, v248
    v_mul_f32 v193, v193, v249
    v_mul_f32 v194, v194, v250
    v_mul_f32 v195, v195, v251
L_poll4:
    buffer_load_dword v60, v33, s[92:95], s57 offen sc1
    s_waitcnt vmcnt(0)
    v_cmp_ne_u32 vcc, v37, v60
    s_cbranch_vccnz L_poll4
    s_lshl_b32 s45, s55, 2
    s_add_u32 s45, s45, s40
    s_mul_i32 s45, s45, 40960
    s_mul_i32 s46, s38, 2560
    s_add_u32 s45, s45, s46
    s_add_u32 s45, s45, 0
    s_add_u32 s45, s45, 10240
    buffer_load_dwordx4 v[116:119], v1, s[4:7], s45 offen sc1
    buffer_load_dwordx4 v[120:123], v1, s[4:7], s45 offen offset:1024 sc1
    buffer_load_dwordx2 v[124:125], v32, s[4:7], s45 offen offset:2048 sc1
    s_add_u32 s45, s45, 10240
    buffer_load_dwordx4 v[128:131], v1, s[4:7], s45 offen sc1
    buffer_load_dwordx4 v[132:135], v1, s[4:7], s45 offen offset:1024 sc1
    buffer_load_dwordx2 v[136:137], v32, s[4:7], s45 offen offset:2048 sc1
    s_add_u32 s45, s45, 10240
    buffer_load_dwordx4 v[140:143], v1, s[4:7], s45 offen sc1
    buffer_load_dwordx4 v[144:147], v1, s[4:7], s45 offen offset:1024 sc1
    buffer_load_dwordx2 v[148:149], v32, s[4:7], s45 offen offset:2048 sc1
    v_lshlrev_b32 v152, 16, v64
    v_and_b32 v153, 0xffff0000, v64
    v_lshlrev_b32 v154, 16, v65
    v_and_b32 v155, 0xffff0000, v65
    v_lshlrev_b32 v156, 16, v66
    v_and_b32 v157, 0xffff0000, v66
    v_lshlrev_b32 v158, 16, v67
    v_and_b32 v159, 0xffff0000, v67
    v_lshlrev_b32 v160, 16, v68
    v_and_b32 v161, 0xffff0000, v68
    v_lshlrev_b32 v162, 16, v69
    v_and_b32 v163, 0xffff0000, v69
    v_lshlrev_b32 v164, 16, v70
    v_and_b32 v165, 0xffff0000, v70
    v_lshlrev_b32 v166, 16, v71
    v_and_b32 v167, 0xffff0000, v71
    v_lshlrev_b32 v168, 16, v72
    v_and_b32 v169, 0xffff0000, v72
    v_lshlrev_b32 v170, 16, v73
    v_and_b32 v171, 0xffff0000, v73
    s_waitcnt vmcnt(6)
    v_lshlrev_b32 v84, 16, v116
    v_and_b32 v85, 0xffff0000, v116
    v_pk_add_f32 v[96:97], v[96:97], v[84:85]
    v_lshlrev_b32 v86, 16, v117
    v_and_b32 v87, 0xffff0000, v117
    v_pk_add_f32 v[98:99], v[98:99], v[86:87]
    v_lshlrev_b32 v84, 16, v118
    v_and_b32 v85, 0xffff0000, v118
    v_pk_add_f32 v[100:101], v[100:101], v[84:85]
    v_lshlrev_b32 v86, 16, v119
    v_and_b32 v87, 0xffff0000, v119
    v_pk_add_f32 v[102:103], v[102:103], v[86:87]
    v_lshlrev_b32 v84, 16, v120
    v_and_b32 v85, 0xffff0000, v120
    v_pk_add_f32 v[104:105], v[104:105], v[84:85]
    v_lshlrev_b32 v86, 16, v121
    v_and_b32 v87, 0xffff0000, v121
    v_pk_add_f32 v[106:107], v[106:107], v[86:87]
    v_lshlrev_b32 v84, 16, v122
    v_and_b32 v85, 0xffff0000, v122
    v_pk_add_f32 v[108:109], v[108:109], v[84:85]
    v_lshlrev_b32 v86, 16, v123
    v_and_b32 v87, 0xffff0000, v123
    v_pk_add_f32 v[110:111], v[110:111], v[86:87]
    v_lshlrev_b32 v84, 16, v124
    v_and_b32 v85, 0xffff0000, v124
    v_pk_add_f32 v[112:113], v[112:113], v[84:85]
    v_lshlrev_b32 v86, 16, v125
    v_and_b32 v87, 0xffff0000, v125
    v_pk_add_f32 v[114:115], v[114:115], v[86:87]
    s_waitcnt vmcnt(3)
    v_lshlrev_b32 v84, 16, v128
    v_and_b32 v85, 0xffff0000, v128
    v_pk_add_f32 v[96:97], v[96:97], v[84:85]
    v_lshlrev_b32 v86, 16, v129
    v_and_b32 v87, 0xffff0000, v129
    v_pk_add_f32 v[98:99], v[98:99], v[86:87]
    v_lshlrev_b32 v84, 16, v130
    v_and_b32 v85, 0xffff0000, v130
    v_pk_add_f32 v[100:101], v[100:101], v[84:85]
    v_lshlrev_b32 v86, 16, v131
    v_and_b32 v87, 0xffff0000, v131
    v_pk_add_f32 v[102:103], v[102:103], v[86:87]
    v_lshlrev_b32 v84, 16, v132
    v_and_b32 v85, 0xffff0000, v132
    v_pk_add_f32 v[104:105], v[104:105], v[84:85]
    v_lshlrev_b32 v86, 16, v133
    v_and_b32 v87, 0xffff0000, v133
    v_pk_add_f32 v[106:107], v[106:107], v[86:87]
    v_lshlrev_b32 v84, 16, v134
    v_and_b32 v85, 0xffff0000, v134
    v_pk_add_f32 v[108:109], v[108:109], v[84:85]
    v_lshlrev_b32 v86, 16, v135
    v_and_b32 v87, 0xffff0000, v135
    v_pk_add_f32 v[110:111], v[110:111], v[86:87]
    v_lshlrev_b32 v84, 16, v136
    v_and_b32 v85, 0xffff0000, v136
    v_pk_add_f32 v[112:113], v[112:113], v[84:85]
    v_lshlrev_b32 v86, 16, v137
    v_and_b32 v87, 0xffff0000, v137
    v_pk_add_f32 v[114:115], v[114:115], v[86:87]
    s_waitcnt vmcnt(0)
    v_lshlrev_b32 v84, 16, v140
    v_and_b32 v85, 0xffff0000, v140
    v_pk_add_f32 v[96:97], v[96:97], v[84:85]
    v_lshlrev_b32 v86, 16, v141
    v_and_b32 v87, 0xffff0000, v141
    v_pk_add_f32 v[98:99], v[98:99], v[86:87]
    v_lshlrev_b32 v84, 16, v142
    v_and_b32 v85, 0xffff0000, v142
    v_pk_add_f32 v[100:101], v[100:101], v[84:85]
    v_lshlrev_b32 v86, 16, v143
    v_and_b32 v87, 0xffff0000, v143
    v_pk_add_f32 v[102:103], v[102:103], v[86:87]
    v_lshlrev_b32 v84, 16, v144
    v_and_b32 v85, 0xffff0000, v144
    v_pk_add_f32 v[104:105], v[104:105], v[84:85]
    v_lshlrev_b32 v86, 16, v145
    v_and_b32 v87, 0xffff0000, v145
    v_pk_add_f32 v[106:107], v[106:107], v[86:87]
    v_lshlrev_b32 v84, 16, v146
    v_and_b32 v85, 0xffff0000, v146
    v_pk_add_f32 v[108:109], v[108:109], v[84:85]
    v_lshlrev_b32 v86, 16, v147
    v_and_b32 v87, 0xffff0000, v147
    v_pk_add_f32 v[110:111], v[110:111], v[86:87]
    v_lshlrev_b32 v84, 16, v148
    v_and_b32 v85, 0xffff0000, v148
    v_pk_add_f32 v[112:113], v[112:113], v[84:85]
    v_lshlrev_b32 v86, 16, v149
    v_and_b32 v87, 0xffff0000, v149
    v_pk_add_f32 v[114:115], v[114:115], v[86:87]
    v_fmac_f32 v152, v176, v96
    v_fmac_f32 v153, v177, v97
    v_fmac_f32 v154, v178, v98
    v_fmac_f32 v155, v179, v99
    v_fmac_f32 v156, v180, v100
    v_fmac_f32 v157, v181, v101
    v_fmac_f32 v158, v182, v102
    v_fmac_f32 v159, v183, v103
    v_fmac_f32 v160, v184, v104
    v_fmac_f32 v161, v185, v105
    v_fmac_f32 v162, v186, v106
    v_fmac_f32 v163, v187, v107
    v_fmac_f32 v164, v188, v108
    v_fmac_f32 v165, v189, v109
    v_fmac_f32 v166, v190, v110
    v_fmac_f32 v167, v191, v111
    v_fmac_f32 v168, v192, v112
    v_fmac_f32 v169, v193, v113
    v_fmac_f32 v170, v194, v114
    v_fmac_f32 v171, v195, v115
    v_cvt_pk_bf16_f32 v40, v152, v153
    v_cvt_pk_bf16_f32 v41, v154, v155
    buffer_store_dwordx2 v[40:41], v18, s[8:11], 0 offen offset:0
    v_cvt_pk_bf16_f32 v42, v156, v157
    v_cvt_pk_bf16_f32 v43, v158, v159
    buffer_store_dwordx2 v[42:43], v18, s[8:11], 0 offen offset:32
    v_cvt_pk_bf16_f32 v44, v160, v161
    v_cvt_pk_bf16_f32 v45, v162, v163
    buffer_store_dwordx2 v[44:45], v18, s[8:11], 0 offen offset:64
    v_cvt_pk_bf16_f32 v46, v164, v165
    v_cvt_pk_bf16_f32 v47, v166, v167
    buffer_store_dwordx2 v[46:47], v18, s[8:11], 0 offen offset:96
    v_cvt_pk_bf16_f32 v48, v168, v169
    v_cvt_pk_bf16_f32 v49, v170, v171
    buffer_store_dwordx2 v[48:49], v18, s[8:11], 0 offen offset:128
L_end:
    s_endpgm
.section .rodata,"a"
.p2align 6
.amdhsa_kernel recurrent_scan__gqa_block_cached__dense_activation_gelu__prompt_kernel
  .amdhsa_next_free_vgpr 512
  .amdhsa_next_free_sgpr 102
  .amdhsa_accum_offset 256
  .amdhsa_group_segment_fixed_size 0
  .amdhsa_kernarg_size 104
  .amdhsa_user_sgpr_count 2
  .amdhsa_user_sgpr_kernarg_segment_ptr 1
  .amdhsa_system_sgpr_workgroup_id_x 1
.end_amdhsa_kernel
```
